```python
import torch

def _softmax(x, axis=-1):
    return torch.softmax(x, dim=axis)
def _gelu(x):
    return torch.nn.functional.gelu(x, approximate="tanh")
def _silu(x):
    return torch.nn.functional.silu(x)
def _sigmoid(x):
    return torch.sigmoid(x)
def _layernorm(x, axis=-1, eps=1e-5):
    m = x.mean(dim=axis, keepdim=True)
    v = x.var(dim=axis, keepdim=True, unbiased=False)
    return (x - m) / torch.sqrt(v + eps)
def _scatter_add(tgt, idx, src, axis=0):
    return tgt.clone().index_add_(axis, idx, src)
def _segment_sum(src, seg, n):
    out = torch.zeros((n,) + src.shape[1:], dtype=src.dtype)
    return out.index_add_(0, seg, src)
def _pad(x, pw):
    flat = tuple(v for pair in reversed(pw) for v in pair)
    return torch.nn.functional.pad(x, flat)

kernel_name = 'recurrent_scan__linear_attn_block__dense_activation_squared_relu__prompt'

def setup_inputs():

    _w = (lambda a: (lambda t: t.to(torch.bfloat16) if t.is_floating_point() else t)(torch.as_tensor(a)))
    def _A_setup():
        B, S, D = 1, 2048, 512
        return {
            "x": _w((lambda *s: torch.randn(*s, dtype=torch.bfloat16) * 0.05)(B, S, D)),
            "wqkv": _w((lambda *s: torch.randn(*s, dtype=torch.bfloat16) * 0.05)(D, 3 * D)),
            "wo": _w((lambda *s: torch.randn(*s, dtype=torch.bfloat16) * 0.05)(D, D)),
        }
    _A_in = _A_setup()

    def _B_setup():
        B, S, D, F = 1, 2048, 512, 1792
        return {
            "x": _w((lambda *s: torch.randn(*s, dtype=torch.bfloat16) * 0.05)(B, S, D)),
            "w1": _w((lambda *s: torch.randn(*s, dtype=torch.bfloat16) * 0.05)(D, F)),
            "b1": _w((lambda *s: torch.randn(*s, dtype=torch.bfloat16) * 0.2)(F)),
            "w2": _w((lambda *s: torch.randn(*s, dtype=torch.bfloat16) * 0.05)(F, D)),
            "b2": _w((lambda *s: torch.randn(*s, dtype=torch.bfloat16) * 1.6)(D)),
        }
    _B_in = _B_setup()

    return {
        "A_x": _A_in["x"],
        "A_wqkv": _A_in["wqkv"],
        "A_wo": _A_in["wo"],
        "B_x": _B_in["x"],
        "B_w1": _B_in["w1"],
        "B_b1": _B_in["b1"],
        "B_w2": _B_in["w2"],
        "B_b2": _B_in["b2"],
    }

def reference(A_x, A_wqkv, A_wo, B_x, B_w1, B_b1, B_w2, B_b2):
    def _A_ref(x, wqkv, wo):
        B, S, D = x.shape
        H = 32; Dh = D // H
        qkv = (lambda x, *d: x.permute(*d))((x @ wqkv).reshape(B, S, 3, H, Dh), 2, 0, 3, 1, 4)
        q, k, v = qkv[0], qkv[1], qkv[2]
        phi = lambda t: torch.where(t > 0, t + 1, torch.exp(t)) + 1e-6
        pq, pk = phi(q), phi(k)
        kv = torch.einsum("bhsd,bhse->bhde", pk, v)
        z = torch.einsum("bhsd->bhd", pk)
        num = torch.einsum("bhqd,bhde->bhqe", pq, kv)
        den = torch.einsum("bhqd,bhd->bhq", pq, z)[..., None] + 1e-6
        o = num / den
        return (lambda x, *d: x.permute(*d))(o, 0, 2, 1, 3).reshape(B, S, D) @ wo

    def _B_ref(x, w1, b1, w2, b2):
        h = torch.einsum("bsd,df->bsf", x, w1) + b1
        zero = torch.zeros_like(h)
        r = torch.where(h > zero, h, zero)
        h = r * r
        out = torch.einsum("bsf,fd->bsd", h, w2) + b2
        return out

    x = A_x
    xn = _layernorm(x, axis=-1)
    s = _A_ref(xn, A_wqkv, A_wo)
    g = _silu(_B_ref(xn, B_w1, B_b1, B_w2, B_b2))
    return x + s * g
```

```asm
; @launch grid=(256,1,1) block=(512,1,1) lds=163840
.amdgcn_target "amdgcn-amd-amdhsa--gfx950"
.text
.globl recurrent_scan__linear_attn_block__dense_activation_squared_relu__prompt_kernel
.p2align 8
.type recurrent_scan__linear_attn_block__dense_activation_squared_relu__prompt_kernel,@function
recurrent_scan__linear_attn_block__dense_activation_squared_relu__prompt_kernel:
s_cmp_ge_u32 s2, 256
s_cbranch_scc1 k_end
s_load_dwordx16 s[4:19], s[0:1], 0
s_load_dwordx4 s[20:23], s[0:1], 64
s_load_dwordx2 s[24:25], s[0:1], 80
s_getpc_b64 s[56:57]
k_pc:
v_lshrrev_b32 v2, 6, v0
v_and_b32 v1, 63, v0
s_lshr_b32 s58, s2, 3
v_readfirstlane_b32 s3, v2
s_and_b32 s59, s58, 7
v_lshl_add_u32 v5, v0, 3, s59
v_cmp_gt_u32 vcc, (code_end-k_pc)>>7, v5
v_lshlrev_b32 v5, 7, v5
s_and_saveexec_b64 s[60:61], vcc
s_cbranch_execz k_nopf
global_load_dword v255, v5, s[56:57]
k_nopf:
s_mov_b64 exec, s[60:61]
s_and_b32 s60, s2, 7
s_lshr_b32 s61, s60, 2
s_lshl_b32 s61, s61, 3
s_add_u32 s26, s61, s59
s_lshr_b32 s62, s58, 3
s_and_b32 s60, s60, 3
s_lshl_b32 s60, s60, 2
s_add_u32 s27, s60, s62
s_lshr_b32 s28, s27, 1
s_and_b32 s29, s28, 1
s_and_b32 s31, s3, 3
s_lshl_b32 s65, s26, 17
s_cmp_ge_u32 s3, 4
s_cbranch_scc1 k_loader
v_lshrrev_b32 v2, 5, v1
v_and_b32 v3, 31, v1
s_lshl_b32 s67, s27, 3
s_lshl_b32 s68, s31, 1
s_add_u32 s67, s67, s68
v_add_u32 v4, s67, v2
v_lshlrev_b32 v16, 10, v4
v_lshl_add_u32 v16, v3, 4, v16
s_waitcnt lgkmcnt(0)
s_add_u32 s32, s4, s65
s_addc_u32 s33, s5, 0
s_and_b32 s33, s33, 0xffff
s_mov_b32 s34, 131072
s_mov_b32 s35, 0x00020000
buffer_load_dwordx4 v[20:23], v16, s[32:35], 0 offen
buffer_load_dwordx4 v[24:27], v16, s[32:35], 0 offen offset:512
s_branch k_mfma
k_loader:
s_and_b32 s31, s3, 1
s_cmp_ge_u32 s3, 6
s_cbranch_scc1 k_helper
v_lshrrev_b32 v5, 3, v1
v_and_b32 v6, 7, v1
v_xor_b32 v7, v5, v6
v_lshlrev_b32 v7, 4, v7
v_lshl_add_u32 v2, v5, 10, v7
s_lshl_b32 s67, s31, 15
v_add_u32 v2, s67, v2
v_and_b32 v7, 3, v5
v_lshrrev_b32 v8, 2, v5
v_lshl_add_u32 v38, v8, 3, v7
v_mul_u32_u24 v3, 3584, v38
v_and_b32 v7, 6, v5
v_xor_b32 v7, v7, v6
v_lshlrev_b32 v40, 4, v7
s_and_b32 s60, s27, 1
s_lshl_b32 s60, s60, 8
s_lshl_b32 s61, s29, 6
s_add_u32 s60, s60, s61
v_add3_u32 v3, v40, v3, s60
s_lshl_b32 s71, s31, 12
s_add_u32 s57, s62, s59
s_and_b32 s57, s57, 3
s_lshl_b32 s57, s57, 1
s_lshl_b32 s73, s57, 7
s_mul_i32 s72, s31, 57344
s_mul_i32 s74, s57, 229376
s_add_u32 s74, s74, s72
s_mul_i32 s63, s28, 448
s_waitcnt lgkmcnt(0)
s_add_u32 s32, s4, s65
s_addc_u32 s33, s5, 0
s_and_b32 s33, s33, 0xffff
s_mov_b32 s34, 131072
s_mov_b32 s35, 0x00020000
s_add_u32 s36, s12, s63
s_addc_u32 s37, s13, 0
s_and_b32 s37, s37, 0xffff
s_sub_u32 s38, 1835008, s63
s_mov_b32 s39, 0x00020000
s_add_u32 m0, s71, 49152
s_add_u32 s77, s73, 0
buffer_load_dwordx4 v2, s[32:35], s77 offen lds
s_add_u32 m0, s71, 57344
s_add_u32 s77, s73, 65536
buffer_load_dwordx4 v2, s[32:35], s77 offen lds
s_add_u32 m0, s71, 50176
s_add_u32 s77, s73, 8192
buffer_load_dwordx4 v2, s[32:35], s77 offen lds
s_add_u32 m0, s71, 58368
s_add_u32 s77, s73, 73728
buffer_load_dwordx4 v2, s[32:35], s77 offen lds
s_add_u32 m0, s71, 51200
s_add_u32 s77, s73, 16384
buffer_load_dwordx4 v2, s[32:35], s77 offen lds
s_add_u32 m0, s71, 59392
s_add_u32 s77, s73, 81920
buffer_load_dwordx4 v2, s[32:35], s77 offen lds
s_add_u32 m0, s71, 52224
s_add_u32 s77, s73, 24576
buffer_load_dwordx4 v2, s[32:35], s77 offen lds
s_add_u32 m0, s71, 60416
s_add_u32 s77, s73, 90112
buffer_load_dwordx4 v2, s[32:35], s77 offen lds
s_add_u32 m0, s71, 0
s_add_u32 s77, s74, 0
buffer_load_dwordx4 v3, s[36:39], s77 offen lds
s_add_u32 m0, s71, 8192
s_add_u32 s77, s74, 114688
buffer_load_dwordx4 v3, s[36:39], s77 offen lds
s_add_u32 m0, s71, 1024
s_add_u32 s77, s74, 14336
buffer_load_dwordx4 v3, s[36:39], s77 offen lds
s_add_u32 m0, s71, 9216
s_add_u32 s77, s74, 129024
buffer_load_dwordx4 v3, s[36:39], s77 offen lds
v_bfe_u32 v7, v1, 2, 2
v_bfe_u32 v8, v1, 4, 1
v_lshl_or_b32 v7, v8, 3, v7
v_lshrrev_b32 v9, 5, v1
v_lshl_or_b32 v7, v9, 2, v7
v_mul_u32_u24 v4, 3584, v7
v_and_b32 v7, 3, v1
v_lshlrev_b32 v8, 1, v8
v_xor_b32 v7, v7, v8
v_lshl_add_u32 v4, v7, 4, v4
s_cmp_eq_u32 s29, 0
s_cselect_b32 s60, 384, 0
v_add_u32 v4, s60, v4
v_mul_u32_u24 v39, 3072, v38
v_add_u32 v39, v40, v39
s_lshl_b32 s64, s28, 7
s_bitcmp1_b32 s27, 0
s_cbranch_scc1 k_ldb
s_branch k_lda
k_mfma:
s_mov_b32 s44, s24
s_and_b32 s45, s25, 0xffff
s_mov_b32 s46, 16777216
s_mov_b32 s47, 0x00020000
s_mov_b32 s48, s22
s_and_b32 s49, s23, 0xffff
s_mov_b32 s50, 256
s_mov_b32 s51, 0x00020000
s_or_b32 s73, s2, s3
s_cmp_lg_u32 s73, 0
s_cbranch_scc1 k_nononce
s_memrealtime s[74:75]
v_mov_b32 v19, 0
s_waitcnt lgkmcnt(0)
s_or_b32 s74, s74, 1
v_mov_b32 v28, s74
s_mov_b64 exec, 1
buffer_store_dword v28, v19, s[48:51], 0 offen sc1
s_mov_b64 exec, -1
k_nononce:
v_lshrrev_b32 v102, 4, v1
v_and_b32 v100, 15, v1
v_lshlrev_b32 v101, 4, v1
v_bfe_u32 v29, v1, 2, 2
v_and_b32 v30, 3, v1
v_and_b32 v31, 1, v102
v_lshl_add_u32 v10, v31, 2, v29
v_lshrrev_b32 v11, 1, v29
v_lshl_or_b32 v11, v31, 1, v11
v_lshrrev_b32 v12, 5, v1
v_lshlrev_b32 v12, 12, v12
v_lshl_add_u32 v12, v30, 3, v12
v_lshl_add_u32 v8, v10, 6, v12
v_lshl_add_u32 v8, v31, 5, v8
v_xor_b32 v9, 32, v8
v_lshl_add_u32 v12, v10, 7, v12
v_xor_b32 v13, 0, v11
v_lshl_add_u32 v4, v13, 5, v12
v_xor_b32 v13, 1, v11
v_lshl_add_u32 v5, v13, 5, v12
v_xor_b32 v13, 2, v11
v_lshl_add_u32 v6, v13, 5, v12
v_xor_b32 v13, 3, v11
v_lshl_add_u32 v7, v13, 5, v12
v_and_b32 v13, 7, v1
v_xor_b32 v13, v102, v13
v_lshlrev_b32 v13, 4, v13
v_lshl_add_u32 v13, v100, 7, v13
s_lshr_b32 s68, s31, 1
s_and_b32 s61, s31, 1
s_lshl_b32 s73, s68, 13
s_add_u32 s73, s73, 49152
v_add_u32 v2, s73, v13
v_xor_b32 v3, 64, v2
v_add_u32 v88, 49152, v2
v_add_u32 v89, 49152, v3
s_cmp_lg_u32 s61, 0
s_cselect_b64 s[74:75], -1, 0
v_cndmask_b32 v90, v4, v6, s[74:75]
v_cndmask_b32 v91, v5, v7, s[74:75]
v_mov_b32 v15, 0
s_xor_b32 s73, s27, 1
s_and_b32 s73, s73, 1
s_or_b32 s73, s73, s26
s_cmp_lg_u32 s73, 0
s_cbranch_scc1 k_nozero
v_mov_b32 v64, 0
v_mov_b32 v65, 0
v_mov_b32 v66, 0
v_mov_b32 v67, 0
s_lshl_b32 s73, s28, 2
s_add_u32 s73, s73, s31
s_lshl_b32 s74, s73, 10
s_add_u32 s74, s74, 11534336
s_lshl_b32 s73, s73, 7
s_add_u32 s73, s73, 12058624
buffer_store_dwordx4 v[64:67], v101, s[44:47], s74 offen sc1
s_mov_b64 exec, 15
buffer_store_dwordx4 v[64:67], v101, s[44:47], s73 offen sc1
s_mov_b64 exec, -1
s_waitcnt vmcnt(2)
s_branch k_zdone
k_nozero:
s_waitcnt vmcnt(0)
k_zdone:
v_lshlrev_b32 v32, 16, v20
v_and_b32 v33, 0xffff0000, v20
v_lshlrev_b32 v34, 16, v21
v_and_b32 v35, 0xffff0000, v21
v_lshlrev_b32 v36, 16, v22
v_and_b32 v37, 0xffff0000, v22
v_lshlrev_b32 v38, 16, v23
v_and_b32 v39, 0xffff0000, v23
v_lshlrev_b32 v40, 16, v24
v_and_b32 v41, 0xffff0000, v24
v_lshlrev_b32 v42, 16, v25
v_and_b32 v43, 0xffff0000, v25
v_lshlrev_b32 v44, 16, v26
v_and_b32 v45, 0xffff0000, v26
v_lshlrev_b32 v46, 16, v27
v_and_b32 v47, 0xffff0000, v27
v_pk_add_f32 v[48:49], v[32:33], v[34:35]
v_pk_add_f32 v[50:51], v[36:37], v[38:39]
v_pk_add_f32 v[52:53], v[40:41], v[42:43]
v_pk_add_f32 v[54:55], v[44:45], v[46:47]
v_pk_add_f32 v[48:49], v[48:49], v[50:51]
v_pk_add_f32 v[52:53], v[52:53], v[54:55]
s_nop 0
v_pk_add_f32 v[48:49], v[48:49], v[52:53]
s_nop 0
v_add_f32 v56, v48, v49
v_mov_b32 v57, v56
s_nop 1
v_permlane16_swap_b32 v57, v56
s_nop 1
v_add_f32 v56, v56, v57
s_nop 1
v_add_f32_dpp v56, v56, v56 row_ror:8 row_mask:0xf bank_mask:0xf
s_nop 1
v_add_f32_dpp v56, v56, v56 row_ror:4 row_mask:0xf bank_mask:0xf
s_nop 1
v_add_f32_dpp v56, v56, v56 row_ror:2 row_mask:0xf bank_mask:0xf
s_nop 1
v_add_f32_dpp v56, v56, v56 row_ror:1 row_mask:0xf bank_mask:0xf
v_mul_f32 v56, 0x3b000000, v56
v_pk_add_f32 v[32:33], v[32:33], v[56:57] op_sel_hi:[1,0] neg_lo:[0,1] neg_hi:[0,1]
v_pk_add_f32 v[34:35], v[34:35], v[56:57] op_sel_hi:[1,0] neg_lo:[0,1] neg_hi:[0,1]
v_pk_add_f32 v[36:37], v[36:37], v[56:57] op_sel_hi:[1,0] neg_lo:[0,1] neg_hi:[0,1]
v_pk_add_f32 v[38:39], v[38:39], v[56:57] op_sel_hi:[1,0] neg_lo:[0,1] neg_hi:[0,1]
v_pk_add_f32 v[40:41], v[40:41], v[56:57] op_sel_hi:[1,0] neg_lo:[0,1] neg_hi:[0,1]
v_pk_add_f32 v[42:43], v[42:43], v[56:57] op_sel_hi:[1,0] neg_lo:[0,1] neg_hi:[0,1]
v_pk_add_f32 v[44:45], v[44:45], v[56:57] op_sel_hi:[1,0] neg_lo:[0,1] neg_hi:[0,1]
v_pk_add_f32 v[46:47], v[46:47], v[56:57] op_sel_hi:[1,0] neg_lo:[0,1] neg_hi:[0,1]
v_pk_mul_f32 v[32:33], v[32:33], v[32:33]
v_pk_mul_f32 v[34:35], v[34:35], v[34:35]
v_pk_mul_f32 v[36:37], v[36:37], v[36:37]
v_pk_mul_f32 v[38:39], v[38:39], v[38:39]
v_pk_mul_f32 v[40:41], v[40:41], v[40:41]
v_pk_mul_f32 v[42:43], v[42:43], v[42:43]
v_pk_mul_f32 v[44:45], v[44:45], v[44:45]
v_pk_mul_f32 v[46:47], v[46:47], v[46:47]
v_pk_add_f32 v[48:49], v[32:33], v[34:35]
v_pk_add_f32 v[50:51], v[36:37], v[38:39]
v_pk_add_f32 v[52:53], v[40:41], v[42:43]
v_pk_add_f32 v[54:55], v[44:45], v[46:47]
v_pk_add_f32 v[48:49], v[48:49], v[50:51]
v_pk_add_f32 v[52:53], v[52:53], v[54:55]
s_nop 0
v_pk_add_f32 v[48:49], v[48:49], v[52:53]
s_nop 0
v_add_f32 v58, v48, v49
v_mov_b32 v59, v58
s_nop 1
v_permlane16_swap_b32 v59, v58
s_nop 1
v_add_f32 v58, v58, v59
s_nop 1
v_add_f32_dpp v58, v58, v58 row_ror:8 row_mask:0xf bank_mask:0xf
s_nop 1
v_add_f32_dpp v58, v58, v58 row_ror:4 row_mask:0xf bank_mask:0xf
s_nop 1
v_add_f32_dpp v58, v58, v58 row_ror:2 row_mask:0xf bank_mask:0xf
s_nop 1
v_add_f32_dpp v58, v58, v58 row_ror:1 row_mask:0xf bank_mask:0xf
v_mov_b32 v59, 0x3727c5ac
v_fmac_f32 v59, 0x3b000000, v58
v_rsq_f32 v61, v59
s_lshl_b32 s73, s26, 7
s_add_u32 s73, s73, s67
s_lshl_b32 s73, s73, 3
s_add_u32 s73, s73, 12091392
v_mul_f32 v60, v56, v61
v_lshrrev_b32 v19, 5, v1
v_lshlrev_b32 v19, 3, v19
s_mov_b32 exec_lo, 1
s_mov_b32 exec_hi, 1
buffer_store_dwordx2 v[60:61], v19, s[44:47], s73 offen sc1
s_mov_b64 exec, -1
v_mov_b32 v92, 0x3f803f80
v_mov_b32 v93, 0x3f803f80
v_mov_b32 v94, 0x3f803f80
v_mov_b32 v95, 0x3f803f80
v_lshlrev_b32 v96, 2, v1
s_lshl_b32 s75, s27, 14
s_lshl_b32 s72, s26, 10
s_add_u32 s75, s75, s72
s_lshl_b32 s72, s31, 8
s_add_u32 s75, s75, s72
s_add_u32 s75, s75, 12124160
s_lshl_b32 s60, s26, 1
s_add_u32 s60, s60, s68
s_mul_i32 s66, s60, 4096
s_lshl_b32 s70, s68, 8
s_add_u32 s70, s70, 147456
s_mov_b32 s62, 0x3fb8aa3b
s_mov_b32 s63, 0x3fb8aa3b
s_mov_b32 s64, 0x358637bd
s_mov_b32 s65, 0x358637bd
s_bitcmp1_b32 s27, 0
s_cselect_b32 s76, 0, s61
s_lshl_b32 s76, s76, 11
v_add_u32 v4, s76, v4
v_add_u32 v5, s76, v5
v_add_u32 v6, s76, v6
v_add_u32 v7, s76, v7
s_and_b32 s72, s27, s61
s_bitcmp1_b32 s72, 0
s_cbranch_scc1 k_p1h2
s_barrier
ds_read_b128 v[16:19], v2 offset:0
ds_read_b64_tr_b16 v[48:49], v4 offset:0
ds_read_b64_tr_b16 v[50:51], v4 offset:1024
ds_read_b128 v[20:23], v2 offset:2048
ds_read_b128 v[24:27], v2 offset:4096
ds_read_b128 v[28:31], v2 offset:6144
ds_read_b64_tr_b16 v[52:53], v5 offset:0
ds_read_b64_tr_b16 v[54:55], v5 offset:1024
ds_read_b64_tr_b16 v[56:57], v6 offset:0
ds_read_b64_tr_b16 v[58:59], v6 offset:1024
s_waitcnt lgkmcnt(4)
v_mfma_f32_16x16x32_bf16 v[108:111], v[48:51], v[16:19], 0
ds_read_b64_tr_b16 v[60:61], v7 offset:0
ds_read_b64_tr_b16 v[62:63], v7 offset:1024
v_mfma_f32_16x16x32_bf16 v[112:115], v[48:51], v[20:23], 0
ds_read_b128 v[32:35], v3 offset:0
ds_read_b128 v[36:39], v3 offset:2048
v_mfma_f32_16x16x32_bf16 v[116:119], v[48:51], v[24:27], 0
ds_read_b128 v[40:43], v3 offset:4096
ds_read_b128 v[44:47], v3 offset:6144
v_mfma_f32_16x16x32_bf16 v[120:123], v[48:51], v[28:31], 0
s_waitcnt lgkmcnt(8)
v_mfma_f32_16x16x32_bf16 v[124:127], v[52:55], v[16:19], 0
ds_read_b64_tr_b16 v[64:65], v4 offset:8192
v_mfma_f32_16x16x32_bf16 v[128:131], v[52:55], v[20:23], 0
ds_read_b64_tr_b16 v[66:67], v4 offset:9216
v_mfma_f32_16x16x32_bf16 v[132:135], v[52:55], v[24:27], 0
v_mfma_f32_16x16x32_bf16 v[136:139], v[52:55], v[28:31], 0
s_waitcnt lgkmcnt(8)
v_mfma_f32_16x16x32_bf16 v[140:143], v[56:59], v[16:19], 0
ds_read_b64_tr_b16 v[68:69], v5 offset:8192
v_mfma_f32_16x16x32_bf16 v[144:147], v[56:59], v[20:23], 0
ds_read_b64_tr_b16 v[70:71], v5 offset:9216
v_mfma_f32_16x16x32_bf16 v[148:151], v[56:59], v[24:27], 0
v_mfma_f32_16x16x32_bf16 v[152:155], v[56:59], v[28:31], 0
s_waitcnt lgkmcnt(8)
v_mfma_f32_16x16x32_bf16 v[156:159], v[60:63], v[16:19], 0
ds_read_b64_tr_b16 v[72:73], v6 offset:8192
v_mfma_f32_16x16x32_bf16 v[160:163], v[60:63], v[20:23], 0
ds_read_b64_tr_b16 v[74:75], v6 offset:9216
v_mfma_f32_16x16x32_bf16 v[164:167], v[60:63], v[24:27], 0
v_mfma_f32_16x16x32_bf16 v[168:171], v[60:63], v[28:31], 0
s_waitcnt lgkmcnt(4)
v_mfma_f32_16x16x32_bf16 v[108:111], v[64:67], v[32:35], v[108:111]
ds_read_b64_tr_b16 v[76:77], v7 offset:8192
v_mfma_f32_16x16x32_bf16 v[112:115], v[64:67], v[36:39], v[112:115]
ds_read_b64_tr_b16 v[78:79], v7 offset:9216
v_mfma_f32_16x16x32_bf16 v[116:119], v[64:67], v[40:43], v[116:119]
v_mfma_f32_16x16x32_bf16 v[120:123], v[64:67], v[44:47], v[120:123]
s_waitcnt lgkmcnt(4)
v_mfma_f32_16x16x32_bf16 v[124:127], v[68:71], v[32:35], v[124:127]
v_mfma_f32_16x16x32_bf16 v[128:131], v[68:71], v[36:39], v[128:131]
v_mfma_f32_16x16x32_bf16 v[132:135], v[68:71], v[40:43], v[132:135]
v_mfma_f32_16x16x32_bf16 v[136:139], v[68:71], v[44:47], v[136:139]
s_waitcnt lgkmcnt(0)
s_barrier
v_mfma_f32_16x16x32_bf16 v[140:143], v[72:75], v[32:35], v[140:143]
ds_read_b128 v[16:19], v2 offset:16384
ds_read_b64_tr_b16 v[48:49], v4 offset:16384
v_mfma_f32_16x16x32_bf16 v[144:147], v[72:75], v[36:39], v[144:147]
ds_read_b64_tr_b16 v[50:51], v4 offset:17408
ds_read_b128 v[20:23], v2 offset:18432
v_mfma_f32_16x16x32_bf16 v[148:151], v[72:75], v[40:43], v[148:151]
ds_read_b128 v[24:27], v2 offset:20480
v_mfma_f32_16x16x32_bf16 v[152:155], v[72:75], v[44:47], v[152:155]
v_mfma_f32_16x16x32_bf16 v[156:159], v[76:79], v[32:35], v[156:159]
ds_read_b128 v[28:31], v2 offset:22528
ds_read_b64_tr_b16 v[52:53], v5 offset:16384
v_mfma_f32_16x16x32_bf16 v[160:163], v[76:79], v[36:39], v[160:163]
ds_read_b64_tr_b16 v[54:55], v5 offset:17408
ds_read_b64_tr_b16 v[56:57], v6 offset:16384
v_mfma_f32_16x16x32_bf16 v[164:167], v[76:79], v[40:43], v[164:167]
ds_read_b64_tr_b16 v[58:59], v6 offset:17408
v_mfma_f32_16x16x32_bf16 v[168:171], v[76:79], v[44:47], v[168:171]
v_lshrrev_b32 v97, 5, v1
v_lshlrev_b32 v97, 12, v97
s_lshl_b32 s72, s31, 11
s_add_u32 s72, s72, 131072
v_add_u32 v97, s72, v97
v_add_u32 v104, v97, v4
v_add_u32 v105, v97, v5
v_add_u32 v106, v97, v6
v_add_u32 v107, v97, v7
v_subrev_u32 v104, s76, v104
v_subrev_u32 v105, s76, v105
v_subrev_u32 v106, s76, v106
v_subrev_u32 v107, s76, v107
ds_read_b64_tr_b16 v[172:173], v104 offset:0
ds_read_b64_tr_b16 v[174:175], v104 offset:1024
ds_read_b64_tr_b16 v[176:177], v105 offset:0
ds_read_b64_tr_b16 v[178:179], v105 offset:1024
ds_read_b64_tr_b16 v[180:181], v106 offset:0
ds_read_b64_tr_b16 v[182:183], v106 offset:1024
ds_read_b64_tr_b16 v[184:185], v107 offset:0
ds_read_b64_tr_b16 v[186:187], v107 offset:1024
s_waitcnt lgkmcnt(0)
v_mfma_f32_16x16x32_bf16 v[188:191], v[92:95], v[172:175], 0
v_mfma_f32_16x16x32_bf16 v[192:195], v[92:95], v[176:179], 0
v_mfma_f32_16x16x32_bf16 v[196:199], v[92:95], v[180:183], 0
v_mfma_f32_16x16x32_bf16 v[200:203], v[92:95], v[184:187], 0
s_nop 7
s_nop 1
v_mov_b32_dpp v188, v192 quad_perm:[0,1,2,3] row_mask:0x2 bank_mask:0xf
s_nop 1
v_mov_b32_dpp v188, v196 quad_perm:[0,1,2,3] row_mask:0x4 bank_mask:0xf
s_nop 1
v_mov_b32_dpp v188, v200 quad_perm:[0,1,2,3] row_mask:0x8 bank_mask:0xf
buffer_store_dword v188, v96, s[44:47], s75 offen sc1
v_mfma_f32_16x16x32_bf16 v[108:111], v[48:51], v[16:19], v[108:111]
ds_read_b64_tr_b16 v[60:61], v7 offset:16384
ds_read_b64_tr_b16 v[62:63], v7 offset:17408
v_mfma_f32_16x16x32_bf16 v[112:115], v[48:51], v[20:23], v[112:115]
ds_read_b128 v[32:35], v3 offset:16384
ds_read_b128 v[36:39], v3 offset:18432
v_mfma_f32_16x16x32_bf16 v[116:119], v[48:51], v[24:27], v[116:119]
ds_read_b128 v[40:43], v3 offset:20480
ds_read_b128 v[44:47], v3 offset:22528
v_mfma_f32_16x16x32_bf16 v[120:123], v[48:51], v[28:31], v[120:123]
v_mfma_f32_16x16x32_bf16 v[124:127], v[52:55], v[16:19], v[124:127]
ds_read_b64_tr_b16 v[64:65], v4 offset:24576
v_mfma_f32_16x16x32_bf16 v[128:131], v[52:55], v[20:23], v[128:131]
ds_read_b64_tr_b16 v[66:67], v4 offset:25600
v_mfma_f32_16x16x32_bf16 v[132:135], v[52:55], v[24:27], v[132:135]
v_mfma_f32_16x16x32_bf16 v[136:139], v[52:55], v[28:31], v[136:139]
v_mfma_f32_16x16x32_bf16 v[140:143], v[56:59], v[16:19], v[140:143]
ds_read_b64_tr_b16 v[68:69], v5 offset:24576
v_mfma_f32_16x16x32_bf16 v[144:147], v[56:59], v[20:23], v[144:147]
ds_read_b64_tr_b16 v[70:71], v5 offset:25600
v_mfma_f32_16x16x32_bf16 v[148:151], v[56:59], v[24:27], v[148:151]
v_mfma_f32_16x16x32_bf16 v[152:155], v[56:59], v[28:31], v[152:155]
s_waitcnt lgkmcnt(8)
v_mfma_f32_16x16x32_bf16 v[156:159], v[60:63], v[16:19], v[156:159]
ds_read_b64_tr_b16 v[72:73], v6 offset:24576
v_mfma_f32_16x16x32_bf16 v[160:163], v[60:63], v[20:23], v[160:163]
ds_read_b64_tr_b16 v[74:75], v6 offset:25600
v_mfma_f32_16x16x32_bf16 v[164:167], v[60:63], v[24:27], v[164:167]
v_mfma_f32_16x16x32_bf16 v[168:171], v[60:63], v[28:31], v[168:171]
s_waitcnt lgkmcnt(4)
v_mfma_f32_16x16x32_bf16 v[108:111], v[64:67], v[32:35], v[108:111]
ds_read_b64_tr_b16 v[76:77], v7 offset:24576
v_mfma_f32_16x16x32_bf16 v[112:115], v[64:67], v[36:39], v[112:115]
ds_read_b64_tr_b16 v[78:79], v7 offset:25600
v_mfma_f32_16x16x32_bf16 v[116:119], v[64:67], v[40:43], v[116:119]
v_mfma_f32_16x16x32_bf16 v[120:123], v[64:67], v[44:47], v[120:123]
s_waitcnt lgkmcnt(4)
v_mfma_f32_16x16x32_bf16 v[124:127], v[68:71], v[32:35], v[124:127]
v_mfma_f32_16x16x32_bf16 v[128:131], v[68:71], v[36:39], v[128:131]
v_mfma_f32_16x16x32_bf16 v[132:135], v[68:71], v[40:43], v[132:135]
v_mfma_f32_16x16x32_bf16 v[136:139], v[68:71], v[44:47], v[136:139]
s_waitcnt lgkmcnt(0)
s_barrier
v_mfma_f32_16x16x32_bf16 v[140:143], v[72:75], v[32:35], v[140:143]
ds_read_b128 v[16:19], v2 offset:32768
ds_read_b64_tr_b16 v[48:49], v4 offset:32768
v_mfma_f32_16x16x32_bf16 v[144:147], v[72:75], v[36:39], v[144:147]
ds_read_b64_tr_b16 v[50:51], v4 offset:33792
ds_read_b128 v[20:23], v2 offset:34816
v_mfma_f32_16x16x32_bf16 v[148:151], v[72:75], v[40:43], v[148:151]
ds_read_b128 v[24:27], v2 offset:36864
v_mfma_f32_16x16x32_bf16 v[152:155], v[72:75], v[44:47], v[152:155]
v_mfma_f32_16x16x32_bf16 v[156:159], v[76:79], v[32:35], v[156:159]
ds_read_b128 v[28:31], v2 offset:38912
ds_read_b64_tr_b16 v[52:53], v5 offset:32768
v_mfma_f32_16x16x32_bf16 v[160:163], v[76:79], v[36:39], v[160:163]
ds_read_b64_tr_b16 v[54:55], v5 offset:33792
ds_read_b64_tr_b16 v[56:57], v6 offset:32768
v_mfma_f32_16x16x32_bf16 v[164:167], v[76:79], v[40:43], v[164:167]
ds_read_b64_tr_b16 v[58:59], v6 offset:33792
v_mfma_f32_16x16x32_bf16 v[168:171], v[76:79], v[44:47], v[168:171]
s_waitcnt lgkmcnt(4)
v_mfma_f32_16x16x32_bf16 v[108:111], v[48:51], v[16:19], v[108:111]
ds_read_b64_tr_b16 v[60:61], v7 offset:32768
ds_read_b64_tr_b16 v[62:63], v7 offset:33792
v_mfma_f32_16x16x32_bf16 v[112:115], v[48:51], v[20:23], v[112:115]
ds_read_b128 v[32:35], v3 offset:32768
ds_read_b128 v[36:39], v3 offset:34816
v_mfma_f32_16x16x32_bf16 v[116:119], v[48:51], v[24:27], v[116:119]
ds_read_b128 v[40:43], v3 offset:36864
ds_read_b128 v[44:47], v3 offset:38912
v_mfma_f32_16x16x32_bf16 v[120:123], v[48:51], v[28:31], v[120:123]
s_waitcnt lgkmcnt(8)
v_mfma_f32_16x16x32_bf16 v[124:127], v[52:55], v[16:19], v[124:127]
ds_read_b64_tr_b16 v[64:65], v4 offset:40960
v_mfma_f32_16x16x32_bf16 v[128:131], v[52:55], v[20:23], v[128:131]
ds_read_b64_tr_b16 v[66:67], v4 offset:41984
v_mfma_f32_16x16x32_bf16 v[132:135], v[52:55], v[24:27], v[132:135]
v_mfma_f32_16x16x32_bf16 v[136:139], v[52:55], v[28:31], v[136:139]
s_waitcnt lgkmcnt(8)
v_mfma_f32_16x16x32_bf16 v[140:143], v[56:59], v[16:19], v[140:143]
ds_read_b64_tr_b16 v[68:69], v5 offset:40960
v_mfma_f32_16x16x32_bf16 v[144:147], v[56:59], v[20:23], v[144:147]
ds_read_b64_tr_b16 v[70:71], v5 offset:41984
v_mfma_f32_16x16x32_bf16 v[148:151], v[56:59], v[24:27], v[148:151]
v_mfma_f32_16x16x32_bf16 v[152:155], v[56:59], v[28:31], v[152:155]
s_waitcnt lgkmcnt(8)
v_mfma_f32_16x16x32_bf16 v[156:159], v[60:63], v[16:19], v[156:159]
ds_read_b64_tr_b16 v[72:73], v6 offset:40960
v_mfma_f32_16x16x32_bf16 v[160:163], v[60:63], v[20:23], v[160:163]
ds_read_b64_tr_b16 v[74:75], v6 offset:41984
v_mfma_f32_16x16x32_bf16 v[164:167], v[60:63], v[24:27], v[164:167]
v_mfma_f32_16x16x32_bf16 v[168:171], v[60:63], v[28:31], v[168:171]
s_waitcnt lgkmcnt(4)
v_mfma_f32_16x16x32_bf16 v[108:111], v[64:67], v[32:35], v[108:111]
ds_read_b64_tr_b16 v[76:77], v7 offset:40960
v_mfma_f32_16x16x32_bf16 v[112:115], v[64:67], v[36:39], v[112:115]
ds_read_b64_tr_b16 v[78:79], v7 offset:41984
v_mfma_f32_16x16x32_bf16 v[116:119], v[64:67], v[40:43], v[116:119]
v_mfma_f32_16x16x32_bf16 v[120:123], v[64:67], v[44:47], v[120:123]
s_waitcnt lgkmcnt(4)
v_mfma_f32_16x16x32_bf16 v[124:127], v[68:71], v[32:35], v[124:127]
v_mfma_f32_16x16x32_bf16 v[128:131], v[68:71], v[36:39], v[128:131]
v_mfma_f32_16x16x32_bf16 v[132:135], v[68:71], v[40:43], v[132:135]
v_mfma_f32_16x16x32_bf16 v[136:139], v[68:71], v[44:47], v[136:139]
s_waitcnt lgkmcnt(0)
s_barrier
v_mfma_f32_16x16x32_bf16 v[140:143], v[72:75], v[32:35], v[140:143]
ds_read_b128 v[16:19], v88 offset:0
ds_read_b64_tr_b16 v[48:49], v4 offset:0
v_mfma_f32_16x16x32_bf16 v[144:147], v[72:75], v[36:39], v[144:147]
ds_read_b64_tr_b16 v[50:51], v4 offset:1024
ds_read_b128 v[20:23], v88 offset:2048
v_mfma_f32_16x16x32_bf16 v[148:151], v[72:75], v[40:43], v[148:151]
ds_read_b128 v[24:27], v88 offset:4096
v_mfma_f32_16x16x32_bf16 v[152:155], v[72:75], v[44:47], v[152:155]
v_mfma_f32_16x16x32_bf16 v[156:159], v[76:79], v[32:35], v[156:159]
ds_read_b128 v[28:31], v88 offset:6144
ds_read_b64_tr_b16 v[52:53], v5 offset:0
v_mfma_f32_16x16x32_bf16 v[160:163], v[76:79], v[36:39], v[160:163]
ds_read_b64_tr_b16 v[54:55], v5 offset:1024
ds_read_b64_tr_b16 v[56:57], v6 offset:0
v_mfma_f32_16x16x32_bf16 v[164:167], v[76:79], v[40:43], v[164:167]
ds_read_b64_tr_b16 v[58:59], v6 offset:1024
v_mfma_f32_16x16x32_bf16 v[168:171], v[76:79], v[44:47], v[168:171]
s_waitcnt vmcnt(0)
s_waitcnt lgkmcnt(4)
v_mfma_f32_16x16x32_bf16 v[108:111], v[48:51], v[16:19], v[108:111]
ds_read_b64_tr_b16 v[60:61], v7 offset:0
ds_read_b64_tr_b16 v[62:63], v7 offset:1024
v_mfma_f32_16x16x32_bf16 v[112:115], v[48:51], v[20:23], v[112:115]
ds_read_b128 v[32:35], v89 offset:0
ds_read_b128 v[36:39], v89 offset:2048
v_mfma_f32_16x16x32_bf16 v[116:119], v[48:51], v[24:27], v[116:119]
ds_read_b128 v[40:43], v89 offset:4096
ds_read_b128 v[44:47], v89 offset:6144
v_mfma_f32_16x16x32_bf16 v[120:123], v[48:51], v[28:31], v[120:123]
s_waitcnt lgkmcnt(8)
v_mfma_f32_16x16x32_bf16 v[124:127], v[52:55], v[16:19], v[124:127]
ds_read_b64_tr_b16 v[64:65], v4 offset:8192
v_mfma_f32_16x16x32_bf16 v[128:131], v[52:55], v[20:23], v[128:131]
ds_read_b64_tr_b16 v[66:67], v4 offset:9216
v_mfma_f32_16x16x32_bf16 v[132:135], v[52:55], v[24:27], v[132:135]
v_mfma_f32_16x16x32_bf16 v[136:139], v[52:55], v[28:31], v[136:139]
s_waitcnt lgkmcnt(8)
v_mfma_f32_16x16x32_bf16 v[140:143], v[56:59], v[16:19], v[140:143]
ds_read_b64_tr_b16 v[68:69], v5 offset:8192
v_mfma_f32_16x16x32_bf16 v[144:147], v[56:59], v[20:23], v[144:147]
ds_read_b64_tr_b16 v[70:71], v5 offset:9216
v_mfma_f32_16x16x32_bf16 v[148:151], v[56:59], v[24:27], v[148:151]
v_mfma_f32_16x16x32_bf16 v[152:155], v[56:59], v[28:31], v[152:155]
s_waitcnt lgkmcnt(8)
v_mfma_f32_16x16x32_bf16 v[156:159], v[60:63], v[16:19], v[156:159]
ds_read_b64_tr_b16 v[72:73], v6 offset:8192
v_mfma_f32_16x16x32_bf16 v[160:163], v[60:63], v[20:23], v[160:163]
ds_read_b64_tr_b16 v[74:75], v6 offset:9216
v_mfma_f32_16x16x32_bf16 v[164:167], v[60:63], v[24:27], v[164:167]
v_mfma_f32_16x16x32_bf16 v[168:171], v[60:63], v[28:31], v[168:171]
s_waitcnt lgkmcnt(4)
v_mfma_f32_16x16x32_bf16 v[108:111], v[64:67], v[32:35], v[108:111]
ds_read_b64_tr_b16 v[76:77], v7 offset:8192
v_mfma_f32_16x16x32_bf16 v[112:115], v[64:67], v[36:39], v[112:115]
ds_read_b64_tr_b16 v[78:79], v7 offset:9216
v_mfma_f32_16x16x32_bf16 v[116:119], v[64:67], v[40:43], v[116:119]
v_mfma_f32_16x16x32_bf16 v[120:123], v[64:67], v[44:47], v[120:123]
s_waitcnt lgkmcnt(4)
v_mfma_f32_16x16x32_bf16 v[124:127], v[68:71], v[32:35], v[124:127]
v_mfma_f32_16x16x32_bf16 v[128:131], v[68:71], v[36:39], v[128:131]
v_mfma_f32_16x16x32_bf16 v[132:135], v[68:71], v[40:43], v[132:135]
v_mfma_f32_16x16x32_bf16 v[136:139], v[68:71], v[44:47], v[136:139]
s_waitcnt lgkmcnt(0)
s_barrier
v_mfma_f32_16x16x32_bf16 v[140:143], v[72:75], v[32:35], v[140:143]
ds_read_b128 v[16:19], v88 offset:16384
ds_read_b64_tr_b16 v[48:49], v4 offset:16384
v_mfma_f32_16x16x32_bf16 v[144:147], v[72:75], v[36:39], v[144:147]
ds_read_b64_tr_b16 v[50:51], v4 offset:17408
ds_read_b128 v[20:23], v88 offset:18432
v_mfma_f32_16x16x32_bf16 v[148:151], v[72:75], v[40:43], v[148:151]
ds_read_b128 v[24:27], v88 offset:20480
v_mfma_f32_16x16x32_bf16 v[152:155], v[72:75], v[44:47], v[152:155]
v_mfma_f32_16x16x32_bf16 v[156:159], v[76:79], v[32:35], v[156:159]
ds_read_b128 v[28:31], v88 offset:22528
ds_read_b64_tr_b16 v[52:53], v5 offset:16384
v_mfma_f32_16x16x32_bf16 v[160:163], v[76:79], v[36:39], v[160:163]
ds_read_b64_tr_b16 v[54:55], v5 offset:17408
ds_read_b64_tr_b16 v[56:57], v6 offset:16384
v_mfma_f32_16x16x32_bf16 v[164:167], v[76:79], v[40:43], v[164:167]
ds_read_b64_tr_b16 v[58:59], v6 offset:17408
v_mfma_f32_16x16x32_bf16 v[168:171], v[76:79], v[44:47], v[168:171]
s_waitcnt lgkmcnt(4)
v_mfma_f32_16x16x32_bf16 v[108:111], v[48:51], v[16:19], v[108:111]
ds_read_b64_tr_b16 v[60:61], v7 offset:16384
ds_read_b64_tr_b16 v[62:63], v7 offset:17408
v_mfma_f32_16x16x32_bf16 v[112:115], v[48:51], v[20:23], v[112:115]
ds_read_b128 v[32:35], v89 offset:16384
ds_read_b128 v[36:39], v89 offset:18432
v_mfma_f32_16x16x32_bf16 v[116:119], v[48:51], v[24:27], v[116:119]
ds_read_b128 v[40:43], v89 offset:20480
ds_read_b128 v[44:47], v89 offset:22528
v_mfma_f32_16x16x32_bf16 v[120:123], v[48:51], v[28:31], v[120:123]
s_waitcnt lgkmcnt(8)
v_mfma_f32_16x16x32_bf16 v[124:127], v[52:55], v[16:19], v[124:127]
ds_read_b64_tr_b16 v[64:65], v4 offset:24576
v_mfma_f32_16x16x32_bf16 v[128:131], v[52:55], v[20:23], v[128:131]
ds_read_b64_tr_b16 v[66:67], v4 offset:25600
v_mfma_f32_16x16x32_bf16 v[132:135], v[52:55], v[24:27], v[132:135]
v_mfma_f32_16x16x32_bf16 v[136:139], v[52:55], v[28:31], v[136:139]
s_waitcnt lgkmcnt(8)
v_mfma_f32_16x16x32_bf16 v[140:143], v[56:59], v[16:19], v[140:143]
ds_read_b64_tr_b16 v[68:69], v5 offset:24576
v_mfma_f32_16x16x32_bf16 v[144:147], v[56:59], v[20:23], v[144:147]
ds_read_b64_tr_b16 v[70:71], v5 offset:25600
v_mfma_f32_16x16x32_bf16 v[148:151], v[56:59], v[24:27], v[148:151]
v_mfma_f32_16x16x32_bf16 v[152:155], v[56:59], v[28:31], v[152:155]
s_waitcnt lgkmcnt(8)
v_mfma_f32_16x16x32_bf16 v[156:159], v[60:63], v[16:19], v[156:159]
ds_read_b64_tr_b16 v[72:73], v6 offset:24576
v_mfma_f32_16x16x32_bf16 v[160:163], v[60:63], v[20:23], v[160:163]
ds_read_b64_tr_b16 v[74:75], v6 offset:25600
v_mfma_f32_16x16x32_bf16 v[164:167], v[60:63], v[24:27], v[164:167]
v_mfma_f32_16x16x32_bf16 v[168:171], v[60:63], v[28:31], v[168:171]
s_waitcnt lgkmcnt(4)
v_mfma_f32_16x16x32_bf16 v[108:111], v[64:67], v[32:35], v[108:111]
ds_read_b64_tr_b16 v[76:77], v7 offset:24576
v_mfma_f32_16x16x32_bf16 v[112:115], v[64:67], v[36:39], v[112:115]
ds_read_b64_tr_b16 v[78:79], v7 offset:25600
v_mfma_f32_16x16x32_bf16 v[116:119], v[64:67], v[40:43], v[116:119]
v_mfma_f32_16x16x32_bf16 v[120:123], v[64:67], v[44:47], v[120:123]
s_waitcnt lgkmcnt(4)
v_mfma_f32_16x16x32_bf16 v[124:127], v[68:71], v[32:35], v[124:127]
v_mfma_f32_16x16x32_bf16 v[128:131], v[68:71], v[36:39], v[128:131]
v_mfma_f32_16x16x32_bf16 v[132:135], v[68:71], v[40:43], v[132:135]
v_mfma_f32_16x16x32_bf16 v[136:139], v[68:71], v[44:47], v[136:139]
s_waitcnt lgkmcnt(0)
s_barrier
v_mfma_f32_16x16x32_bf16 v[140:143], v[72:75], v[32:35], v[140:143]
ds_read_b128 v[16:19], v88 offset:32768
ds_read_b64_tr_b16 v[48:49], v4 offset:32768
v_mfma_f32_16x16x32_bf16 v[144:147], v[72:75], v[36:39], v[144:147]
ds_read_b64_tr_b16 v[50:51], v4 offset:33792
ds_read_b128 v[20:23], v88 offset:34816
v_mfma_f32_16x16x32_bf16 v[148:151], v[72:75], v[40:43], v[148:151]
ds_read_b128 v[24:27], v88 offset:36864
v_mfma_f32_16x16x32_bf16 v[152:155], v[72:75], v[44:47], v[152:155]
v_mfma_f32_16x16x32_bf16 v[156:159], v[76:79], v[32:35], v[156:159]
ds_read_b128 v[28:31], v88 offset:38912
ds_read_b64_tr_b16 v[52:53], v5 offset:32768
v_mfma_f32_16x16x32_bf16 v[160:163], v[76:79], v[36:39], v[160:163]
ds_read_b64_tr_b16 v[54:55], v5 offset:33792
ds_read_b64_tr_b16 v[56:57], v6 offset:32768
v_mfma_f32_16x16x32_bf16 v[164:167], v[76:79], v[40:43], v[164:167]
ds_read_b64_tr_b16 v[58:59], v6 offset:33792
v_mfma_f32_16x16x32_bf16 v[168:171], v[76:79], v[44:47], v[168:171]
s_waitcnt lgkmcnt(4)
v_mfma_f32_16x16x32_bf16 v[108:111], v[48:51], v[16:19], v[108:111]
ds_read_b64_tr_b16 v[60:61], v7 offset:32768
ds_read_b64_tr_b16 v[62:63], v7 offset:33792
v_mfma_f32_16x16x32_bf16 v[112:115], v[48:51], v[20:23], v[112:115]
ds_read_b128 v[32:35], v89 offset:32768
ds_read_b128 v[36:39], v89 offset:34816
v_mfma_f32_16x16x32_bf16 v[116:119], v[48:51], v[24:27], v[116:119]
ds_read_b128 v[40:43], v89 offset:36864
ds_read_b128 v[44:47], v89 offset:38912
v_mfma_f32_16x16x32_bf16 v[120:123], v[48:51], v[28:31], v[120:123]
s_waitcnt lgkmcnt(8)
v_mfma_f32_16x16x32_bf16 v[124:127], v[52:55], v[16:19], v[124:127]
ds_read_b64_tr_b16 v[64:65], v4 offset:40960
v_mfma_f32_16x16x32_bf16 v[128:131], v[52:55], v[20:23], v[128:131]
ds_read_b64_tr_b16 v[66:67], v4 offset:41984
v_mfma_f32_16x16x32_bf16 v[132:135], v[52:55], v[24:27], v[132:135]
v_mfma_f32_16x16x32_bf16 v[136:139], v[52:55], v[28:31], v[136:139]
s_waitcnt lgkmcnt(8)
v_mfma_f32_16x16x32_bf16 v[140:143], v[56:59], v[16:19], v[140:143]
ds_read_b64_tr_b16 v[68:69], v5 offset:40960
v_mfma_f32_16x16x32_bf16 v[144:147], v[56:59], v[20:23], v[144:147]
ds_read_b64_tr_b16 v[70:71], v5 offset:41984
v_mfma_f32_16x16x32_bf16 v[148:151], v[56:59], v[24:27], v[148:151]
v_mfma_f32_16x16x32_bf16 v[152:155], v[56:59], v[28:31], v[152:155]
s_waitcnt lgkmcnt(8)
v_mfma_f32_16x16x32_bf16 v[156:159], v[60:63], v[16:19], v[156:159]
ds_read_b64_tr_b16 v[72:73], v6 offset:40960
v_mfma_f32_16x16x32_bf16 v[160:163], v[60:63], v[20:23], v[160:163]
ds_read_b64_tr_b16 v[74:75], v6 offset:41984
v_mfma_f32_16x16x32_bf16 v[164:167], v[60:63], v[24:27], v[164:167]
v_mfma_f32_16x16x32_bf16 v[168:171], v[60:63], v[28:31], v[168:171]
s_waitcnt lgkmcnt(4)
v_mfma_f32_16x16x32_bf16 v[108:111], v[64:67], v[32:35], v[108:111]
ds_read_b64_tr_b16 v[76:77], v7 offset:40960
v_mfma_f32_16x16x32_bf16 v[112:115], v[64:67], v[36:39], v[112:115]
ds_read_b64_tr_b16 v[78:79], v7 offset:41984
v_mfma_f32_16x16x32_bf16 v[116:119], v[64:67], v[40:43], v[116:119]
v_mfma_f32_16x16x32_bf16 v[120:123], v[64:67], v[44:47], v[120:123]
s_waitcnt lgkmcnt(4)
v_mfma_f32_16x16x32_bf16 v[124:127], v[68:71], v[32:35], v[124:127]
v_mfma_f32_16x16x32_bf16 v[128:131], v[68:71], v[36:39], v[128:131]
v_mfma_f32_16x16x32_bf16 v[132:135], v[68:71], v[40:43], v[132:135]
v_mfma_f32_16x16x32_bf16 v[136:139], v[68:71], v[44:47], v[136:139]
s_waitcnt lgkmcnt(0)
s_barrier
v_mfma_f32_16x16x32_bf16 v[140:143], v[72:75], v[32:35], v[140:143]
ds_read_b128 v[16:19], v2 offset:0
ds_read_b64_tr_b16 v[48:49], v4 offset:0
v_mfma_f32_16x16x32_bf16 v[144:147], v[72:75], v[36:39], v[144:147]
ds_read_b64_tr_b16 v[50:51], v4 offset:1024
ds_read_b128 v[20:23], v2 offset:2048
v_mfma_f32_16x16x32_bf16 v[148:151], v[72:75], v[40:43], v[148:151]
ds_read_b128 v[24:27], v2 offset:4096
v_mfma_f32_16x16x32_bf16 v[152:155], v[72:75], v[44:47], v[152:155]
v_mfma_f32_16x16x32_bf16 v[156:159], v[76:79], v[32:35], v[156:159]
ds_read_b128 v[28:31], v2 offset:6144
ds_read_b64_tr_b16 v[52:53], v5 offset:0
v_mfma_f32_16x16x32_bf16 v[160:163], v[76:79], v[36:39], v[160:163]
ds_read_b64_tr_b16 v[54:55], v5 offset:1024
ds_read_b64_tr_b16 v[56:57], v6 offset:0
v_mfma_f32_16x16x32_bf16 v[164:167], v[76:79], v[40:43], v[164:167]
ds_read_b64_tr_b16 v[58:59], v6 offset:1024
v_mfma_f32_16x16x32_bf16 v[168:171], v[76:79], v[44:47], v[168:171]
s_waitcnt lgkmcnt(4)
v_mfma_f32_16x16x32_bf16 v[108:111], v[48:51], v[16:19], v[108:111]
ds_read_b64_tr_b16 v[60:61], v7 offset:0
ds_read_b64_tr_b16 v[62:63], v7 offset:1024
v_mfma_f32_16x16x32_bf16 v[112:115], v[48:51], v[20:23], v[112:115]
ds_read_b128 v[32:35], v3 offset:0
ds_read_b128 v[36:39], v3 offset:2048
v_mfma_f32_16x16x32_bf16 v[116:119], v[48:51], v[24:27], v[116:119]
ds_read_b128 v[40:43], v3 offset:4096
ds_read_b128 v[44:47], v3 offset:6144
v_mfma_f32_16x16x32_bf16 v[120:123], v[48:51], v[28:31], v[120:123]
s_waitcnt lgkmcnt(8)
v_mfma_f32_16x16x32_bf16 v[124:127], v[52:55], v[16:19], v[124:127]
ds_read_b64_tr_b16 v[64:65], v4 offset:8192
v_mfma_f32_16x16x32_bf16 v[128:131], v[52:55], v[20:23], v[128:131]
ds_read_b64_tr_b16 v[66:67], v4 offset:9216
v_mfma_f32_16x16x32_bf16 v[132:135], v[52:55], v[24:27], v[132:135]
v_mfma_f32_16x16x32_bf16 v[136:139], v[52:55], v[28:31], v[136:139]
s_waitcnt lgkmcnt(8)
v_mfma_f32_16x16x32_bf16 v[140:143], v[56:59], v[16:19], v[140:143]
ds_read_b64_tr_b16 v[68:69], v5 offset:8192
v_mfma_f32_16x16x32_bf16 v[144:147], v[56:59], v[20:23], v[144:147]
ds_read_b64_tr_b16 v[70:71], v5 offset:9216
v_mfma_f32_16x16x32_bf16 v[148:151], v[56:59], v[24:27], v[148:151]
v_mfma_f32_16x16x32_bf16 v[152:155], v[56:59], v[28:31], v[152:155]
s_waitcnt lgkmcnt(8)
v_mfma_f32_16x16x32_bf16 v[156:159], v[60:63], v[16:19], v[156:159]
ds_read_b64_tr_b16 v[72:73], v6 offset:8192
v_mfma_f32_16x16x32_bf16 v[160:163], v[60:63], v[20:23], v[160:163]
ds_read_b64_tr_b16 v[74:75], v6 offset:9216
v_mfma_f32_16x16x32_bf16 v[164:167], v[60:63], v[24:27], v[164:167]
v_mfma_f32_16x16x32_bf16 v[168:171], v[60:63], v[28:31], v[168:171]
s_waitcnt lgkmcnt(4)
v_mfma_f32_16x16x32_bf16 v[108:111], v[64:67], v[32:35], v[108:111]
ds_read_b64_tr_b16 v[76:77], v7 offset:8192
v_mfma_f32_16x16x32_bf16 v[112:115], v[64:67], v[36:39], v[112:115]
ds_read_b64_tr_b16 v[78:79], v7 offset:9216
v_mfma_f32_16x16x32_bf16 v[116:119], v[64:67], v[40:43], v[116:119]
v_mfma_f32_16x16x32_bf16 v[120:123], v[64:67], v[44:47], v[120:123]
s_waitcnt lgkmcnt(4)
v_mfma_f32_16x16x32_bf16 v[124:127], v[68:71], v[32:35], v[124:127]
v_mfma_f32_16x16x32_bf16 v[128:131], v[68:71], v[36:39], v[128:131]
v_mfma_f32_16x16x32_bf16 v[132:135], v[68:71], v[40:43], v[132:135]
v_mfma_f32_16x16x32_bf16 v[136:139], v[68:71], v[44:47], v[136:139]
s_waitcnt lgkmcnt(0)
s_barrier
v_mfma_f32_16x16x32_bf16 v[140:143], v[72:75], v[32:35], v[140:143]
ds_read_b128 v[16:19], v2 offset:16384
ds_read_b64_tr_b16 v[48:49], v4 offset:16384
v_mfma_f32_16x16x32_bf16 v[144:147], v[72:75], v[36:39], v[144:147]
ds_read_b64_tr_b16 v[50:51], v4 offset:17408
ds_read_b128 v[20:23], v2 offset:18432
v_mfma_f32_16x16x32_bf16 v[148:151], v[72:75], v[40:43], v[148:151]
ds_read_b128 v[24:27], v2 offset:20480
v_mfma_f32_16x16x32_bf16 v[152:155], v[72:75], v[44:47], v[152:155]
v_mfma_f32_16x16x32_bf16 v[156:159], v[76:79], v[32:35], v[156:159]
ds_read_b128 v[28:31], v2 offset:22528
ds_read_b64_tr_b16 v[52:53], v5 offset:16384
v_mfma_f32_16x16x32_bf16 v[160:163], v[76:79], v[36:39], v[160:163]
ds_read_b64_tr_b16 v[54:55], v5 offset:17408
ds_read_b64_tr_b16 v[56:57], v6 offset:16384
v_mfma_f32_16x16x32_bf16 v[164:167], v[76:79], v[40:43], v[164:167]
ds_read_b64_tr_b16 v[58:59], v6 offset:17408
v_mfma_f32_16x16x32_bf16 v[168:171], v[76:79], v[44:47], v[168:171]
s_waitcnt lgkmcnt(4)
v_mfma_f32_16x16x32_bf16 v[108:111], v[48:51], v[16:19], v[108:111]
ds_read_b64_tr_b16 v[60:61], v7 offset:16384
ds_read_b64_tr_b16 v[62:63], v7 offset:17408
v_mfma_f32_16x16x32_bf16 v[112:115], v[48:51], v[20:23], v[112:115]
ds_read_b128 v[32:35], v3 offset:16384
ds_read_b128 v[36:39], v3 offset:18432
v_mfma_f32_16x16x32_bf16 v[116:119], v[48:51], v[24:27], v[116:119]
ds_read_b128 v[40:43], v3 offset:20480
ds_read_b128 v[44:47], v3 offset:22528
v_mfma_f32_16x16x32_bf16 v[120:123], v[48:51], v[28:31], v[120:123]
s_waitcnt lgkmcnt(8)
v_mfma_f32_16x16x32_bf16 v[124:127], v[52:55], v[16:19], v[124:127]
ds_read_b64_tr_b16 v[64:65], v4 offset:24576
v_mfma_f32_16x16x32_bf16 v[128:131], v[52:55], v[20:23], v[128:131]
ds_read_b64_tr_b16 v[66:67], v4 offset:25600
v_mfma_f32_16x16x32_bf16 v[132:135], v[52:55], v[24:27], v[132:135]
v_mfma_f32_16x16x32_bf16 v[136:139], v[52:55], v[28:31], v[136:139]
s_waitcnt lgkmcnt(8)
v_mfma_f32_16x16x32_bf16 v[140:143], v[56:59], v[16:19], v[140:143]
ds_read_b64_tr_b16 v[68:69], v5 offset:24576
v_mfma_f32_16x16x32_bf16 v[144:147], v[56:59], v[20:23], v[144:147]
ds_read_b64_tr_b16 v[70:71], v5 offset:25600
v_mfma_f32_16x16x32_bf16 v[148:151], v[56:59], v[24:27], v[148:151]
v_mfma_f32_16x16x32_bf16 v[152:155], v[56:59], v[28:31], v[152:155]
s_waitcnt lgkmcnt(8)
v_mfma_f32_16x16x32_bf16 v[156:159], v[60:63], v[16:19], v[156:159]
ds_read_b64_tr_b16 v[72:73], v6 offset:24576
v_mfma_f32_16x16x32_bf16 v[160:163], v[60:63], v[20:23], v[160:163]
ds_read_b64_tr_b16 v[74:75], v6 offset:25600
v_mfma_f32_16x16x32_bf16 v[164:167], v[60:63], v[24:27], v[164:167]
v_mfma_f32_16x16x32_bf16 v[168:171], v[60:63], v[28:31], v[168:171]
s_waitcnt lgkmcnt(4)
v_mfma_f32_16x16x32_bf16 v[108:111], v[64:67], v[32:35], v[108:111]
ds_read_b64_tr_b16 v[76:77], v7 offset:24576
v_mfma_f32_16x16x32_bf16 v[112:115], v[64:67], v[36:39], v[112:115]
ds_read_b64_tr_b16 v[78:79], v7 offset:25600
v_mfma_f32_16x16x32_bf16 v[116:119], v[64:67], v[40:43], v[116:119]
v_mfma_f32_16x16x32_bf16 v[120:123], v[64:67], v[44:47], v[120:123]
s_waitcnt lgkmcnt(4)
v_mfma_f32_16x16x32_bf16 v[124:127], v[68:71], v[32:35], v[124:127]
v_mfma_f32_16x16x32_bf16 v[128:131], v[68:71], v[36:39], v[128:131]
v_mfma_f32_16x16x32_bf16 v[132:135], v[68:71], v[40:43], v[132:135]
v_mfma_f32_16x16x32_bf16 v[136:139], v[68:71], v[44:47], v[136:139]
s_waitcnt lgkmcnt(0)
s_barrier
v_mfma_f32_16x16x32_bf16 v[140:143], v[72:75], v[32:35], v[140:143]
v_mfma_f32_16x16x32_bf16 v[144:147], v[72:75], v[36:39], v[144:147]
v_mfma_f32_16x16x32_bf16 v[148:151], v[72:75], v[40:43], v[148:151]
v_mfma_f32_16x16x32_bf16 v[152:155], v[72:75], v[44:47], v[152:155]
v_mfma_f32_16x16x32_bf16 v[156:159], v[76:79], v[32:35], v[156:159]
v_mfma_f32_16x16x32_bf16 v[160:163], v[76:79], v[36:39], v[160:163]
v_mfma_f32_16x16x32_bf16 v[164:167], v[76:79], v[40:43], v[164:167]
v_mfma_f32_16x16x32_bf16 v[168:171], v[76:79], v[44:47], v[168:171]
s_bitcmp1_b32 s27, 0
s_cbranch_scc1 k_p2kv
s_branch k_p2q
k_p1h2:
s_barrier
ds_read_b128 v[16:19], v2 offset:0
ds_read_b64_tr_b16 v[48:49], v8 offset:2048
ds_read_b64_tr_b16 v[50:51], v8 offset:2560
ds_read_b128 v[20:23], v2 offset:2048
ds_read_b128 v[24:27], v2 offset:4096
ds_read_b128 v[28:31], v2 offset:6144
ds_read_b64_tr_b16 v[52:53], v9 offset:2048
ds_read_b64_tr_b16 v[54:55], v9 offset:2560
ds_read_b64_tr_b16 v[56:57], v8 offset:10240
ds_read_b64_tr_b16 v[58:59], v8 offset:10752
s_waitcnt lgkmcnt(4)
v_mfma_f32_16x16x32_bf16 v[108:111], v[48:51], v[16:19], 0
ds_read_b64_tr_b16 v[60:61], v9 offset:10240
ds_read_b64_tr_b16 v[62:63], v9 offset:10752
v_mfma_f32_16x16x32_bf16 v[112:115], v[48:51], v[20:23], 0
ds_read_b128 v[32:35], v3 offset:0
ds_read_b128 v[36:39], v3 offset:2048
v_mfma_f32_16x16x32_bf16 v[116:119], v[48:51], v[24:27], 0
ds_read_b128 v[40:43], v3 offset:4096
ds_read_b128 v[44:47], v3 offset:6144
v_mfma_f32_16x16x32_bf16 v[120:123], v[48:51], v[28:31], 0
s_waitcnt lgkmcnt(8)
v_mfma_f32_16x16x32_bf16 v[124:127], v[52:55], v[16:19], 0
v_mfma_f32_16x16x32_bf16 v[128:131], v[52:55], v[20:23], 0
v_mfma_f32_16x16x32_bf16 v[132:135], v[52:55], v[24:27], 0
v_mfma_f32_16x16x32_bf16 v[136:139], v[52:55], v[28:31], 0
s_waitcnt lgkmcnt(0)
v_mfma_f32_16x16x32_bf16 v[108:111], v[56:59], v[32:35], v[108:111]
v_mfma_f32_16x16x32_bf16 v[112:115], v[56:59], v[36:39], v[112:115]
v_mfma_f32_16x16x32_bf16 v[116:119], v[56:59], v[40:43], v[116:119]
v_mfma_f32_16x16x32_bf16 v[120:123], v[56:59], v[44:47], v[120:123]
s_waitcnt lgkmcnt(0)
s_barrier
v_mfma_f32_16x16x32_bf16 v[124:127], v[60:63], v[32:35], v[124:127]
ds_read_b128 v[16:19], v2 offset:16384
ds_read_b64_tr_b16 v[64:65], v8 offset:18432
ds_read_b64_tr_b16 v[66:67], v8 offset:18944
v_mfma_f32_16x16x32_bf16 v[128:131], v[60:63], v[36:39], v[128:131]
ds_read_b128 v[20:23], v2 offset:18432
ds_read_b128 v[24:27], v2 offset:20480
ds_read_b128 v[28:31], v2 offset:22528
v_mfma_f32_16x16x32_bf16 v[132:135], v[60:63], v[40:43], v[132:135]
ds_read_b64_tr_b16 v[68:69], v9 offset:18432
ds_read_b64_tr_b16 v[70:71], v9 offset:18944
ds_read_b64_tr_b16 v[72:73], v8 offset:26624
v_mfma_f32_16x16x32_bf16 v[136:139], v[60:63], v[44:47], v[136:139]
ds_read_b64_tr_b16 v[74:75], v8 offset:27136
v_lshrrev_b32 v97, 5, v1
v_lshlrev_b32 v97, 12, v97
s_lshl_b32 s72, s31, 11
s_add_u32 s72, s72, 131072
v_add_u32 v97, s72, v97
s_cmp_eq_u32 s31, 1
s_cbranch_scc1 k_cshalf
v_add_u32 v104, v97, v4
v_add_u32 v105, v97, v5
v_add_u32 v106, v97, v6
v_add_u32 v107, v97, v7
ds_read_b64_tr_b16 v[172:173], v104 offset:0
ds_read_b64_tr_b16 v[174:175], v104 offset:1024
ds_read_b64_tr_b16 v[176:177], v105 offset:0
ds_read_b64_tr_b16 v[178:179], v105 offset:1024
ds_read_b64_tr_b16 v[180:181], v106 offset:0
ds_read_b64_tr_b16 v[182:183], v106 offset:1024
ds_read_b64_tr_b16 v[184:185], v107 offset:0
ds_read_b64_tr_b16 v[186:187], v107 offset:1024
s_waitcnt lgkmcnt(0)
v_mfma_f32_16x16x32_bf16 v[188:191], v[92:95], v[172:175], 0
v_mfma_f32_16x16x32_bf16 v[192:195], v[92:95], v[176:179], 0
v_mfma_f32_16x16x32_bf16 v[196:199], v[92:95], v[180:183], 0
v_mfma_f32_16x16x32_bf16 v[200:203], v[92:95], v[184:187], 0
s_nop 7
s_nop 1
v_mov_b32_dpp v188, v192 quad_perm:[0,1,2,3] row_mask:0x2 bank_mask:0xf
s_nop 1
v_mov_b32_dpp v188, v196 quad_perm:[0,1,2,3] row_mask:0x4 bank_mask:0xf
s_nop 1
v_mov_b32_dpp v188, v200 quad_perm:[0,1,2,3] row_mask:0x8 bank_mask:0xf
s_branch k_csst
k_cshalf:
v_add_u32 v104, v97, v8
v_add_u32 v105, v97, v9
ds_read_b64_tr_b16 v[172:173], v104 offset:0
ds_read_b64_tr_b16 v[174:175], v104 offset:512
ds_read_b64_tr_b16 v[176:177], v105 offset:0
ds_read_b64_tr_b16 v[178:179], v105 offset:512
s_waitcnt lgkmcnt(0)
v_mfma_f32_16x16x32_bf16 v[188:191], v[92:95], v[172:175], 0
v_mfma_f32_16x16x32_bf16 v[192:195], v[92:95], v[176:179], 0
s_nop 7
v_mov_b32_dpp v188, v192 quad_perm:[0,1,2,3] row_mask:0x2 bank_mask:0xf
k_csst:
buffer_store_dword v188, v96, s[44:47], s75 offen sc1
v_mfma_f32_16x16x32_bf16 v[108:111], v[64:67], v[16:19], v[108:111]
ds_read_b64_tr_b16 v[76:77], v9 offset:26624
ds_read_b64_tr_b16 v[78:79], v9 offset:27136
v_mfma_f32_16x16x32_bf16 v[112:115], v[64:67], v[20:23], v[112:115]
ds_read_b128 v[32:35], v3 offset:16384
ds_read_b128 v[36:39], v3 offset:18432
v_mfma_f32_16x16x32_bf16 v[116:119], v[64:67], v[24:27], v[116:119]
ds_read_b128 v[40:43], v3 offset:20480
ds_read_b128 v[44:47], v3 offset:22528
v_mfma_f32_16x16x32_bf16 v[120:123], v[64:67], v[28:31], v[120:123]
v_mfma_f32_16x16x32_bf16 v[124:127], v[68:71], v[16:19], v[124:127]
v_mfma_f32_16x16x32_bf16 v[128:131], v[68:71], v[20:23], v[128:131]
v_mfma_f32_16x16x32_bf16 v[132:135], v[68:71], v[24:27], v[132:135]
v_mfma_f32_16x16x32_bf16 v[136:139], v[68:71], v[28:31], v[136:139]
s_waitcnt lgkmcnt(0)
v_mfma_f32_16x16x32_bf16 v[108:111], v[72:75], v[32:35], v[108:111]
v_mfma_f32_16x16x32_bf16 v[112:115], v[72:75], v[36:39], v[112:115]
v_mfma_f32_16x16x32_bf16 v[116:119], v[72:75], v[40:43], v[116:119]
v_mfma_f32_16x16x32_bf16 v[120:123], v[72:75], v[44:47], v[120:123]
s_waitcnt lgkmcnt(0)
s_barrier
v_mfma_f32_16x16x32_bf16 v[124:127], v[76:79], v[32:35], v[124:127]
ds_read_b128 v[16:19], v2 offset:32768
ds_read_b64_tr_b16 v[48:49], v8 offset:34816
ds_read_b64_tr_b16 v[50:51], v8 offset:35328
v_mfma_f32_16x16x32_bf16 v[128:131], v[76:79], v[36:39], v[128:131]
ds_read_b128 v[20:23], v2 offset:34816
ds_read_b128 v[24:27], v2 offset:36864
ds_read_b128 v[28:31], v2 offset:38912
v_mfma_f32_16x16x32_bf16 v[132:135], v[76:79], v[40:43], v[132:135]
ds_read_b64_tr_b16 v[52:53], v9 offset:34816
ds_read_b64_tr_b16 v[54:55], v9 offset:35328
ds_read_b64_tr_b16 v[56:57], v8 offset:43008
v_mfma_f32_16x16x32_bf16 v[136:139], v[76:79], v[44:47], v[136:139]
ds_read_b64_tr_b16 v[58:59], v8 offset:43520
s_waitcnt lgkmcnt(4)
v_mfma_f32_16x16x32_bf16 v[108:111], v[48:51], v[16:19], v[108:111]
ds_read_b64_tr_b16 v[60:61], v9 offset:43008
ds_read_b64_tr_b16 v[62:63], v9 offset:43520
v_mfma_f32_16x16x32_bf16 v[112:115], v[48:51], v[20:23], v[112:115]
ds_read_b128 v[32:35], v3 offset:32768
ds_read_b128 v[36:39], v3 offset:34816
v_mfma_f32_16x16x32_bf16 v[116:119], v[48:51], v[24:27], v[116:119]
ds_read_b128 v[40:43], v3 offset:36864
ds_read_b128 v[44:47], v3 offset:38912
v_mfma_f32_16x16x32_bf16 v[120:123], v[48:51], v[28:31], v[120:123]
s_waitcnt lgkmcnt(8)
v_mfma_f32_16x16x32_bf16 v[124:127], v[52:55], v[16:19], v[124:127]
v_mfma_f32_16x16x32_bf16 v[128:131], v[52:55], v[20:23], v[128:131]
v_mfma_f32_16x16x32_bf16 v[132:135], v[52:55], v[24:27], v[132:135]
v_mfma_f32_16x16x32_bf16 v[136:139], v[52:55], v[28:31], v[136:139]
s_waitcnt lgkmcnt(0)
v_mfma_f32_16x16x32_bf16 v[108:111], v[56:59], v[32:35], v[108:111]
v_mfma_f32_16x16x32_bf16 v[112:115], v[56:59], v[36:39], v[112:115]
v_mfma_f32_16x16x32_bf16 v[116:119], v[56:59], v[40:43], v[116:119]
v_mfma_f32_16x16x32_bf16 v[120:123], v[56:59], v[44:47], v[120:123]
s_waitcnt lgkmcnt(0)
s_barrier
v_mfma_f32_16x16x32_bf16 v[124:127], v[60:63], v[32:35], v[124:127]
ds_read_b128 v[16:19], v88 offset:0
ds_read_b64_tr_b16 v[64:65], v8 offset:2048
ds_read_b64_tr_b16 v[66:67], v8 offset:2560
v_mfma_f32_16x16x32_bf16 v[128:131], v[60:63], v[36:39], v[128:131]
ds_read_b128 v[20:23], v88 offset:2048
ds_read_b128 v[24:27], v88 offset:4096
ds_read_b128 v[28:31], v88 offset:6144
v_mfma_f32_16x16x32_bf16 v[132:135], v[60:63], v[40:43], v[132:135]
ds_read_b64_tr_b16 v[68:69], v9 offset:2048
ds_read_b64_tr_b16 v[70:71], v9 offset:2560
ds_read_b64_tr_b16 v[72:73], v8 offset:10240
v_mfma_f32_16x16x32_bf16 v[136:139], v[60:63], v[44:47], v[136:139]
ds_read_b64_tr_b16 v[74:75], v8 offset:10752
s_waitcnt vmcnt(0)
s_waitcnt lgkmcnt(4)
v_mfma_f32_16x16x32_bf16 v[108:111], v[64:67], v[16:19], v[108:111]
ds_read_b64_tr_b16 v[76:77], v9 offset:10240
ds_read_b64_tr_b16 v[78:79], v9 offset:10752
v_mfma_f32_16x16x32_bf16 v[112:115], v[64:67], v[20:23], v[112:115]
ds_read_b128 v[32:35], v89 offset:0
ds_read_b128 v[36:39], v89 offset:2048
v_mfma_f32_16x16x32_bf16 v[116:119], v[64:67], v[24:27], v[116:119]
ds_read_b128 v[40:43], v89 offset:4096
ds_read_b128 v[44:47], v89 offset:6144
v_mfma_f32_16x16x32_bf16 v[120:123], v[64:67], v[28:31], v[120:123]
s_waitcnt lgkmcnt(8)
v_mfma_f32_16x16x32_bf16 v[124:127], v[68:71], v[16:19], v[124:127]
v_mfma_f32_16x16x32_bf16 v[128:131], v[68:71], v[20:23], v[128:131]
v_mfma_f32_16x16x32_bf16 v[132:135], v[68:71], v[24:27], v[132:135]
v_mfma_f32_16x16x32_bf16 v[136:139], v[68:71], v[28:31], v[136:139]
s_waitcnt lgkmcnt(0)
v_mfma_f32_16x16x32_bf16 v[108:111], v[72:75], v[32:35], v[108:111]
v_mfma_f32_16x16x32_bf16 v[112:115], v[72:75], v[36:39], v[112:115]
v_mfma_f32_16x16x32_bf16 v[116:119], v[72:75], v[40:43], v[116:119]
v_mfma_f32_16x16x32_bf16 v[120:123], v[72:75], v[44:47], v[120:123]
s_waitcnt lgkmcnt(0)
s_barrier
v_mfma_f32_16x16x32_bf16 v[124:127], v[76:79], v[32:35], v[124:127]
ds_read_b128 v[16:19], v88 offset:16384
ds_read_b64_tr_b16 v[48:49], v8 offset:18432
ds_read_b64_tr_b16 v[50:51], v8 offset:18944
v_mfma_f32_16x16x32_bf16 v[128:131], v[76:79], v[36:39], v[128:131]
ds_read_b128 v[20:23], v88 offset:18432
ds_read_b128 v[24:27], v88 offset:20480
ds_read_b128 v[28:31], v88 offset:22528
v_mfma_f32_16x16x32_bf16 v[132:135], v[76:79], v[40:43], v[132:135]
ds_read_b64_tr_b16 v[52:53], v9 offset:18432
ds_read_b64_tr_b16 v[54:55], v9 offset:18944
ds_read_b64_tr_b16 v[56:57], v8 offset:26624
v_mfma_f32_16x16x32_bf16 v[136:139], v[76:79], v[44:47], v[136:139]
ds_read_b64_tr_b16 v[58:59], v8 offset:27136
s_waitcnt lgkmcnt(4)
v_mfma_f32_16x16x32_bf16 v[108:111], v[48:51], v[16:19], v[108:111]
ds_read_b64_tr_b16 v[60:61], v9 offset:26624
ds_read_b64_tr_b16 v[62:63], v9 offset:27136
v_mfma_f32_16x16x32_bf16 v[112:115], v[48:51], v[20:23], v[112:115]
ds_read_b128 v[32:35], v89 offset:16384
ds_read_b128 v[36:39], v89 offset:18432
v_mfma_f32_16x16x32_bf16 v[116:119], v[48:51], v[24:27], v[116:119]
ds_read_b128 v[40:43], v89 offset:20480
ds_read_b128 v[44:47], v89 offset:22528
v_mfma_f32_16x16x32_bf16 v[120:123], v[48:51], v[28:31], v[120:123]
s_waitcnt lgkmcnt(8)
v_mfma_f32_16x16x32_bf16 v[124:127], v[52:55], v[16:19], v[124:127]
v_mfma_f32_16x16x32_bf16 v[128:131], v[52:55], v[20:23], v[128:131]
v_mfma_f32_16x16x32_bf16 v[132:135], v[52:55], v[24:27], v[132:135]
v_mfma_f32_16x16x32_bf16 v[136:139], v[52:55], v[28:31], v[136:139]
s_waitcnt lgkmcnt(0)
v_mfma_f32_16x16x32_bf16 v[108:111], v[56:59], v[32:35], v[108:111]
v_mfma_f32_16x16x32_bf16 v[112:115], v[56:59], v[36:39], v[112:115]
v_mfma_f32_16x16x32_bf16 v[116:119], v[56:59], v[40:43], v[116:119]
v_mfma_f32_16x16x32_bf16 v[120:123], v[56:59], v[44:47], v[120:123]
s_waitcnt lgkmcnt(0)
s_barrier
v_mfma_f32_16x16x32_bf16 v[124:127], v[60:63], v[32:35], v[124:127]
ds_read_b128 v[16:19], v88 offset:32768
ds_read_b64_tr_b16 v[64:65], v8 offset:34816
ds_read_b64_tr_b16 v[66:67], v8 offset:35328
v_mfma_f32_16x16x32_bf16 v[128:131], v[60:63], v[36:39], v[128:131]
ds_read_b128 v[20:23], v88 offset:34816
ds_read_b128 v[24:27], v88 offset:36864
ds_read_b128 v[28:31], v88 offset:38912
v_mfma_f32_16x16x32_bf16 v[132:135], v[60:63], v[40:43], v[132:135]
ds_read_b64_tr_b16 v[68:69], v9 offset:34816
ds_read_b64_tr_b16 v[70:71], v9 offset:35328
ds_read_b64_tr_b16 v[72:73], v8 offset:43008
v_mfma_f32_16x16x32_bf16 v[136:139], v[60:63], v[44:47], v[136:139]
ds_read_b64_tr_b16 v[74:75], v8 offset:43520
s_waitcnt lgkmcnt(4)
v_mfma_f32_16x16x32_bf16 v[108:111], v[64:67], v[16:19], v[108:111]
ds_read_b64_tr_b16 v[76:77], v9 offset:43008
ds_read_b64_tr_b16 v[78:79], v9 offset:43520
v_mfma_f32_16x16x32_bf16 v[112:115], v[64:67], v[20:23], v[112:115]
ds_read_b128 v[32:35], v89 offset:32768
ds_read_b128 v[36:39], v89 offset:34816
v_mfma_f32_16x16x32_bf16 v[116:119], v[64:67], v[24:27], v[116:119]
ds_read_b128 v[40:43], v89 offset:36864
ds_read_b128 v[44:47], v89 offset:38912
v_mfma_f32_16x16x32_bf16 v[120:123], v[64:67], v[28:31], v[120:123]
s_waitcnt lgkmcnt(8)
v_mfma_f32_16x16x32_bf16 v[124:127], v[68:71], v[16:19], v[124:127]
v_mfma_f32_16x16x32_bf16 v[128:131], v[68:71], v[20:23], v[128:131]
v_mfma_f32_16x16x32_bf16 v[132:135], v[68:71], v[24:27], v[132:135]
v_mfma_f32_16x16x32_bf16 v[136:139], v[68:71], v[28:31], v[136:139]
s_waitcnt lgkmcnt(0)
v_mfma_f32_16x16x32_bf16 v[108:111], v[72:75], v[32:35], v[108:111]
v_mfma_f32_16x16x32_bf16 v[112:115], v[72:75], v[36:39], v[112:115]
v_mfma_f32_16x16x32_bf16 v[116:119], v[72:75], v[40:43], v[116:119]
v_mfma_f32_16x16x32_bf16 v[120:123], v[72:75], v[44:47], v[120:123]
s_waitcnt lgkmcnt(0)
s_barrier
v_mfma_f32_16x16x32_bf16 v[124:127], v[76:79], v[32:35], v[124:127]
ds_read_b128 v[16:19], v2 offset:0
ds_read_b64_tr_b16 v[48:49], v8 offset:2048
ds_read_b64_tr_b16 v[50:51], v8 offset:2560
v_mfma_f32_16x16x32_bf16 v[128:131], v[76:79], v[36:39], v[128:131]
ds_read_b128 v[20:23], v2 offset:2048
ds_read_b128 v[24:27], v2 offset:4096
ds_read_b128 v[28:31], v2 offset:6144
v_mfma_f32_16x16x32_bf16 v[132:135], v[76:79], v[40:43], v[132:135]
ds_read_b64_tr_b16 v[52:53], v9 offset:2048
ds_read_b64_tr_b16 v[54:55], v9 offset:2560
ds_read_b64_tr_b16 v[56:57], v8 offset:10240
v_mfma_f32_16x16x32_bf16 v[136:139], v[76:79], v[44:47], v[136:139]
ds_read_b64_tr_b16 v[58:59], v8 offset:10752
s_waitcnt lgkmcnt(4)
v_mfma_f32_16x16x32_bf16 v[108:111], v[48:51], v[16:19], v[108:111]
ds_read_b64_tr_b16 v[60:61], v9 offset:10240
ds_read_b64_tr_b16 v[62:63], v9 offset:10752
v_mfma_f32_16x16x32_bf16 v[112:115], v[48:51], v[20:23], v[112:115]
ds_read_b128 v[32:35], v3 offset:0
ds_read_b128 v[36:39], v3 offset:2048
v_mfma_f32_16x16x32_bf16 v[116:119], v[48:51], v[24:27], v[116:119]
ds_read_b128 v[40:43], v3 offset:4096
ds_read_b128 v[44:47], v3 offset:6144
v_mfma_f32_16x16x32_bf16 v[120:123], v[48:51], v[28:31], v[120:123]
s_waitcnt lgkmcnt(8)
v_mfma_f32_16x16x32_bf16 v[124:127], v[52:55], v[16:19], v[124:127]
v_mfma_f32_16x16x32_bf16 v[128:131], v[52:55], v[20:23], v[128:131]
v_mfma_f32_16x16x32_bf16 v[132:135], v[52:55], v[24:27], v[132:135]
v_mfma_f32_16x16x32_bf16 v[136:139], v[52:55], v[28:31], v[136:139]
s_waitcnt lgkmcnt(0)
v_mfma_f32_16x16x32_bf16 v[108:111], v[56:59], v[32:35], v[108:111]
v_mfma_f32_16x16x32_bf16 v[112:115], v[56:59], v[36:39], v[112:115]
v_mfma_f32_16x16x32_bf16 v[116:119], v[56:59], v[40:43], v[116:119]
v_mfma_f32_16x16x32_bf16 v[120:123], v[56:59], v[44:47], v[120:123]
s_waitcnt lgkmcnt(0)
s_barrier
v_mfma_f32_16x16x32_bf16 v[124:127], v[60:63], v[32:35], v[124:127]
ds_read_b128 v[16:19], v2 offset:16384
ds_read_b64_tr_b16 v[64:65], v8 offset:18432
ds_read_b64_tr_b16 v[66:67], v8 offset:18944
v_mfma_f32_16x16x32_bf16 v[128:131], v[60:63], v[36:39], v[128:131]
ds_read_b128 v[20:23], v2 offset:18432
ds_read_b128 v[24:27], v2 offset:20480
ds_read_b128 v[28:31], v2 offset:22528
v_mfma_f32_16x16x32_bf16 v[132:135], v[60:63], v[40:43], v[132:135]
ds_read_b64_tr_b16 v[68:69], v9 offset:18432
ds_read_b64_tr_b16 v[70:71], v9 offset:18944
ds_read_b64_tr_b16 v[72:73], v8 offset:26624
v_mfma_f32_16x16x32_bf16 v[136:139], v[60:63], v[44:47], v[136:139]
ds_read_b64_tr_b16 v[74:75], v8 offset:27136
s_waitcnt lgkmcnt(4)
v_mfma_f32_16x16x32_bf16 v[108:111], v[64:67], v[16:19], v[108:111]
ds_read_b64_tr_b16 v[76:77], v9 offset:26624
ds_read_b64_tr_b16 v[78:79], v9 offset:27136
v_mfma_f32_16x16x32_bf16 v[112:115], v[64:67], v[20:23], v[112:115]
ds_read_b128 v[32:35], v3 offset:16384
ds_read_b128 v[36:39], v3 offset:18432
v_mfma_f32_16x16x32_bf16 v[116:119], v[64:67], v[24:27], v[116:119]
ds_read_b128 v[40:43], v3 offset:20480
ds_read_b128 v[44:47], v3 offset:22528
v_mfma_f32_16x16x32_bf16 v[120:123], v[64:67], v[28:31], v[120:123]
s_waitcnt lgkmcnt(8)
v_mfma_f32_16x16x32_bf16 v[124:127], v[68:71], v[16:19], v[124:127]
v_mfma_f32_16x16x32_bf16 v[128:131], v[68:71], v[20:23], v[128:131]
v_mfma_f32_16x16x32_bf16 v[132:135], v[68:71], v[24:27], v[132:135]
v_mfma_f32_16x16x32_bf16 v[136:139], v[68:71], v[28:31], v[136:139]
s_waitcnt lgkmcnt(0)
v_mfma_f32_16x16x32_bf16 v[108:111], v[72:75], v[32:35], v[108:111]
v_mfma_f32_16x16x32_bf16 v[112:115], v[72:75], v[36:39], v[112:115]
v_mfma_f32_16x16x32_bf16 v[116:119], v[72:75], v[40:43], v[116:119]
v_mfma_f32_16x16x32_bf16 v[120:123], v[72:75], v[44:47], v[120:123]
s_waitcnt lgkmcnt(0)
s_barrier
v_mfma_f32_16x16x32_bf16 v[124:127], v[76:79], v[32:35], v[124:127]
v_mfma_f32_16x16x32_bf16 v[128:131], v[76:79], v[36:39], v[128:131]
v_mfma_f32_16x16x32_bf16 v[132:135], v[76:79], v[40:43], v[132:135]
v_mfma_f32_16x16x32_bf16 v[136:139], v[76:79], v[44:47], v[136:139]
s_branch k_p2kv
k_p2q:
v_lshrrev_b32 v97, 5, v1
v_lshlrev_b32 v97, 11, v97
v_sub_u32 v90, v90, v97
v_sub_u32 v91, v91, v97
ds_read_b128 v[16:19], v2 offset:32768
ds_read_b64_tr_b16 v[48:49], v90 offset:32768
ds_read_b64_tr_b16 v[50:51], v90 offset:33792
ds_read_b128 v[20:23], v2 offset:34816
ds_read_b128 v[24:27], v2 offset:36864
ds_read_b128 v[28:31], v2 offset:38912
ds_read_b64_tr_b16 v[52:53], v91 offset:32768
ds_read_b64_tr_b16 v[54:55], v91 offset:33792
ds_read_b64_tr_b16 v[56:57], v90 offset:36864
ds_read_b64_tr_b16 v[58:59], v90 offset:37888
s_waitcnt lgkmcnt(4)
v_mfma_f32_16x16x32_bf16 v[172:175], v[48:51], v[16:19], 0
ds_read_b64_tr_b16 v[60:61], v91 offset:36864
ds_read_b64_tr_b16 v[62:63], v91 offset:37888
v_mfma_f32_16x16x32_bf16 v[176:179], v[48:51], v[20:23], 0
ds_read_b128 v[32:35], v3 offset:32768
ds_read_b128 v[36:39], v3 offset:34816
v_mfma_f32_16x16x32_bf16 v[180:183], v[48:51], v[24:27], 0
ds_read_b128 v[40:43], v3 offset:36864
ds_read_b128 v[44:47], v3 offset:38912
v_mfma_f32_16x16x32_bf16 v[184:187], v[48:51], v[28:31], 0
s_waitcnt lgkmcnt(8)
v_mfma_f32_16x16x32_bf16 v[188:191], v[52:55], v[16:19], 0
v_mfma_f32_16x16x32_bf16 v[192:195], v[52:55], v[20:23], 0
v_mfma_f32_16x16x32_bf16 v[196:199], v[52:55], v[24:27], 0
v_mfma_f32_16x16x32_bf16 v[200:203], v[52:55], v[28:31], 0
s_waitcnt lgkmcnt(0)
v_mfma_f32_16x16x32_bf16 v[172:175], v[56:59], v[32:35], v[172:175]
v_mfma_f32_16x16x32_bf16 v[176:179], v[56:59], v[36:39], v[176:179]
v_mfma_f32_16x16x32_bf16 v[180:183], v[56:59], v[40:43], v[180:183]
v_mfma_f32_16x16x32_bf16 v[184:187], v[56:59], v[44:47], v[184:187]
s_waitcnt lgkmcnt(0)
s_barrier
v_mfma_f32_16x16x32_bf16 v[188:191], v[60:63], v[32:35], v[188:191]
ds_read_b128 v[16:19], v88 offset:0
ds_read_b64_tr_b16 v[64:65], v90 offset:40960
ds_read_b64_tr_b16 v[66:67], v90 offset:41984
v_mfma_f32_16x16x32_bf16 v[192:195], v[60:63], v[36:39], v[192:195]
ds_read_b128 v[20:23], v88 offset:2048
ds_read_b128 v[24:27], v88 offset:4096
ds_read_b128 v[28:31], v88 offset:6144
v_mfma_f32_16x16x32_bf16 v[196:199], v[60:63], v[40:43], v[196:199]
ds_read_b64_tr_b16 v[68:69], v91 offset:40960
ds_read_b64_tr_b16 v[70:71], v91 offset:41984
ds_read_b64_tr_b16 v[72:73], v90 offset:45056
v_mfma_f32_16x16x32_bf16 v[200:203], v[60:63], v[44:47], v[200:203]
ds_read_b64_tr_b16 v[74:75], v90 offset:46080
s_waitcnt lgkmcnt(4)
v_mfma_f32_16x16x32_bf16 v[172:175], v[64:67], v[16:19], v[172:175]
ds_read_b64_tr_b16 v[76:77], v91 offset:45056
ds_read_b64_tr_b16 v[78:79], v91 offset:46080
v_mfma_f32_16x16x32_bf16 v[176:179], v[64:67], v[20:23], v[176:179]
ds_read_b128 v[32:35], v89 offset:0
ds_read_b128 v[36:39], v89 offset:2048
v_mfma_f32_16x16x32_bf16 v[180:183], v[64:67], v[24:27], v[180:183]
ds_read_b128 v[40:43], v89 offset:4096
ds_read_b128 v[44:47], v89 offset:6144
v_mfma_f32_16x16x32_bf16 v[184:187], v[64:67], v[28:31], v[184:187]
s_waitcnt lgkmcnt(8)
v_mfma_f32_16x16x32_bf16 v[188:191], v[68:71], v[16:19], v[188:191]
v_mfma_f32_16x16x32_bf16 v[192:195], v[68:71], v[20:23], v[192:195]
v_mfma_f32_16x16x32_bf16 v[196:199], v[68:71], v[24:27], v[196:199]
v_mfma_f32_16x16x32_bf16 v[200:203], v[68:71], v[28:31], v[200:203]
s_waitcnt lgkmcnt(0)
v_mfma_f32_16x16x32_bf16 v[172:175], v[72:75], v[32:35], v[172:175]
v_mfma_f32_16x16x32_bf16 v[176:179], v[72:75], v[36:39], v[176:179]
v_mfma_f32_16x16x32_bf16 v[180:183], v[72:75], v[40:43], v[180:183]
v_mfma_f32_16x16x32_bf16 v[184:187], v[72:75], v[44:47], v[184:187]
s_waitcnt lgkmcnt(0)
s_barrier
v_mfma_f32_16x16x32_bf16 v[188:191], v[76:79], v[32:35], v[188:191]
ds_read_b128 v[16:19], v88 offset:16384
ds_read_b64_tr_b16 v[48:49], v90 offset:0
ds_read_b64_tr_b16 v[50:51], v90 offset:1024
v_mfma_f32_16x16x32_bf16 v[192:195], v[76:79], v[36:39], v[192:195]
ds_read_b128 v[20:23], v88 offset:18432
ds_read_b128 v[24:27], v88 offset:20480
ds_read_b128 v[28:31], v88 offset:22528
v_mfma_f32_16x16x32_bf16 v[196:199], v[76:79], v[40:43], v[196:199]
ds_read_b64_tr_b16 v[52:53], v91 offset:0
ds_read_b64_tr_b16 v[54:55], v91 offset:1024
ds_read_b64_tr_b16 v[56:57], v90 offset:4096
v_mfma_f32_16x16x32_bf16 v[200:203], v[76:79], v[44:47], v[200:203]
ds_read_b64_tr_b16 v[58:59], v90 offset:5120
s_waitcnt lgkmcnt(4)
v_mfma_f32_16x16x32_bf16 v[172:175], v[48:51], v[16:19], v[172:175]
ds_read_b64_tr_b16 v[60:61], v91 offset:4096
ds_read_b64_tr_b16 v[62:63], v91 offset:5120
v_mfma_f32_16x16x32_bf16 v[176:179], v[48:51], v[20:23], v[176:179]
ds_read_b128 v[32:35], v89 offset:16384
ds_read_b128 v[36:39], v89 offset:18432
v_mfma_f32_16x16x32_bf16 v[180:183], v[48:51], v[24:27], v[180:183]
ds_read_b128 v[40:43], v89 offset:20480
ds_read_b128 v[44:47], v89 offset:22528
v_mfma_f32_16x16x32_bf16 v[184:187], v[48:51], v[28:31], v[184:187]
s_waitcnt lgkmcnt(8)
v_mfma_f32_16x16x32_bf16 v[188:191], v[52:55], v[16:19], v[188:191]
v_mfma_f32_16x16x32_bf16 v[192:195], v[52:55], v[20:23], v[192:195]
v_mfma_f32_16x16x32_bf16 v[196:199], v[52:55], v[24:27], v[196:199]
v_mfma_f32_16x16x32_bf16 v[200:203], v[52:55], v[28:31], v[200:203]
s_waitcnt lgkmcnt(0)
v_mfma_f32_16x16x32_bf16 v[172:175], v[56:59], v[32:35], v[172:175]
v_mfma_f32_16x16x32_bf16 v[176:179], v[56:59], v[36:39], v[176:179]
v_mfma_f32_16x16x32_bf16 v[180:183], v[56:59], v[40:43], v[180:183]
v_mfma_f32_16x16x32_bf16 v[184:187], v[56:59], v[44:47], v[184:187]
s_waitcnt lgkmcnt(0)
s_barrier
v_mfma_f32_16x16x32_bf16 v[188:191], v[60:63], v[32:35], v[188:191]
ds_read_b128 v[16:19], v88 offset:32768
ds_read_b64_tr_b16 v[64:65], v90 offset:8192
ds_read_b64_tr_b16 v[66:67], v90 offset:9216
v_mfma_f32_16x16x32_bf16 v[192:195], v[60:63], v[36:39], v[192:195]
ds_read_b128 v[20:23], v88 offset:34816
ds_read_b128 v[24:27], v88 offset:36864
ds_read_b128 v[28:31], v88 offset:38912
v_mfma_f32_16x16x32_bf16 v[196:199], v[60:63], v[40:43], v[196:199]
ds_read_b64_tr_b16 v[68:69], v91 offset:8192
ds_read_b64_tr_b16 v[70:71], v91 offset:9216
ds_read_b64_tr_b16 v[72:73], v90 offset:12288
v_mfma_f32_16x16x32_bf16 v[200:203], v[60:63], v[44:47], v[200:203]
ds_read_b64_tr_b16 v[74:75], v90 offset:13312
s_waitcnt lgkmcnt(4)
v_mfma_f32_16x16x32_bf16 v[172:175], v[64:67], v[16:19], v[172:175]
ds_read_b64_tr_b16 v[76:77], v91 offset:12288
ds_read_b64_tr_b16 v[78:79], v91 offset:13312
v_mfma_f32_16x16x32_bf16 v[176:179], v[64:67], v[20:23], v[176:179]
ds_read_b128 v[32:35], v89 offset:32768
ds_read_b128 v[36:39], v89 offset:34816
v_mfma_f32_16x16x32_bf16 v[180:183], v[64:67], v[24:27], v[180:183]
ds_read_b128 v[40:43], v89 offset:36864
ds_read_b128 v[44:47], v89 offset:38912
v_mfma_f32_16x16x32_bf16 v[184:187], v[64:67], v[28:31], v[184:187]
s_waitcnt lgkmcnt(8)
v_mfma_f32_16x16x32_bf16 v[188:191], v[68:71], v[16:19], v[188:191]
v_mfma_f32_16x16x32_bf16 v[192:195], v[68:71], v[20:23], v[192:195]
v_mfma_f32_16x16x32_bf16 v[196:199], v[68:71], v[24:27], v[196:199]
v_mfma_f32_16x16x32_bf16 v[200:203], v[68:71], v[28:31], v[200:203]
s_waitcnt lgkmcnt(0)
v_mfma_f32_16x16x32_bf16 v[172:175], v[72:75], v[32:35], v[172:175]
v_mfma_f32_16x16x32_bf16 v[176:179], v[72:75], v[36:39], v[176:179]
v_mfma_f32_16x16x32_bf16 v[180:183], v[72:75], v[40:43], v[180:183]
v_mfma_f32_16x16x32_bf16 v[184:187], v[72:75], v[44:47], v[184:187]
s_waitcnt lgkmcnt(0)
s_barrier
v_mfma_f32_16x16x32_bf16 v[188:191], v[76:79], v[32:35], v[188:191]
ds_read_b128 v[16:19], v2 offset:0
ds_read_b64_tr_b16 v[48:49], v90 offset:16384
ds_read_b64_tr_b16 v[50:51], v90 offset:17408
v_mfma_f32_16x16x32_bf16 v[192:195], v[76:79], v[36:39], v[192:195]
ds_read_b128 v[20:23], v2 offset:2048
ds_read_b128 v[24:27], v2 offset:4096
ds_read_b128 v[28:31], v2 offset:6144
v_mfma_f32_16x16x32_bf16 v[196:199], v[76:79], v[40:43], v[196:199]
ds_read_b64_tr_b16 v[52:53], v91 offset:16384
ds_read_b64_tr_b16 v[54:55], v91 offset:17408
ds_read_b64_tr_b16 v[56:57], v90 offset:20480
v_mfma_f32_16x16x32_bf16 v[200:203], v[76:79], v[44:47], v[200:203]
ds_read_b64_tr_b16 v[58:59], v90 offset:21504
s_mul_i32 s71, s28, 917504
s_add_u32 s71, s71, s66
s_mul_i32 s72, s29, 131072
v_mov_b32 v6, 150528
s_lshl_b32 s73, s61, 8
s_add_u32 s73, s73, 147456
v_lshl_add_u32 v104, v102, 4, s73
s_add_u32 s71, s71, s72
s_mul_i32 s72, s61, 262144
s_add_u32 s71, s71, s72
s_mov_b32 s77, 1
k_cwa:
ds_read_b32 v105, v6 offset:20
s_waitcnt lgkmcnt(0)
v_readfirstlane_b32 s72, v105
s_cmp_lt_u32 s72, 2
s_cbranch_scc1 k_cwa
ds_read_b32 v14, v6
v_lshl_add_u32 v105, v100, 2, s70
ds_read2_b32 v[10:11], v105 offset0:0 offset1:128
ds_read2_b32 v[12:13], v105 offset0:16 offset1:144
ds_read2_b32 v[80:81], v105 offset0:32 offset1:160
ds_read2_b32 v[82:83], v105 offset0:48 offset1:176
ds_read_b128 v[92:95], v104 offset:1024
ds_read_b128 v[244:247], v104 offset:2048
ds_read_b128 v[96:99], v104 offset:1088
ds_read_b128 v[248:251], v104 offset:2112
s_waitcnt lgkmcnt(0)
v_pk_fma_f32 v[236:237], v[92:93], v[10:11], v[244:245] op_sel_hi:[1,0,1] neg_lo:[0,1,0] neg_hi:[0,1,0]
v_pk_fma_f32 v[238:239], v[94:95], v[10:11], v[246:247] op_sel_hi:[1,0,1] neg_lo:[0,1,0] neg_hi:[0,1,0]
v_pk_fma_f32 v[240:241], v[92:93], v[12:13], v[244:245] op_sel_hi:[1,0,1] neg_lo:[0,1,0] neg_hi:[0,1,0]
v_pk_fma_f32 v[242:243], v[94:95], v[12:13], v[246:247] op_sel_hi:[1,0,1] neg_lo:[0,1,0] neg_hi:[0,1,0]
v_pk_fma_f32 v[108:109], v[108:109], v[10:11], v[236:237] op_sel:[0,1,0]
v_pk_fma_f32 v[110:111], v[110:111], v[10:11], v[238:239] op_sel:[0,1,0]
v_pk_fma_f32 v[112:113], v[112:113], v[12:13], v[240:241] op_sel:[0,1,0]
v_pk_fma_f32 v[114:115], v[114:115], v[12:13], v[242:243] op_sel:[0,1,0]
v_pk_fma_f32 v[236:237], v[92:93], v[80:81], v[244:245] op_sel_hi:[1,0,1] neg_lo:[0,1,0] neg_hi:[0,1,0]
v_pk_fma_f32 v[238:239], v[94:95], v[80:81], v[246:247] op_sel_hi:[1,0,1] neg_lo:[0,1,0] neg_hi:[0,1,0]
v_pk_fma_f32 v[240:241], v[92:93], v[82:83], v[244:245] op_sel_hi:[1,0,1] neg_lo:[0,1,0] neg_hi:[0,1,0]
v_pk_fma_f32 v[242:243], v[94:95], v[82:83], v[246:247] op_sel_hi:[1,0,1] neg_lo:[0,1,0] neg_hi:[0,1,0]
v_pk_fma_f32 v[116:117], v[116:117], v[80:81], v[236:237] op_sel:[0,1,0]
v_pk_fma_f32 v[118:119], v[118:119], v[80:81], v[238:239] op_sel:[0,1,0]
v_pk_fma_f32 v[120:121], v[120:121], v[82:83], v[240:241] op_sel:[0,1,0]
v_pk_fma_f32 v[122:123], v[122:123], v[82:83], v[242:243] op_sel:[0,1,0]
v_max_f32 v108, 0, v108
v_max_f32 v109, 0, v109
v_max_f32 v110, 0, v110
v_max_f32 v111, 0, v111
v_max_f32 v112, 0, v112
v_max_f32 v113, 0, v113
v_max_f32 v114, 0, v114
v_max_f32 v115, 0, v115
v_max_f32 v116, 0, v116
v_max_f32 v117, 0, v117
v_max_f32 v118, 0, v118
v_max_f32 v119, 0, v119
v_max_f32 v120, 0, v120
v_max_f32 v121, 0, v121
v_max_f32 v122, 0, v122
v_max_f32 v123, 0, v123
v_pk_mul_f32 v[108:109], v[108:109], v[108:109]
v_pk_mul_f32 v[110:111], v[110:111], v[110:111]
v_pk_mul_f32 v[112:113], v[112:113], v[112:113]
v_pk_mul_f32 v[114:115], v[114:115], v[114:115]
v_pk_mul_f32 v[116:117], v[116:117], v[116:117]
v_pk_mul_f32 v[118:119], v[118:119], v[118:119]
v_pk_mul_f32 v[120:121], v[120:121], v[120:121]
v_pk_mul_f32 v[122:123], v[122:123], v[122:123]
v_pk_fma_f32 v[236:237], v[96:97], v[10:11], v[248:249] op_sel_hi:[1,0,1] neg_lo:[0,1,0] neg_hi:[0,1,0]
v_pk_fma_f32 v[238:239], v[98:99], v[10:11], v[250:251] op_sel_hi:[1,0,1] neg_lo:[0,1,0] neg_hi:[0,1,0]
v_pk_fma_f32 v[240:241], v[96:97], v[12:13], v[248:249] op_sel_hi:[1,0,1] neg_lo:[0,1,0] neg_hi:[0,1,0]
v_pk_fma_f32 v[242:243], v[98:99], v[12:13], v[250:251] op_sel_hi:[1,0,1] neg_lo:[0,1,0] neg_hi:[0,1,0]
v_pk_fma_f32 v[124:125], v[124:125], v[10:11], v[236:237] op_sel:[0,1,0]
v_pk_fma_f32 v[126:127], v[126:127], v[10:11], v[238:239] op_sel:[0,1,0]
v_pk_fma_f32 v[128:129], v[128:129], v[12:13], v[240:241] op_sel:[0,1,0]
v_pk_fma_f32 v[130:131], v[130:131], v[12:13], v[242:243] op_sel:[0,1,0]
v_pk_fma_f32 v[236:237], v[96:97], v[80:81], v[248:249] op_sel_hi:[1,0,1] neg_lo:[0,1,0] neg_hi:[0,1,0]
v_pk_fma_f32 v[238:239], v[98:99], v[80:81], v[250:251] op_sel_hi:[1,0,1] neg_lo:[0,1,0] neg_hi:[0,1,0]
v_pk_fma_f32 v[240:241], v[96:97], v[82:83], v[248:249] op_sel_hi:[1,0,1] neg_lo:[0,1,0] neg_hi:[0,1,0]
v_pk_fma_f32 v[242:243], v[98:99], v[82:83], v[250:251] op_sel_hi:[1,0,1] neg_lo:[0,1,0] neg_hi:[0,1,0]
v_pk_fma_f32 v[132:133], v[132:133], v[80:81], v[236:237] op_sel:[0,1,0]
v_pk_fma_f32 v[134:135], v[134:135], v[80:81], v[238:239] op_sel:[0,1,0]
v_pk_fma_f32 v[136:137], v[136:137], v[82:83], v[240:241] op_sel:[0,1,0]
v_pk_fma_f32 v[138:139], v[138:139], v[82:83], v[242:243] op_sel:[0,1,0]
v_max_f32 v124, 0, v124
v_max_f32 v125, 0, v125
v_max_f32 v126, 0, v126
v_max_f32 v127, 0, v127
v_max_f32 v128, 0, v128
v_max_f32 v129, 0, v129
v_max_f32 v130, 0, v130
v_max_f32 v131, 0, v131
v_max_f32 v132, 0, v132
v_max_f32 v133, 0, v133
v_max_f32 v134, 0, v134
v_max_f32 v135, 0, v135
v_max_f32 v136, 0, v136
v_max_f32 v137, 0, v137
v_max_f32 v138, 0, v138
v_max_f32 v139, 0, v139
v_pk_mul_f32 v[124:125], v[124:125], v[124:125]
v_pk_mul_f32 v[126:127], v[126:127], v[126:127]
v_pk_mul_f32 v[128:129], v[128:129], v[128:129]
v_pk_mul_f32 v[130:131], v[130:131], v[130:131]
v_pk_mul_f32 v[132:133], v[132:133], v[132:133]
v_pk_mul_f32 v[134:135], v[134:135], v[134:135]
v_pk_mul_f32 v[136:137], v[136:137], v[136:137]
v_pk_mul_f32 v[138:139], v[138:139], v[138:139]
s_cmp_eq_u32 s77, 0
s_cbranch_scc1 k_he1a
ds_read_b128 v[92:95], v104 offset:1152
ds_read_b128 v[244:247], v104 offset:2176
ds_read_b128 v[96:99], v104 offset:1216
ds_read_b128 v[248:251], v104 offset:2240
v_cvt_pk_bf16_f32 v108, v108, v109
v_cvt_pk_bf16_f32 v109, v110, v111
v_cvt_pk_bf16_f32 v110, v124, v125
v_cvt_pk_bf16_f32 v111, v126, v127
buffer_store_dwordx4 v[108:111], v101, s[44:47], s71 offen offset:0 sc1
v_cvt_pk_bf16_f32 v112, v112, v113
v_cvt_pk_bf16_f32 v113, v114, v115
v_cvt_pk_bf16_f32 v114, v128, v129
v_cvt_pk_bf16_f32 v115, v130, v131
buffer_store_dwordx4 v[112:115], v101, s[44:47], s71 offen offset:1024 sc1
v_cvt_pk_bf16_f32 v116, v116, v117
v_cvt_pk_bf16_f32 v117, v118, v119
v_cvt_pk_bf16_f32 v118, v132, v133
v_cvt_pk_bf16_f32 v119, v134, v135
buffer_store_dwordx4 v[116:119], v101, s[44:47], s71 offen offset:2048 sc1
v_cvt_pk_bf16_f32 v120, v120, v121
v_cvt_pk_bf16_f32 v121, v122, v123
v_cvt_pk_bf16_f32 v122, v136, v137
v_cvt_pk_bf16_f32 v123, v138, v139
buffer_store_dwordx4 v[120:123], v101, s[44:47], s71 offen offset:3072 sc1
s_add_u32 s71, s71, 131072
s_waitcnt lgkmcnt(0)
v_pk_fma_f32 v[236:237], v[92:93], v[10:11], v[244:245] op_sel_hi:[1,0,1] neg_lo:[0,1,0] neg_hi:[0,1,0]
v_pk_fma_f32 v[238:239], v[94:95], v[10:11], v[246:247] op_sel_hi:[1,0,1] neg_lo:[0,1,0] neg_hi:[0,1,0]
v_pk_fma_f32 v[240:241], v[92:93], v[12:13], v[244:245] op_sel_hi:[1,0,1] neg_lo:[0,1,0] neg_hi:[0,1,0]
v_pk_fma_f32 v[242:243], v[94:95], v[12:13], v[246:247] op_sel_hi:[1,0,1] neg_lo:[0,1,0] neg_hi:[0,1,0]
v_pk_fma_f32 v[140:141], v[140:141], v[10:11], v[236:237] op_sel:[0,1,0]
v_pk_fma_f32 v[142:143], v[142:143], v[10:11], v[238:239] op_sel:[0,1,0]
v_pk_fma_f32 v[144:145], v[144:145], v[12:13], v[240:241] op_sel:[0,1,0]
v_pk_fma_f32 v[146:147], v[146:147], v[12:13], v[242:243] op_sel:[0,1,0]
v_pk_fma_f32 v[236:237], v[92:93], v[80:81], v[244:245] op_sel_hi:[1,0,1] neg_lo:[0,1,0] neg_hi:[0,1,0]
v_pk_fma_f32 v[238:239], v[94:95], v[80:81], v[246:247] op_sel_hi:[1,0,1] neg_lo:[0,1,0] neg_hi:[0,1,0]
v_pk_fma_f32 v[240:241], v[92:93], v[82:83], v[244:245] op_sel_hi:[1,0,1] neg_lo:[0,1,0] neg_hi:[0,1,0]
v_pk_fma_f32 v[242:243], v[94:95], v[82:83], v[246:247] op_sel_hi:[1,0,1] neg_lo:[0,1,0] neg_hi:[0,1,0]
v_pk_fma_f32 v[148:149], v[148:149], v[80:81], v[236:237] op_sel:[0,1,0]
v_pk_fma_f32 v[150:151], v[150:151], v[80:81], v[238:239] op_sel:[0,1,0]
v_pk_fma_f32 v[152:153], v[152:153], v[82:83], v[240:241] op_sel:[0,1,0]
v_pk_fma_f32 v[154:155], v[154:155], v[82:83], v[242:243] op_sel:[0,1,0]
v_max_f32 v140, 0, v140
v_max_f32 v141, 0, v141
v_max_f32 v142, 0, v142
v_max_f32 v143, 0, v143
v_max_f32 v144, 0, v144
v_max_f32 v145, 0, v145
v_max_f32 v146, 0, v146
v_max_f32 v147, 0, v147
v_max_f32 v148, 0, v148
v_max_f32 v149, 0, v149
v_max_f32 v150, 0, v150
v_max_f32 v151, 0, v151
v_max_f32 v152, 0, v152
v_max_f32 v153, 0, v153
v_max_f32 v154, 0, v154
v_max_f32 v155, 0, v155
v_pk_mul_f32 v[140:141], v[140:141], v[140:141]
v_pk_mul_f32 v[142:143], v[142:143], v[142:143]
v_pk_mul_f32 v[144:145], v[144:145], v[144:145]
v_pk_mul_f32 v[146:147], v[146:147], v[146:147]
v_pk_mul_f32 v[148:149], v[148:149], v[148:149]
v_pk_mul_f32 v[150:151], v[150:151], v[150:151]
v_pk_mul_f32 v[152:153], v[152:153], v[152:153]
v_pk_mul_f32 v[154:155], v[154:155], v[154:155]
v_pk_fma_f32 v[236:237], v[96:97], v[10:11], v[248:249] op_sel_hi:[1,0,1] neg_lo:[0,1,0] neg_hi:[0,1,0]
v_pk_fma_f32 v[238:239], v[98:99], v[10:11], v[250:251] op_sel_hi:[1,0,1] neg_lo:[0,1,0] neg_hi:[0,1,0]
v_pk_fma_f32 v[240:241], v[96:97], v[12:13], v[248:249] op_sel_hi:[1,0,1] neg_lo:[0,1,0] neg_hi:[0,1,0]
v_pk_fma_f32 v[242:243], v[98:99], v[12:13], v[250:251] op_sel_hi:[1,0,1] neg_lo:[0,1,0] neg_hi:[0,1,0]
v_pk_fma_f32 v[156:157], v[156:157], v[10:11], v[236:237] op_sel:[0,1,0]
v_pk_fma_f32 v[158:159], v[158:159], v[10:11], v[238:239] op_sel:[0,1,0]
v_pk_fma_f32 v[160:161], v[160:161], v[12:13], v[240:241] op_sel:[0,1,0]
v_pk_fma_f32 v[162:163], v[162:163], v[12:13], v[242:243] op_sel:[0,1,0]
v_pk_fma_f32 v[236:237], v[96:97], v[80:81], v[248:249] op_sel_hi:[1,0,1] neg_lo:[0,1,0] neg_hi:[0,1,0]
v_pk_fma_f32 v[238:239], v[98:99], v[80:81], v[250:251] op_sel_hi:[1,0,1] neg_lo:[0,1,0] neg_hi:[0,1,0]
v_pk_fma_f32 v[240:241], v[96:97], v[82:83], v[248:249] op_sel_hi:[1,0,1] neg_lo:[0,1,0] neg_hi:[0,1,0]
v_pk_fma_f32 v[242:243], v[98:99], v[82:83], v[250:251] op_sel_hi:[1,0,1] neg_lo:[0,1,0] neg_hi:[0,1,0]
v_pk_fma_f32 v[164:165], v[164:165], v[80:81], v[236:237] op_sel:[0,1,0]
v_pk_fma_f32 v[166:167], v[166:167], v[80:81], v[238:239] op_sel:[0,1,0]
v_pk_fma_f32 v[168:169], v[168:169], v[82:83], v[240:241] op_sel:[0,1,0]
v_pk_fma_f32 v[170:171], v[170:171], v[82:83], v[242:243] op_sel:[0,1,0]
v_max_f32 v156, 0, v156
v_max_f32 v157, 0, v157
v_max_f32 v158, 0, v158
v_max_f32 v159, 0, v159
v_max_f32 v160, 0, v160
v_max_f32 v161, 0, v161
v_max_f32 v162, 0, v162
v_max_f32 v163, 0, v163
v_max_f32 v164, 0, v164
v_max_f32 v165, 0, v165
v_max_f32 v166, 0, v166
v_max_f32 v167, 0, v167
v_max_f32 v168, 0, v168
v_max_f32 v169, 0, v169
v_max_f32 v170, 0, v170
v_max_f32 v171, 0, v171
v_pk_mul_f32 v[156:157], v[156:157], v[156:157]
v_pk_mul_f32 v[158:159], v[158:159], v[158:159]
v_pk_mul_f32 v[160:161], v[160:161], v[160:161]
v_pk_mul_f32 v[162:163], v[162:163], v[162:163]
v_pk_mul_f32 v[164:165], v[164:165], v[164:165]
v_pk_mul_f32 v[166:167], v[166:167], v[166:167]
v_pk_mul_f32 v[168:169], v[168:169], v[168:169]
v_pk_mul_f32 v[170:171], v[170:171], v[170:171]
v_cvt_pk_bf16_f32 v140, v140, v141
v_cvt_pk_bf16_f32 v141, v142, v143
v_cvt_pk_bf16_f32 v142, v156, v157
v_cvt_pk_bf16_f32 v143, v158, v159
buffer_store_dwordx4 v[140:143], v101, s[44:47], s71 offen offset:0 sc1
v_cvt_pk_bf16_f32 v144, v144, v145
v_cvt_pk_bf16_f32 v145, v146, v147
v_cvt_pk_bf16_f32 v146, v160, v161
v_cvt_pk_bf16_f32 v147, v162, v163
buffer_store_dwordx4 v[144:147], v101, s[44:47], s71 offen offset:1024 sc1
v_cvt_pk_bf16_f32 v148, v148, v149
v_cvt_pk_bf16_f32 v149, v150, v151
v_cvt_pk_bf16_f32 v150, v164, v165
v_cvt_pk_bf16_f32 v151, v166, v167
buffer_store_dwordx4 v[148:151], v101, s[44:47], s71 offen offset:2048 sc1
v_cvt_pk_bf16_f32 v152, v152, v153
v_cvt_pk_bf16_f32 v153, v154, v155
v_cvt_pk_bf16_f32 v154, v168, v169
v_cvt_pk_bf16_f32 v155, v170, v171
buffer_store_dwordx4 v[152:155], v101, s[44:47], s71 offen offset:3072 sc1
s_branch k_he2a
k_he1a:
v_cvt_pk_bf16_f32 v108, v108, v109
v_cvt_pk_bf16_f32 v109, v110, v111
v_cvt_pk_bf16_f32 v110, v124, v125
v_cvt_pk_bf16_f32 v111, v126, v127
buffer_store_dwordx4 v[108:111], v101, s[44:47], s71 offen offset:0 sc1
v_cvt_pk_bf16_f32 v112, v112, v113
v_cvt_pk_bf16_f32 v113, v114, v115
v_cvt_pk_bf16_f32 v114, v128, v129
v_cvt_pk_bf16_f32 v115, v130, v131
buffer_store_dwordx4 v[112:115], v101, s[44:47], s71 offen offset:1024 sc1
v_cvt_pk_bf16_f32 v116, v116, v117
v_cvt_pk_bf16_f32 v117, v118, v119
v_cvt_pk_bf16_f32 v118, v132, v133
v_cvt_pk_bf16_f32 v119, v134, v135
buffer_store_dwordx4 v[116:119], v101, s[44:47], s71 offen offset:2048 sc1
v_cvt_pk_bf16_f32 v120, v120, v121
v_cvt_pk_bf16_f32 v121, v122, v123
v_cvt_pk_bf16_f32 v122, v136, v137
v_cvt_pk_bf16_f32 v123, v138, v139
buffer_store_dwordx4 v[120:123], v101, s[44:47], s71 offen offset:3072 sc1
k_he2a:
v_mfma_f32_16x16x32_bf16 v[172:175], v[48:51], v[16:19], v[172:175]
ds_read_b64_tr_b16 v[60:61], v91 offset:20480
ds_read_b64_tr_b16 v[62:63], v91 offset:21504
v_mfma_f32_16x16x32_bf16 v[176:179], v[48:51], v[20:23], v[176:179]
ds_read_b128 v[32:35], v3 offset:0
ds_read_b128 v[36:39], v3 offset:2048
v_mfma_f32_16x16x32_bf16 v[180:183], v[48:51], v[24:27], v[180:183]
ds_read_b128 v[40:43], v3 offset:4096
ds_read_b128 v[44:47], v3 offset:6144
v_mfma_f32_16x16x32_bf16 v[184:187], v[48:51], v[28:31], v[184:187]
v_mfma_f32_16x16x32_bf16 v[188:191], v[52:55], v[16:19], v[188:191]
v_mfma_f32_16x16x32_bf16 v[192:195], v[52:55], v[20:23], v[192:195]
v_mfma_f32_16x16x32_bf16 v[196:199], v[52:55], v[24:27], v[196:199]
v_mfma_f32_16x16x32_bf16 v[200:203], v[52:55], v[28:31], v[200:203]
s_waitcnt lgkmcnt(0)
v_mfma_f32_16x16x32_bf16 v[172:175], v[56:59], v[32:35], v[172:175]
v_mfma_f32_16x16x32_bf16 v[176:179], v[56:59], v[36:39], v[176:179]
v_mfma_f32_16x16x32_bf16 v[180:183], v[56:59], v[40:43], v[180:183]
v_mfma_f32_16x16x32_bf16 v[184:187], v[56:59], v[44:47], v[184:187]
s_waitcnt lgkmcnt(0)
s_barrier
v_mfma_f32_16x16x32_bf16 v[188:191], v[60:63], v[32:35], v[188:191]
ds_read_b128 v[16:19], v2 offset:16384
ds_read_b64_tr_b16 v[64:65], v90 offset:24576
ds_read_b64_tr_b16 v[66:67], v90 offset:25600
v_mfma_f32_16x16x32_bf16 v[192:195], v[60:63], v[36:39], v[192:195]
ds_read_b128 v[20:23], v2 offset:18432
ds_read_b128 v[24:27], v2 offset:20480
ds_read_b128 v[28:31], v2 offset:22528
v_mfma_f32_16x16x32_bf16 v[196:199], v[60:63], v[40:43], v[196:199]
ds_read_b64_tr_b16 v[68:69], v91 offset:24576
ds_read_b64_tr_b16 v[70:71], v91 offset:25600
ds_read_b64_tr_b16 v[72:73], v90 offset:28672
v_mfma_f32_16x16x32_bf16 v[200:203], v[60:63], v[44:47], v[200:203]
ds_read_b64_tr_b16 v[74:75], v90 offset:29696
s_waitcnt lgkmcnt(4)
v_mfma_f32_16x16x32_bf16 v[172:175], v[64:67], v[16:19], v[172:175]
ds_read_b64_tr_b16 v[76:77], v91 offset:28672
ds_read_b64_tr_b16 v[78:79], v91 offset:29696
v_mfma_f32_16x16x32_bf16 v[176:179], v[64:67], v[20:23], v[176:179]
ds_read_b128 v[32:35], v3 offset:16384
ds_read_b128 v[36:39], v3 offset:18432
v_mfma_f32_16x16x32_bf16 v[180:183], v[64:67], v[24:27], v[180:183]
ds_read_b128 v[40:43], v3 offset:20480
ds_read_b128 v[44:47], v3 offset:22528
v_mfma_f32_16x16x32_bf16 v[184:187], v[64:67], v[28:31], v[184:187]
s_waitcnt lgkmcnt(8)
v_mfma_f32_16x16x32_bf16 v[188:191], v[68:71], v[16:19], v[188:191]
v_mfma_f32_16x16x32_bf16 v[192:195], v[68:71], v[20:23], v[192:195]
v_mfma_f32_16x16x32_bf16 v[196:199], v[68:71], v[24:27], v[196:199]
v_mfma_f32_16x16x32_bf16 v[200:203], v[68:71], v[28:31], v[200:203]
s_waitcnt lgkmcnt(0)
v_mfma_f32_16x16x32_bf16 v[172:175], v[72:75], v[32:35], v[172:175]
v_mfma_f32_16x16x32_bf16 v[176:179], v[72:75], v[36:39], v[176:179]
v_mfma_f32_16x16x32_bf16 v[180:183], v[72:75], v[40:43], v[180:183]
v_mfma_f32_16x16x32_bf16 v[184:187], v[72:75], v[44:47], v[184:187]
s_waitcnt lgkmcnt(0)
s_barrier
v_mfma_f32_16x16x32_bf16 v[188:191], v[76:79], v[32:35], v[188:191]
ds_read_b128 v[16:19], v2 offset:32768
ds_read_b64_tr_b16 v[48:49], v90 offset:32768
ds_read_b64_tr_b16 v[50:51], v90 offset:33792
v_mfma_f32_16x16x32_bf16 v[192:195], v[76:79], v[36:39], v[192:195]
ds_read_b128 v[20:23], v2 offset:34816
ds_read_b128 v[24:27], v2 offset:36864
ds_read_b128 v[28:31], v2 offset:38912
v_mfma_f32_16x16x32_bf16 v[196:199], v[76:79], v[40:43], v[196:199]
ds_read_b64_tr_b16 v[52:53], v91 offset:32768
ds_read_b64_tr_b16 v[54:55], v91 offset:33792
ds_read_b64_tr_b16 v[56:57], v90 offset:36864
v_mfma_f32_16x16x32_bf16 v[200:203], v[76:79], v[44:47], v[200:203]
ds_read_b64_tr_b16 v[58:59], v90 offset:37888
s_waitcnt lgkmcnt(4)
v_mfma_f32_16x16x32_bf16 v[172:175], v[48:51], v[16:19], v[172:175]
ds_read_b64_tr_b16 v[60:61], v91 offset:36864
ds_read_b64_tr_b16 v[62:63], v91 offset:37888
v_mfma_f32_16x16x32_bf16 v[176:179], v[48:51], v[20:23], v[176:179]
ds_read_b128 v[32:35], v3 offset:32768
ds_read_b128 v[36:39], v3 offset:34816
v_mfma_f32_16x16x32_bf16 v[180:183], v[48:51], v[24:27], v[180:183]
ds_read_b128 v[40:43], v3 offset:36864
ds_read_b128 v[44:47], v3 offset:38912
v_mfma_f32_16x16x32_bf16 v[184:187], v[48:51], v[28:31], v[184:187]
s_waitcnt lgkmcnt(8)
v_mfma_f32_16x16x32_bf16 v[188:191], v[52:55], v[16:19], v[188:191]
v_mfma_f32_16x16x32_bf16 v[192:195], v[52:55], v[20:23], v[192:195]
v_mfma_f32_16x16x32_bf16 v[196:199], v[52:55], v[24:27], v[196:199]
v_mfma_f32_16x16x32_bf16 v[200:203], v[52:55], v[28:31], v[200:203]
s_waitcnt lgkmcnt(0)
v_mfma_f32_16x16x32_bf16 v[172:175], v[56:59], v[32:35], v[172:175]
v_mfma_f32_16x16x32_bf16 v[176:179], v[56:59], v[36:39], v[176:179]
v_mfma_f32_16x16x32_bf16 v[180:183], v[56:59], v[40:43], v[180:183]
v_mfma_f32_16x16x32_bf16 v[184:187], v[56:59], v[44:47], v[184:187]
s_waitcnt lgkmcnt(0)
s_barrier
v_mfma_f32_16x16x32_bf16 v[188:191], v[60:63], v[32:35], v[188:191]
ds_read_b128 v[16:19], v88 offset:0
ds_read_b64_tr_b16 v[64:65], v90 offset:40960
ds_read_b64_tr_b16 v[66:67], v90 offset:41984
v_mfma_f32_16x16x32_bf16 v[192:195], v[60:63], v[36:39], v[192:195]
ds_read_b128 v[20:23], v88 offset:2048
ds_read_b128 v[24:27], v88 offset:4096
ds_read_b128 v[28:31], v88 offset:6144
v_mfma_f32_16x16x32_bf16 v[196:199], v[60:63], v[40:43], v[196:199]
ds_read_b64_tr_b16 v[68:69], v91 offset:40960
ds_read_b64_tr_b16 v[70:71], v91 offset:41984
ds_read_b64_tr_b16 v[72:73], v90 offset:45056
v_mfma_f32_16x16x32_bf16 v[200:203], v[60:63], v[44:47], v[200:203]
ds_read_b64_tr_b16 v[74:75], v90 offset:46080
s_waitcnt lgkmcnt(4)
v_mfma_f32_16x16x32_bf16 v[172:175], v[64:67], v[16:19], v[172:175]
ds_read_b64_tr_b16 v[76:77], v91 offset:45056
ds_read_b64_tr_b16 v[78:79], v91 offset:46080
v_mfma_f32_16x16x32_bf16 v[176:179], v[64:67], v[20:23], v[176:179]
ds_read_b128 v[32:35], v89 offset:0
ds_read_b128 v[36:39], v89 offset:2048
v_mfma_f32_16x16x32_bf16 v[180:183], v[64:67], v[24:27], v[180:183]
ds_read_b128 v[40:43], v89 offset:4096
ds_read_b128 v[44:47], v89 offset:6144
v_mfma_f32_16x16x32_bf16 v[184:187], v[64:67], v[28:31], v[184:187]
s_waitcnt lgkmcnt(8)
v_mfma_f32_16x16x32_bf16 v[188:191], v[68:71], v[16:19], v[188:191]
v_mfma_f32_16x16x32_bf16 v[192:195], v[68:71], v[20:23], v[192:195]
v_mfma_f32_16x16x32_bf16 v[196:199], v[68:71], v[24:27], v[196:199]
v_mfma_f32_16x16x32_bf16 v[200:203], v[68:71], v[28:31], v[200:203]
s_waitcnt lgkmcnt(0)
v_mfma_f32_16x16x32_bf16 v[172:175], v[72:75], v[32:35], v[172:175]
v_mfma_f32_16x16x32_bf16 v[176:179], v[72:75], v[36:39], v[176:179]
v_mfma_f32_16x16x32_bf16 v[180:183], v[72:75], v[40:43], v[180:183]
v_mfma_f32_16x16x32_bf16 v[184:187], v[72:75], v[44:47], v[184:187]
s_waitcnt lgkmcnt(0)
s_barrier
s_lshl_b32 s72, s27, 1
s_add_u32 s72, s72, s61
s_lshr_b32 s73, s72, 3
s_lshl_b32 s73, s73, 7
s_and_b32 s72, s72, 7
s_lshl_b32 s72, s72, 2
s_add_u32 s72, s72, s73
s_lshl_b32 s73, s60, 9
s_add_u32 s72, s72, s73
s_add_u32 s72, s72, 12402688
s_waitcnt vmcnt(0)
s_mov_b64 exec, 1
buffer_store_dword v14, v15, s[44:47], s72 offen sc1
s_mov_b64 exec, -1
v_mfma_f32_16x16x32_bf16 v[188:191], v[76:79], v[32:35], v[188:191]
v_mfma_f32_16x16x32_bf16 v[192:195], v[76:79], v[36:39], v[192:195]
v_mfma_f32_16x16x32_bf16 v[196:199], v[76:79], v[40:43], v[196:199]
v_mfma_f32_16x16x32_bf16 v[200:203], v[76:79], v[44:47], v[200:203]
s_lshl_b32 s72, s61, 7
s_add_u32 s72, s72, 148992
v_lshl_add_u32 v104, v102, 4, s72
ds_read_b128 v[92:95], v104
ds_read_b128 v[96:99], v104 offset:64
s_waitcnt lgkmcnt(0)
v_pk_mul_f32 v[236:237], v[92:93], v[10:11] op_sel_hi:[1,0] neg_lo:[0,1] neg_hi:[0,1]
v_pk_mul_f32 v[238:239], v[94:95], v[10:11] op_sel_hi:[1,0] neg_lo:[0,1] neg_hi:[0,1]
v_pk_mul_f32 v[240:241], v[92:93], v[12:13] op_sel_hi:[1,0] neg_lo:[0,1] neg_hi:[0,1]
v_pk_mul_f32 v[242:243], v[94:95], v[12:13] op_sel_hi:[1,0] neg_lo:[0,1] neg_hi:[0,1]
v_pk_fma_f32 v[236:237], v[172:173], v[10:11], v[236:237] op_sel:[0,1,0]
v_pk_fma_f32 v[238:239], v[174:175], v[10:11], v[238:239] op_sel:[0,1,0]
v_pk_fma_f32 v[240:241], v[176:177], v[12:13], v[240:241] op_sel:[0,1,0]
v_pk_fma_f32 v[242:243], v[178:179], v[12:13], v[242:243] op_sel:[0,1,0]
v_pk_mul_f32 v[244:245], v[236:237], s[62:63]
v_pk_mul_f32 v[246:247], v[238:239], s[62:63]
v_pk_mul_f32 v[248:249], v[240:241], s[62:63]
v_pk_mul_f32 v[250:251], v[242:243], s[62:63]
v_pk_add_f32 v[236:237], v[236:237], 1.0 op_sel_hi:[1,0]
v_pk_add_f32 v[238:239], v[238:239], 1.0 op_sel_hi:[1,0]
v_pk_add_f32 v[240:241], v[240:241], 1.0 op_sel_hi:[1,0]
v_pk_add_f32 v[242:243], v[242:243], 1.0 op_sel_hi:[1,0]
v_exp_f32 v244, v244
v_exp_f32 v245, v245
v_exp_f32 v246, v246
v_exp_f32 v247, v247
v_exp_f32 v248, v248
v_exp_f32 v249, v249
v_exp_f32 v250, v250
v_exp_f32 v251, v251
v_med3_f32 v236, v244, v236, 1.0
v_med3_f32 v237, v245, v237, 1.0
v_med3_f32 v238, v246, v238, 1.0
v_med3_f32 v239, v247, v239, 1.0
v_med3_f32 v240, v248, v240, 1.0
v_med3_f32 v241, v249, v241, 1.0
v_med3_f32 v242, v250, v242, 1.0
v_med3_f32 v243, v251, v243, 1.0
v_pk_add_f32 v[236:237], v[236:237], s[64:65]
v_pk_add_f32 v[238:239], v[238:239], s[64:65]
v_pk_add_f32 v[240:241], v[240:241], s[64:65]
v_pk_add_f32 v[242:243], v[242:243], s[64:65]
v_cvt_pk_bf16_f32 v204, v236, v237
v_cvt_pk_bf16_f32 v205, v238, v239
v_cvt_pk_bf16_f32 v206, v240, v241
v_cvt_pk_bf16_f32 v207, v242, v243
v_pk_mul_f32 v[236:237], v[92:93], v[80:81] op_sel_hi:[1,0] neg_lo:[0,1] neg_hi:[0,1]
v_pk_mul_f32 v[238:239], v[94:95], v[80:81] op_sel_hi:[1,0] neg_lo:[0,1] neg_hi:[0,1]
v_pk_mul_f32 v[240:241], v[92:93], v[82:83] op_sel_hi:[1,0] neg_lo:[0,1] neg_hi:[0,1]
v_pk_mul_f32 v[242:243], v[94:95], v[82:83] op_sel_hi:[1,0] neg_lo:[0,1] neg_hi:[0,1]
v_pk_fma_f32 v[236:237], v[180:181], v[80:81], v[236:237] op_sel:[0,1,0]
v_pk_fma_f32 v[238:239], v[182:183], v[80:81], v[238:239] op_sel:[0,1,0]
v_pk_fma_f32 v[240:241], v[184:185], v[82:83], v[240:241] op_sel:[0,1,0]
v_pk_fma_f32 v[242:243], v[186:187], v[82:83], v[242:243] op_sel:[0,1,0]
v_pk_mul_f32 v[244:245], v[236:237], s[62:63]
v_pk_mul_f32 v[246:247], v[238:239], s[62:63]
v_pk_mul_f32 v[248:249], v[240:241], s[62:63]
v_pk_mul_f32 v[250:251], v[242:243], s[62:63]
v_pk_add_f32 v[236:237], v[236:237], 1.0 op_sel_hi:[1,0]
v_pk_add_f32 v[238:239], v[238:239], 1.0 op_sel_hi:[1,0]
v_pk_add_f32 v[240:241], v[240:241], 1.0 op_sel_hi:[1,0]
v_pk_add_f32 v[242:243], v[242:243], 1.0 op_sel_hi:[1,0]
v_exp_f32 v244, v244
v_exp_f32 v245, v245
v_exp_f32 v246, v246
v_exp_f32 v247, v247
v_exp_f32 v248, v248
v_exp_f32 v249, v249
v_exp_f32 v250, v250
v_exp_f32 v251, v251
v_med3_f32 v236, v244, v236, 1.0
v_med3_f32 v237, v245, v237, 1.0
v_med3_f32 v238, v246, v238, 1.0
v_med3_f32 v239, v247, v239, 1.0
v_med3_f32 v240, v248, v240, 1.0
v_med3_f32 v241, v249, v241, 1.0
v_med3_f32 v242, v250, v242, 1.0
v_med3_f32 v243, v251, v243, 1.0
v_pk_add_f32 v[236:237], v[236:237], s[64:65]
v_pk_add_f32 v[238:239], v[238:239], s[64:65]
v_pk_add_f32 v[240:241], v[240:241], s[64:65]
v_pk_add_f32 v[242:243], v[242:243], s[64:65]
v_cvt_pk_bf16_f32 v208, v236, v237
v_cvt_pk_bf16_f32 v209, v238, v239
v_cvt_pk_bf16_f32 v210, v240, v241
v_cvt_pk_bf16_f32 v211, v242, v243
v_pk_mul_f32 v[236:237], v[96:97], v[10:11] op_sel_hi:[1,0] neg_lo:[0,1] neg_hi:[0,1]
v_pk_mul_f32 v[238:239], v[98:99], v[10:11] op_sel_hi:[1,0] neg_lo:[0,1] neg_hi:[0,1]
v_pk_mul_f32 v[240:241], v[96:97], v[12:13] op_sel_hi:[1,0] neg_lo:[0,1] neg_hi:[0,1]
v_pk_mul_f32 v[242:243], v[98:99], v[12:13] op_sel_hi:[1,0] neg_lo:[0,1] neg_hi:[0,1]
v_pk_fma_f32 v[236:237], v[188:189], v[10:11], v[236:237] op_sel:[0,1,0]
v_pk_fma_f32 v[238:239], v[190:191], v[10:11], v[238:239] op_sel:[0,1,0]
v_pk_fma_f32 v[240:241], v[192:193], v[12:13], v[240:241] op_sel:[0,1,0]
v_pk_fma_f32 v[242:243], v[194:195], v[12:13], v[242:243] op_sel:[0,1,0]
v_pk_mul_f32 v[244:245], v[236:237], s[62:63]
v_pk_mul_f32 v[246:247], v[238:239], s[62:63]
v_pk_mul_f32 v[248:249], v[240:241], s[62:63]
v_pk_mul_f32 v[250:251], v[242:243], s[62:63]
v_pk_add_f32 v[236:237], v[236:237], 1.0 op_sel_hi:[1,0]
v_pk_add_f32 v[238:239], v[238:239], 1.0 op_sel_hi:[1,0]
v_pk_add_f32 v[240:241], v[240:241], 1.0 op_sel_hi:[1,0]
v_pk_add_f32 v[242:243], v[242:243], 1.0 op_sel_hi:[1,0]
v_exp_f32 v244, v244
v_exp_f32 v245, v245
v_exp_f32 v246, v246
v_exp_f32 v247, v247
v_exp_f32 v248, v248
v_exp_f32 v249, v249
v_exp_f32 v250, v250
v_exp_f32 v251, v251
v_med3_f32 v236, v244, v236, 1.0
v_med3_f32 v237, v245, v237, 1.0
v_med3_f32 v238, v246, v238, 1.0
v_med3_f32 v239, v247, v239, 1.0
v_med3_f32 v240, v248, v240, 1.0
v_med3_f32 v241, v249, v241, 1.0
v_med3_f32 v242, v250, v242, 1.0
v_med3_f32 v243, v251, v243, 1.0
v_pk_add_f32 v[236:237], v[236:237], s[64:65]
v_pk_add_f32 v[238:239], v[238:239], s[64:65]
v_pk_add_f32 v[240:241], v[240:241], s[64:65]
v_pk_add_f32 v[242:243], v[242:243], s[64:65]
v_cvt_pk_bf16_f32 v212, v236, v237
v_cvt_pk_bf16_f32 v213, v238, v239
v_cvt_pk_bf16_f32 v214, v240, v241
v_cvt_pk_bf16_f32 v215, v242, v243
v_pk_mul_f32 v[236:237], v[96:97], v[80:81] op_sel_hi:[1,0] neg_lo:[0,1] neg_hi:[0,1]
v_pk_mul_f32 v[238:239], v[98:99], v[80:81] op_sel_hi:[1,0] neg_lo:[0,1] neg_hi:[0,1]
v_pk_mul_f32 v[240:241], v[96:97], v[82:83] op_sel_hi:[1,0] neg_lo:[0,1] neg_hi:[0,1]
v_pk_mul_f32 v[242:243], v[98:99], v[82:83] op_sel_hi:[1,0] neg_lo:[0,1] neg_hi:[0,1]
v_pk_fma_f32 v[236:237], v[196:197], v[80:81], v[236:237] op_sel:[0,1,0]
v_pk_fma_f32 v[238:239], v[198:199], v[80:81], v[238:239] op_sel:[0,1,0]
v_pk_fma_f32 v[240:241], v[200:201], v[82:83], v[240:241] op_sel:[0,1,0]
v_pk_fma_f32 v[242:243], v[202:203], v[82:83], v[242:243] op_sel:[0,1,0]
v_pk_mul_f32 v[244:245], v[236:237], s[62:63]
v_pk_mul_f32 v[246:247], v[238:239], s[62:63]
v_pk_mul_f32 v[248:249], v[240:241], s[62:63]
v_pk_mul_f32 v[250:251], v[242:243], s[62:63]
v_pk_add_f32 v[236:237], v[236:237], 1.0 op_sel_hi:[1,0]
v_pk_add_f32 v[238:239], v[238:239], 1.0 op_sel_hi:[1,0]
v_pk_add_f32 v[240:241], v[240:241], 1.0 op_sel_hi:[1,0]
v_pk_add_f32 v[242:243], v[242:243], 1.0 op_sel_hi:[1,0]
v_exp_f32 v244, v244
v_exp_f32 v245, v245
v_exp_f32 v246, v246
v_exp_f32 v247, v247
v_exp_f32 v248, v248
v_exp_f32 v249, v249
v_exp_f32 v250, v250
v_exp_f32 v251, v251
v_med3_f32 v236, v244, v236, 1.0
v_med3_f32 v237, v245, v237, 1.0
v_med3_f32 v238, v246, v238, 1.0
v_med3_f32 v239, v247, v239, 1.0
v_med3_f32 v240, v248, v240, 1.0
v_med3_f32 v241, v249, v241, 1.0
v_med3_f32 v242, v250, v242, 1.0
v_med3_f32 v243, v251, v243, 1.0
v_pk_add_f32 v[236:237], v[236:237], s[64:65]
v_pk_add_f32 v[238:239], v[238:239], s[64:65]
v_pk_add_f32 v[240:241], v[240:241], s[64:65]
v_pk_add_f32 v[242:243], v[242:243], s[64:65]
v_cvt_pk_bf16_f32 v216, v236, v237
v_cvt_pk_bf16_f32 v217, v238, v239
v_cvt_pk_bf16_f32 v218, v240, v241
v_cvt_pk_bf16_f32 v219, v242, v243
v_mov_b32 v84, v204
v_mov_b32 v85, v205
v_mov_b32 v86, v206
v_mov_b32 v87, v207
v_mov_b32 v88, v208
v_mov_b32 v89, v209
v_mov_b32 v90, v210
v_mov_b32 v91, v211
v_mov_b32 v92, v212
v_mov_b32 v93, v213
v_mov_b32 v94, v214
v_mov_b32 v95, v215
v_mov_b32 v96, v216
v_mov_b32 v97, v217
v_mov_b32 v98, v218
v_mov_b32 v99, v219
v_readfirstlane_b32 s79, v14
s_branch k_ph2
k_p2kv:
ds_read_b128 v[16:19], v2 offset:32768
ds_read_b64_tr_b16 v[48:49], v90 offset:32768
ds_read_b64_tr_b16 v[50:51], v90 offset:33792
ds_read_b128 v[20:23], v2 offset:34816
ds_read_b128 v[24:27], v2 offset:36864
ds_read_b128 v[28:31], v2 offset:38912
ds_read_b64_tr_b16 v[52:53], v91 offset:32768
ds_read_b64_tr_b16 v[54:55], v91 offset:33792
ds_read_b64_tr_b16 v[56:57], v90 offset:34816
ds_read_b64_tr_b16 v[58:59], v90 offset:35840
s_waitcnt lgkmcnt(4)
v_mfma_f32_16x16x32_bf16 v[172:175], v[16:19], v[48:51], 0
ds_read_b64_tr_b16 v[60:61], v91 offset:34816
ds_read_b64_tr_b16 v[62:63], v91 offset:35840
v_mfma_f32_16x16x32_bf16 v[176:179], v[20:23], v[48:51], 0
ds_read_b128 v[32:35], v3 offset:32768
ds_read_b128 v[36:39], v3 offset:34816
v_mfma_f32_16x16x32_bf16 v[180:183], v[24:27], v[48:51], 0
ds_read_b128 v[40:43], v3 offset:36864
ds_read_b128 v[44:47], v3 offset:38912
v_mfma_f32_16x16x32_bf16 v[184:187], v[28:31], v[48:51], 0
s_waitcnt lgkmcnt(8)
v_mfma_f32_16x16x32_bf16 v[188:191], v[16:19], v[52:55], 0
ds_read_b64_tr_b16 v[64:65], v90 offset:40960
v_mfma_f32_16x16x32_bf16 v[192:195], v[20:23], v[52:55], 0
ds_read_b64_tr_b16 v[66:67], v90 offset:41984
v_mfma_f32_16x16x32_bf16 v[196:199], v[24:27], v[52:55], 0
v_mfma_f32_16x16x32_bf16 v[200:203], v[28:31], v[52:55], 0
s_waitcnt lgkmcnt(8)
v_mfma_f32_16x16x32_bf16 v[204:207], v[16:19], v[56:59], 0
ds_read_b64_tr_b16 v[68:69], v91 offset:40960
v_mfma_f32_16x16x32_bf16 v[208:211], v[20:23], v[56:59], 0
ds_read_b64_tr_b16 v[70:71], v91 offset:41984
v_mfma_f32_16x16x32_bf16 v[212:215], v[24:27], v[56:59], 0
v_mfma_f32_16x16x32_bf16 v[216:219], v[28:31], v[56:59], 0
s_waitcnt lgkmcnt(8)
v_mfma_f32_16x16x32_bf16 v[220:223], v[16:19], v[60:63], 0
ds_read_b64_tr_b16 v[72:73], v90 offset:43008
v_mfma_f32_16x16x32_bf16 v[224:227], v[20:23], v[60:63], 0
ds_read_b64_tr_b16 v[74:75], v90 offset:44032
v_mfma_f32_16x16x32_bf16 v[228:231], v[24:27], v[60:63], 0
v_mfma_f32_16x16x32_bf16 v[232:235], v[28:31], v[60:63], 0
s_waitcnt lgkmcnt(4)
v_mfma_f32_16x16x32_bf16 v[172:175], v[32:35], v[64:67], v[172:175]
ds_read_b64_tr_b16 v[76:77], v91 offset:43008
v_mfma_f32_16x16x32_bf16 v[176:179], v[36:39], v[64:67], v[176:179]
ds_read_b64_tr_b16 v[78:79], v91 offset:44032
v_mfma_f32_16x16x32_bf16 v[180:183], v[40:43], v[64:67], v[180:183]
v_mfma_f32_16x16x32_bf16 v[184:187], v[44:47], v[64:67], v[184:187]
s_waitcnt lgkmcnt(4)
v_mfma_f32_16x16x32_bf16 v[188:191], v[32:35], v[68:71], v[188:191]
v_mfma_f32_16x16x32_bf16 v[192:195], v[36:39], v[68:71], v[192:195]
v_mfma_f32_16x16x32_bf16 v[196:199], v[40:43], v[68:71], v[196:199]
v_mfma_f32_16x16x32_bf16 v[200:203], v[44:47], v[68:71], v[200:203]
s_waitcnt lgkmcnt(0)
s_barrier
v_mfma_f32_16x16x32_bf16 v[204:207], v[32:35], v[72:75], v[204:207]
ds_read_b128 v[16:19], v88 offset:0
ds_read_b64_tr_b16 v[48:49], v90 offset:0
v_mfma_f32_16x16x32_bf16 v[208:211], v[36:39], v[72:75], v[208:211]
ds_read_b64_tr_b16 v[50:51], v90 offset:1024
ds_read_b128 v[20:23], v88 offset:2048
v_mfma_f32_16x16x32_bf16 v[212:215], v[40:43], v[72:75], v[212:215]
ds_read_b128 v[24:27], v88 offset:4096
v_mfma_f32_16x16x32_bf16 v[216:219], v[44:47], v[72:75], v[216:219]
v_mfma_f32_16x16x32_bf16 v[220:223], v[32:35], v[76:79], v[220:223]
ds_read_b128 v[28:31], v88 offset:6144
ds_read_b64_tr_b16 v[52:53], v91 offset:0
v_mfma_f32_16x16x32_bf16 v[224:227], v[36:39], v[76:79], v[224:227]
ds_read_b64_tr_b16 v[54:55], v91 offset:1024
ds_read_b64_tr_b16 v[56:57], v90 offset:2048
v_mfma_f32_16x16x32_bf16 v[228:231], v[40:43], v[76:79], v[228:231]
ds_read_b64_tr_b16 v[58:59], v90 offset:3072
v_mfma_f32_16x16x32_bf16 v[232:235], v[44:47], v[76:79], v[232:235]
s_waitcnt lgkmcnt(4)
v_mfma_f32_16x16x32_bf16 v[172:175], v[16:19], v[48:51], v[172:175]
ds_read_b64_tr_b16 v[60:61], v91 offset:2048
ds_read_b64_tr_b16 v[62:63], v91 offset:3072
v_mfma_f32_16x16x32_bf16 v[176:179], v[20:23], v[48:51], v[176:179]
ds_read_b128 v[32:35], v89 offset:0
ds_read_b128 v[36:39], v89 offset:2048
v_mfma_f32_16x16x32_bf16 v[180:183], v[24:27], v[48:51], v[180:183]
ds_read_b128 v[40:43], v89 offset:4096
ds_read_b128 v[44:47], v89 offset:6144
v_mfma_f32_16x16x32_bf16 v[184:187], v[28:31], v[48:51], v[184:187]
s_waitcnt lgkmcnt(8)
v_mfma_f32_16x16x32_bf16 v[188:191], v[16:19], v[52:55], v[188:191]
ds_read_b64_tr_b16 v[64:65], v90 offset:8192
v_mfma_f32_16x16x32_bf16 v[192:195], v[20:23], v[52:55], v[192:195]
ds_read_b64_tr_b16 v[66:67], v90 offset:9216
v_mfma_f32_16x16x32_bf16 v[196:199], v[24:27], v[52:55], v[196:199]
v_mfma_f32_16x16x32_bf16 v[200:203], v[28:31], v[52:55], v[200:203]
s_waitcnt lgkmcnt(8)
v_mfma_f32_16x16x32_bf16 v[204:207], v[16:19], v[56:59], v[204:207]
ds_read_b64_tr_b16 v[68:69], v91 offset:8192
v_mfma_f32_16x16x32_bf16 v[208:211], v[20:23], v[56:59], v[208:211]
ds_read_b64_tr_b16 v[70:71], v91 offset:9216
v_mfma_f32_16x16x32_bf16 v[212:215], v[24:27], v[56:59], v[212:215]
v_mfma_f32_16x16x32_bf16 v[216:219], v[28:31], v[56:59], v[216:219]
s_waitcnt lgkmcnt(8)
v_mfma_f32_16x16x32_bf16 v[220:223], v[16:19], v[60:63], v[220:223]
ds_read_b64_tr_b16 v[72:73], v90 offset:10240
v_mfma_f32_16x16x32_bf16 v[224:227], v[20:23], v[60:63], v[224:227]
ds_read_b64_tr_b16 v[74:75], v90 offset:11264
v_mfma_f32_16x16x32_bf16 v[228:231], v[24:27], v[60:63], v[228:231]
v_mfma_f32_16x16x32_bf16 v[232:235], v[28:31], v[60:63], v[232:235]
s_waitcnt lgkmcnt(4)
v_mfma_f32_16x16x32_bf16 v[172:175], v[32:35], v[64:67], v[172:175]
ds_read_b64_tr_b16 v[76:77], v91 offset:10240
v_mfma_f32_16x16x32_bf16 v[176:179], v[36:39], v[64:67], v[176:179]
ds_read_b64_tr_b16 v[78:79], v91 offset:11264
v_mfma_f32_16x16x32_bf16 v[180:183], v[40:43], v[64:67], v[180:183]
v_mfma_f32_16x16x32_bf16 v[184:187], v[44:47], v[64:67], v[184:187]
s_waitcnt lgkmcnt(4)
v_mfma_f32_16x16x32_bf16 v[188:191], v[32:35], v[68:71], v[188:191]
v_mfma_f32_16x16x32_bf16 v[192:195], v[36:39], v[68:71], v[192:195]
v_mfma_f32_16x16x32_bf16 v[196:199], v[40:43], v[68:71], v[196:199]
v_mfma_f32_16x16x32_bf16 v[200:203], v[44:47], v[68:71], v[200:203]
s_waitcnt lgkmcnt(0)
s_barrier
v_mfma_f32_16x16x32_bf16 v[204:207], v[32:35], v[72:75], v[204:207]
ds_read_b128 v[16:19], v88 offset:16384
ds_read_b64_tr_b16 v[48:49], v90 offset:16384
v_mfma_f32_16x16x32_bf16 v[208:211], v[36:39], v[72:75], v[208:211]
ds_read_b64_tr_b16 v[50:51], v90 offset:17408
ds_read_b128 v[20:23], v88 offset:18432
v_mfma_f32_16x16x32_bf16 v[212:215], v[40:43], v[72:75], v[212:215]
ds_read_b128 v[24:27], v88 offset:20480
v_mfma_f32_16x16x32_bf16 v[216:219], v[44:47], v[72:75], v[216:219]
v_mfma_f32_16x16x32_bf16 v[220:223], v[32:35], v[76:79], v[220:223]
ds_read_b128 v[28:31], v88 offset:22528
ds_read_b64_tr_b16 v[52:53], v91 offset:16384
v_mfma_f32_16x16x32_bf16 v[224:227], v[36:39], v[76:79], v[224:227]
ds_read_b64_tr_b16 v[54:55], v91 offset:17408
ds_read_b64_tr_b16 v[56:57], v90 offset:18432
v_mfma_f32_16x16x32_bf16 v[228:231], v[40:43], v[76:79], v[228:231]
ds_read_b64_tr_b16 v[58:59], v90 offset:19456
v_mfma_f32_16x16x32_bf16 v[232:235], v[44:47], v[76:79], v[232:235]
s_waitcnt lgkmcnt(4)
v_mfma_f32_16x16x32_bf16 v[172:175], v[16:19], v[48:51], v[172:175]
ds_read_b64_tr_b16 v[60:61], v91 offset:18432
ds_read_b64_tr_b16 v[62:63], v91 offset:19456
v_mfma_f32_16x16x32_bf16 v[176:179], v[20:23], v[48:51], v[176:179]
ds_read_b128 v[32:35], v89 offset:16384
ds_read_b128 v[36:39], v89 offset:18432
v_mfma_f32_16x16x32_bf16 v[180:183], v[24:27], v[48:51], v[180:183]
ds_read_b128 v[40:43], v89 offset:20480
ds_read_b128 v[44:47], v89 offset:22528
v_mfma_f32_16x16x32_bf16 v[184:187], v[28:31], v[48:51], v[184:187]
s_waitcnt lgkmcnt(8)
v_mfma_f32_16x16x32_bf16 v[188:191], v[16:19], v[52:55], v[188:191]
ds_read_b64_tr_b16 v[64:65], v90 offset:24576
v_mfma_f32_16x16x32_bf16 v[192:195], v[20:23], v[52:55], v[192:195]
ds_read_b64_tr_b16 v[66:67], v90 offset:25600
v_mfma_f32_16x16x32_bf16 v[196:199], v[24:27], v[52:55], v[196:199]
v_mfma_f32_16x16x32_bf16 v[200:203], v[28:31], v[52:55], v[200:203]
s_waitcnt lgkmcnt(8)
v_mfma_f32_16x16x32_bf16 v[204:207], v[16:19], v[56:59], v[204:207]
ds_read_b64_tr_b16 v[68:69], v91 offset:24576
v_mfma_f32_16x16x32_bf16 v[208:211], v[20:23], v[56:59], v[208:211]
ds_read_b64_tr_b16 v[70:71], v91 offset:25600
v_mfma_f32_16x16x32_bf16 v[212:215], v[24:27], v[56:59], v[212:215]
v_mfma_f32_16x16x32_bf16 v[216:219], v[28:31], v[56:59], v[216:219]
s_waitcnt lgkmcnt(8)
v_mfma_f32_16x16x32_bf16 v[220:223], v[16:19], v[60:63], v[220:223]
ds_read_b64_tr_b16 v[72:73], v90 offset:26624
v_mfma_f32_16x16x32_bf16 v[224:227], v[20:23], v[60:63], v[224:227]
ds_read_b64_tr_b16 v[74:75], v90 offset:27648
v_mfma_f32_16x16x32_bf16 v[228:231], v[24:27], v[60:63], v[228:231]
v_mfma_f32_16x16x32_bf16 v[232:235], v[28:31], v[60:63], v[232:235]
s_waitcnt lgkmcnt(4)
v_mfma_f32_16x16x32_bf16 v[172:175], v[32:35], v[64:67], v[172:175]
ds_read_b64_tr_b16 v[76:77], v91 offset:26624
v_mfma_f32_16x16x32_bf16 v[176:179], v[36:39], v[64:67], v[176:179]
ds_read_b64_tr_b16 v[78:79], v91 offset:27648
v_mfma_f32_16x16x32_bf16 v[180:183], v[40:43], v[64:67], v[180:183]
v_mfma_f32_16x16x32_bf16 v[184:187], v[44:47], v[64:67], v[184:187]
s_waitcnt lgkmcnt(4)
v_mfma_f32_16x16x32_bf16 v[188:191], v[32:35], v[68:71], v[188:191]
v_mfma_f32_16x16x32_bf16 v[192:195], v[36:39], v[68:71], v[192:195]
v_mfma_f32_16x16x32_bf16 v[196:199], v[40:43], v[68:71], v[196:199]
v_mfma_f32_16x16x32_bf16 v[200:203], v[44:47], v[68:71], v[200:203]
s_waitcnt lgkmcnt(0)
s_barrier
v_mfma_f32_16x16x32_bf16 v[204:207], v[32:35], v[72:75], v[204:207]
ds_read_b128 v[16:19], v88 offset:32768
ds_read_b64_tr_b16 v[48:49], v90 offset:32768
v_mfma_f32_16x16x32_bf16 v[208:211], v[36:39], v[72:75], v[208:211]
ds_read_b64_tr_b16 v[50:51], v90 offset:33792
ds_read_b128 v[20:23], v88 offset:34816
v_mfma_f32_16x16x32_bf16 v[212:215], v[40:43], v[72:75], v[212:215]
ds_read_b128 v[24:27], v88 offset:36864
v_mfma_f32_16x16x32_bf16 v[216:219], v[44:47], v[72:75], v[216:219]
v_mfma_f32_16x16x32_bf16 v[220:223], v[32:35], v[76:79], v[220:223]
ds_read_b128 v[28:31], v88 offset:38912
ds_read_b64_tr_b16 v[52:53], v91 offset:32768
v_mfma_f32_16x16x32_bf16 v[224:227], v[36:39], v[76:79], v[224:227]
ds_read_b64_tr_b16 v[54:55], v91 offset:33792
ds_read_b64_tr_b16 v[56:57], v90 offset:34816
v_mfma_f32_16x16x32_bf16 v[228:231], v[40:43], v[76:79], v[228:231]
ds_read_b64_tr_b16 v[58:59], v90 offset:35840
v_mfma_f32_16x16x32_bf16 v[232:235], v[44:47], v[76:79], v[232:235]
s_mul_i32 s71, s28, 917504
s_add_u32 s71, s71, s66
s_mul_i32 s72, s29, 131072
v_mov_b32 v6, 150528
s_lshl_b32 s73, s61, 8
s_add_u32 s73, s73, 147456
v_lshl_add_u32 v104, v102, 4, s73
s_cmp_eq_u32 s29, 0
s_cselect_b32 s73, 786432, 0
s_add_u32 s72, s72, 524288
s_cmp_eq_u32 s61, 0
s_cselect_b32 s72, s72, s73
s_cselect_b32 s77, 1, 0
s_add_u32 s71, s71, s72
k_cwb:
ds_read_b32 v105, v6 offset:20
s_waitcnt lgkmcnt(0)
v_readfirstlane_b32 s72, v105
s_cmp_lt_u32 s72, 2
s_cbranch_scc1 k_cwb
ds_read_b32 v14, v6
v_lshl_add_u32 v105, v100, 2, s70
ds_read2_b32 v[10:11], v105 offset0:0 offset1:128
ds_read2_b32 v[12:13], v105 offset0:16 offset1:144
ds_read2_b32 v[80:81], v105 offset0:32 offset1:160
ds_read2_b32 v[82:83], v105 offset0:48 offset1:176
ds_read_b128 v[92:95], v104 offset:1024
ds_read_b128 v[244:247], v104 offset:2048
ds_read_b128 v[96:99], v104 offset:1088
ds_read_b128 v[248:251], v104 offset:2112
s_waitcnt lgkmcnt(0)
v_pk_fma_f32 v[236:237], v[92:93], v[10:11], v[244:245] op_sel_hi:[1,0,1] neg_lo:[0,1,0] neg_hi:[0,1,0]
v_pk_fma_f32 v[238:239], v[94:95], v[10:11], v[246:247] op_sel_hi:[1,0,1] neg_lo:[0,1,0] neg_hi:[0,1,0]
v_pk_fma_f32 v[240:241], v[92:93], v[12:13], v[244:245] op_sel_hi:[1,0,1] neg_lo:[0,1,0] neg_hi:[0,1,0]
v_pk_fma_f32 v[242:243], v[94:95], v[12:13], v[246:247] op_sel_hi:[1,0,1] neg_lo:[0,1,0] neg_hi:[0,1,0]
v_pk_fma_f32 v[108:109], v[108:109], v[10:11], v[236:237] op_sel:[0,1,0]
v_pk_fma_f32 v[110:111], v[110:111], v[10:11], v[238:239] op_sel:[0,1,0]
v_pk_fma_f32 v[112:113], v[112:113], v[12:13], v[240:241] op_sel:[0,1,0]
v_pk_fma_f32 v[114:115], v[114:115], v[12:13], v[242:243] op_sel:[0,1,0]
v_pk_fma_f32 v[236:237], v[92:93], v[80:81], v[244:245] op_sel_hi:[1,0,1] neg_lo:[0,1,0] neg_hi:[0,1,0]
v_pk_fma_f32 v[238:239], v[94:95], v[80:81], v[246:247] op_sel_hi:[1,0,1] neg_lo:[0,1,0] neg_hi:[0,1,0]
v_pk_fma_f32 v[240:241], v[92:93], v[82:83], v[244:245] op_sel_hi:[1,0,1] neg_lo:[0,1,0] neg_hi:[0,1,0]
v_pk_fma_f32 v[242:243], v[94:95], v[82:83], v[246:247] op_sel_hi:[1,0,1] neg_lo:[0,1,0] neg_hi:[0,1,0]
v_pk_fma_f32 v[116:117], v[116:117], v[80:81], v[236:237] op_sel:[0,1,0]
v_pk_fma_f32 v[118:119], v[118:119], v[80:81], v[238:239] op_sel:[0,1,0]
v_pk_fma_f32 v[120:121], v[120:121], v[82:83], v[240:241] op_sel:[0,1,0]
v_pk_fma_f32 v[122:123], v[122:123], v[82:83], v[242:243] op_sel:[0,1,0]
v_max_f32 v108, 0, v108
v_max_f32 v109, 0, v109
v_max_f32 v110, 0, v110
v_max_f32 v111, 0, v111
v_max_f32 v112, 0, v112
v_max_f32 v113, 0, v113
v_max_f32 v114, 0, v114
v_max_f32 v115, 0, v115
v_max_f32 v116, 0, v116
v_max_f32 v117, 0, v117
v_max_f32 v118, 0, v118
v_max_f32 v119, 0, v119
v_max_f32 v120, 0, v120
v_max_f32 v121, 0, v121
v_max_f32 v122, 0, v122
v_max_f32 v123, 0, v123
v_pk_mul_f32 v[108:109], v[108:109], v[108:109]
v_pk_mul_f32 v[110:111], v[110:111], v[110:111]
v_pk_mul_f32 v[112:113], v[112:113], v[112:113]
v_pk_mul_f32 v[114:115], v[114:115], v[114:115]
v_pk_mul_f32 v[116:117], v[116:117], v[116:117]
v_pk_mul_f32 v[118:119], v[118:119], v[118:119]
v_pk_mul_f32 v[120:121], v[120:121], v[120:121]
v_pk_mul_f32 v[122:123], v[122:123], v[122:123]
v_pk_fma_f32 v[236:237], v[96:97], v[10:11], v[248:249] op_sel_hi:[1,0,1] neg_lo:[0,1,0] neg_hi:[0,1,0]
v_pk_fma_f32 v[238:239], v[98:99], v[10:11], v[250:251] op_sel_hi:[1,0,1] neg_lo:[0,1,0] neg_hi:[0,1,0]
v_pk_fma_f32 v[240:241], v[96:97], v[12:13], v[248:249] op_sel_hi:[1,0,1] neg_lo:[0,1,0] neg_hi:[0,1,0]
v_pk_fma_f32 v[242:243], v[98:99], v[12:13], v[250:251] op_sel_hi:[1,0,1] neg_lo:[0,1,0] neg_hi:[0,1,0]
v_pk_fma_f32 v[124:125], v[124:125], v[10:11], v[236:237] op_sel:[0,1,0]
v_pk_fma_f32 v[126:127], v[126:127], v[10:11], v[238:239] op_sel:[0,1,0]
v_pk_fma_f32 v[128:129], v[128:129], v[12:13], v[240:241] op_sel:[0,1,0]
v_pk_fma_f32 v[130:131], v[130:131], v[12:13], v[242:243] op_sel:[0,1,0]
v_pk_fma_f32 v[236:237], v[96:97], v[80:81], v[248:249] op_sel_hi:[1,0,1] neg_lo:[0,1,0] neg_hi:[0,1,0]
v_pk_fma_f32 v[238:239], v[98:99], v[80:81], v[250:251] op_sel_hi:[1,0,1] neg_lo:[0,1,0] neg_hi:[0,1,0]
v_pk_fma_f32 v[240:241], v[96:97], v[82:83], v[248:249] op_sel_hi:[1,0,1] neg_lo:[0,1,0] neg_hi:[0,1,0]
v_pk_fma_f32 v[242:243], v[98:99], v[82:83], v[250:251] op_sel_hi:[1,0,1] neg_lo:[0,1,0] neg_hi:[0,1,0]
v_pk_fma_f32 v[132:133], v[132:133], v[80:81], v[236:237] op_sel:[0,1,0]
v_pk_fma_f32 v[134:135], v[134:135], v[80:81], v[238:239] op_sel:[0,1,0]
v_pk_fma_f32 v[136:137], v[136:137], v[82:83], v[240:241] op_sel:[0,1,0]
v_pk_fma_f32 v[138:139], v[138:139], v[82:83], v[242:243] op_sel:[0,1,0]
v_max_f32 v124, 0, v124
v_max_f32 v125, 0, v125
v_max_f32 v126, 0, v126
v_max_f32 v127, 0, v127
v_max_f32 v128, 0, v128
v_max_f32 v129, 0, v129
v_max_f32 v130, 0, v130
v_max_f32 v131, 0, v131
v_max_f32 v132, 0, v132
v_max_f32 v133, 0, v133
v_max_f32 v134, 0, v134
v_max_f32 v135, 0, v135
v_max_f32 v136, 0, v136
v_max_f32 v137, 0, v137
v_max_f32 v138, 0, v138
v_max_f32 v139, 0, v139
v_pk_mul_f32 v[124:125], v[124:125], v[124:125]
v_pk_mul_f32 v[126:127], v[126:127], v[126:127]
v_pk_mul_f32 v[128:129], v[128:129], v[128:129]
v_pk_mul_f32 v[130:131], v[130:131], v[130:131]
v_pk_mul_f32 v[132:133], v[132:133], v[132:133]
v_pk_mul_f32 v[134:135], v[134:135], v[134:135]
v_pk_mul_f32 v[136:137], v[136:137], v[136:137]
v_pk_mul_f32 v[138:139], v[138:139], v[138:139]
s_cmp_eq_u32 s77, 0
s_cbranch_scc1 k_he1b
ds_read_b128 v[92:95], v104 offset:1152
ds_read_b128 v[244:247], v104 offset:2176
ds_read_b128 v[96:99], v104 offset:1216
ds_read_b128 v[248:251], v104 offset:2240
v_cvt_pk_bf16_f32 v108, v108, v109
v_cvt_pk_bf16_f32 v109, v110, v111
v_cvt_pk_bf16_f32 v110, v124, v125
v_cvt_pk_bf16_f32 v111, v126, v127
buffer_store_dwordx4 v[108:111], v101, s[44:47], s71 offen offset:0 sc1
v_cvt_pk_bf16_f32 v112, v112, v113
v_cvt_pk_bf16_f32 v113, v114, v115
v_cvt_pk_bf16_f32 v114, v128, v129
v_cvt_pk_bf16_f32 v115, v130, v131
buffer_store_dwordx4 v[112:115], v101, s[44:47], s71 offen offset:1024 sc1
v_cvt_pk_bf16_f32 v116, v116, v117
v_cvt_pk_bf16_f32 v117, v118, v119
v_cvt_pk_bf16_f32 v118, v132, v133
v_cvt_pk_bf16_f32 v119, v134, v135
buffer_store_dwordx4 v[116:119], v101, s[44:47], s71 offen offset:2048 sc1
v_cvt_pk_bf16_f32 v120, v120, v121
v_cvt_pk_bf16_f32 v121, v122, v123
v_cvt_pk_bf16_f32 v122, v136, v137
v_cvt_pk_bf16_f32 v123, v138, v139
buffer_store_dwordx4 v[120:123], v101, s[44:47], s71 offen offset:3072 sc1
s_add_u32 s71, s71, 131072
s_waitcnt lgkmcnt(0)
v_pk_fma_f32 v[236:237], v[92:93], v[10:11], v[244:245] op_sel_hi:[1,0,1] neg_lo:[0,1,0] neg_hi:[0,1,0]
v_pk_fma_f32 v[238:239], v[94:95], v[10:11], v[246:247] op_sel_hi:[1,0,1] neg_lo:[0,1,0] neg_hi:[0,1,0]
v_pk_fma_f32 v[240:241], v[92:93], v[12:13], v[244:245] op_sel_hi:[1,0,1] neg_lo:[0,1,0] neg_hi:[0,1,0]
v_pk_fma_f32 v[242:243], v[94:95], v[12:13], v[246:247] op_sel_hi:[1,0,1] neg_lo:[0,1,0] neg_hi:[0,1,0]
v_pk_fma_f32 v[140:141], v[140:141], v[10:11], v[236:237] op_sel:[0,1,0]
v_pk_fma_f32 v[142:143], v[142:143], v[10:11], v[238:239] op_sel:[0,1,0]
v_pk_fma_f32 v[144:145], v[144:145], v[12:13], v[240:241] op_sel:[0,1,0]
v_pk_fma_f32 v[146:147], v[146:147], v[12:13], v[242:243] op_sel:[0,1,0]
v_pk_fma_f32 v[236:237], v[92:93], v[80:81], v[244:245] op_sel_hi:[1,0,1] neg_lo:[0,1,0] neg_hi:[0,1,0]
v_pk_fma_f32 v[238:239], v[94:95], v[80:81], v[246:247] op_sel_hi:[1,0,1] neg_lo:[0,1,0] neg_hi:[0,1,0]
v_pk_fma_f32 v[240:241], v[92:93], v[82:83], v[244:245] op_sel_hi:[1,0,1] neg_lo:[0,1,0] neg_hi:[0,1,0]
v_pk_fma_f32 v[242:243], v[94:95], v[82:83], v[246:247] op_sel_hi:[1,0,1] neg_lo:[0,1,0] neg_hi:[0,1,0]
v_pk_fma_f32 v[148:149], v[148:149], v[80:81], v[236:237] op_sel:[0,1,0]
v_pk_fma_f32 v[150:151], v[150:151], v[80:81], v[238:239] op_sel:[0,1,0]
v_pk_fma_f32 v[152:153], v[152:153], v[82:83], v[240:241] op_sel:[0,1,0]
v_pk_fma_f32 v[154:155], v[154:155], v[82:83], v[242:243] op_sel:[0,1,0]
v_max_f32 v140, 0, v140
v_max_f32 v141, 0, v141
v_max_f32 v142, 0, v142
v_max_f32 v143, 0, v143
v_max_f32 v144, 0, v144
v_max_f32 v145, 0, v145
v_max_f32 v146, 0, v146
v_max_f32 v147, 0, v147
v_max_f32 v148, 0, v148
v_max_f32 v149, 0, v149
v_max_f32 v150, 0, v150
v_max_f32 v151, 0, v151
v_max_f32 v152, 0, v152
v_max_f32 v153, 0, v153
v_max_f32 v154, 0, v154
v_max_f32 v155, 0, v155
v_pk_mul_f32 v[140:141], v[140:141], v[140:141]
v_pk_mul_f32 v[142:143], v[142:143], v[142:143]
v_pk_mul_f32 v[144:145], v[144:145], v[144:145]
v_pk_mul_f32 v[146:147], v[146:147], v[146:147]
v_pk_mul_f32 v[148:149], v[148:149], v[148:149]
v_pk_mul_f32 v[150:151], v[150:151], v[150:151]
v_pk_mul_f32 v[152:153], v[152:153], v[152:153]
v_pk_mul_f32 v[154:155], v[154:155], v[154:155]
v_pk_fma_f32 v[236:237], v[96:97], v[10:11], v[248:249] op_sel_hi:[1,0,1] neg_lo:[0,1,0] neg_hi:[0,1,0]
v_pk_fma_f32 v[238:239], v[98:99], v[10:11], v[250:251] op_sel_hi:[1,0,1] neg_lo:[0,1,0] neg_hi:[0,1,0]
v_pk_fma_f32 v[240:241], v[96:97], v[12:13], v[248:249] op_sel_hi:[1,0,1] neg_lo:[0,1,0] neg_hi:[0,1,0]
v_pk_fma_f32 v[242:243], v[98:99], v[12:13], v[250:251] op_sel_hi:[1,0,1] neg_lo:[0,1,0] neg_hi:[0,1,0]
v_pk_fma_f32 v[156:157], v[156:157], v[10:11], v[236:237] op_sel:[0,1,0]
v_pk_fma_f32 v[158:159], v[158:159], v[10:11], v[238:239] op_sel:[0,1,0]
v_pk_fma_f32 v[160:161], v[160:161], v[12:13], v[240:241] op_sel:[0,1,0]
v_pk_fma_f32 v[162:163], v[162:163], v[12:13], v[242:243] op_sel:[0,1,0]
v_pk_fma_f32 v[236:237], v[96:97], v[80:81], v[248:249] op_sel_hi:[1,0,1] neg_lo:[0,1,0] neg_hi:[0,1,0]
v_pk_fma_f32 v[238:239], v[98:99], v[80:81], v[250:251] op_sel_hi:[1,0,1] neg_lo:[0,1,0] neg_hi:[0,1,0]
v_pk_fma_f32 v[240:241], v[96:97], v[82:83], v[248:249] op_sel_hi:[1,0,1] neg_lo:[0,1,0] neg_hi:[0,1,0]
v_pk_fma_f32 v[242:243], v[98:99], v[82:83], v[250:251] op_sel_hi:[1,0,1] neg_lo:[0,1,0] neg_hi:[0,1,0]
v_pk_fma_f32 v[164:165], v[164:165], v[80:81], v[236:237] op_sel:[0,1,0]
v_pk_fma_f32 v[166:167], v[166:167], v[80:81], v[238:239] op_sel:[0,1,0]
v_pk_fma_f32 v[168:169], v[168:169], v[82:83], v[240:241] op_sel:[0,1,0]
v_pk_fma_f32 v[170:171], v[170:171], v[82:83], v[242:243] op_sel:[0,1,0]
v_max_f32 v156, 0, v156
v_max_f32 v157, 0, v157
v_max_f32 v158, 0, v158
v_max_f32 v159, 0, v159
v_max_f32 v160, 0, v160
v_max_f32 v161, 0, v161
v_max_f32 v162, 0, v162
v_max_f32 v163, 0, v163
v_max_f32 v164, 0, v164
v_max_f32 v165, 0, v165
v_max_f32 v166, 0, v166
v_max_f32 v167, 0, v167
v_max_f32 v168, 0, v168
v_max_f32 v169, 0, v169
v_max_f32 v170, 0, v170
v_max_f32 v171, 0, v171
v_pk_mul_f32 v[156:157], v[156:157], v[156:157]
v_pk_mul_f32 v[158:159], v[158:159], v[158:159]
v_pk_mul_f32 v[160:161], v[160:161], v[160:161]
v_pk_mul_f32 v[162:163], v[162:163], v[162:163]
v_pk_mul_f32 v[164:165], v[164:165], v[164:165]
v_pk_mul_f32 v[166:167], v[166:167], v[166:167]
v_pk_mul_f32 v[168:169], v[168:169], v[168:169]
v_pk_mul_f32 v[170:171], v[170:171], v[170:171]
v_cvt_pk_bf16_f32 v140, v140, v141
v_cvt_pk_bf16_f32 v141, v142, v143
v_cvt_pk_bf16_f32 v142, v156, v157
v_cvt_pk_bf16_f32 v143, v158, v159
buffer_store_dwordx4 v[140:143], v101, s[44:47], s71 offen offset:0 sc1
v_cvt_pk_bf16_f32 v144, v144, v145
v_cvt_pk_bf16_f32 v145, v146, v147
v_cvt_pk_bf16_f32 v146, v160, v161
v_cvt_pk_bf16_f32 v147, v162, v163
buffer_store_dwordx4 v[144:147], v101, s[44:47], s71 offen offset:1024 sc1
v_cvt_pk_bf16_f32 v148, v148, v149
v_cvt_pk_bf16_f32 v149, v150, v151
v_cvt_pk_bf16_f32 v150, v164, v165
v_cvt_pk_bf16_f32 v151, v166, v167
buffer_store_dwordx4 v[148:151], v101, s[44:47], s71 offen offset:2048 sc1
v_cvt_pk_bf16_f32 v152, v152, v153
v_cvt_pk_bf16_f32 v153, v154, v155
v_cvt_pk_bf16_f32 v154, v168, v169
v_cvt_pk_bf16_f32 v155, v170, v171
buffer_store_dwordx4 v[152:155], v101, s[44:47], s71 offen offset:3072 sc1
s_branch k_he2b
k_he1b:
v_cvt_pk_bf16_f32 v108, v108, v109
v_cvt_pk_bf16_f32 v109, v110, v111
v_cvt_pk_bf16_f32 v110, v124, v125
v_cvt_pk_bf16_f32 v111, v126, v127
buffer_store_dwordx4 v[108:111], v101, s[44:47], s71 offen offset:0 sc1
v_cvt_pk_bf16_f32 v112, v112, v113
v_cvt_pk_bf16_f32 v113, v114, v115
v_cvt_pk_bf16_f32 v114, v128, v129
v_cvt_pk_bf16_f32 v115, v130, v131
buffer_store_dwordx4 v[112:115], v101, s[44:47], s71 offen offset:1024 sc1
v_cvt_pk_bf16_f32 v116, v116, v117
v_cvt_pk_bf16_f32 v117, v118, v119
v_cvt_pk_bf16_f32 v118, v132, v133
v_cvt_pk_bf16_f32 v119, v134, v135
buffer_store_dwordx4 v[116:119], v101, s[44:47], s71 offen offset:2048 sc1
v_cvt_pk_bf16_f32 v120, v120, v121
v_cvt_pk_bf16_f32 v121, v122, v123
v_cvt_pk_bf16_f32 v122, v136, v137
v_cvt_pk_bf16_f32 v123, v138, v139
buffer_store_dwordx4 v[120:123], v101, s[44:47], s71 offen offset:3072 sc1
k_he2b:
v_mfma_f32_16x16x32_bf16 v[172:175], v[16:19], v[48:51], v[172:175]
ds_read_b64_tr_b16 v[60:61], v91 offset:34816
ds_read_b64_tr_b16 v[62:63], v91 offset:35840
v_mfma_f32_16x16x32_bf16 v[176:179], v[20:23], v[48:51], v[176:179]
ds_read_b128 v[32:35], v89 offset:32768
ds_read_b128 v[36:39], v89 offset:34816
v_mfma_f32_16x16x32_bf16 v[180:183], v[24:27], v[48:51], v[180:183]
ds_read_b128 v[40:43], v89 offset:36864
ds_read_b128 v[44:47], v89 offset:38912
v_mfma_f32_16x16x32_bf16 v[184:187], v[28:31], v[48:51], v[184:187]
v_mfma_f32_16x16x32_bf16 v[188:191], v[16:19], v[52:55], v[188:191]
ds_read_b64_tr_b16 v[64:65], v90 offset:40960
v_mfma_f32_16x16x32_bf16 v[192:195], v[20:23], v[52:55], v[192:195]
ds_read_b64_tr_b16 v[66:67], v90 offset:41984
v_mfma_f32_16x16x32_bf16 v[196:199], v[24:27], v[52:55], v[196:199]
v_mfma_f32_16x16x32_bf16 v[200:203], v[28:31], v[52:55], v[200:203]
v_mfma_f32_16x16x32_bf16 v[204:207], v[16:19], v[56:59], v[204:207]
ds_read_b64_tr_b16 v[68:69], v91 offset:40960
v_mfma_f32_16x16x32_bf16 v[208:211], v[20:23], v[56:59], v[208:211]
ds_read_b64_tr_b16 v[70:71], v91 offset:41984
v_mfma_f32_16x16x32_bf16 v[212:215], v[24:27], v[56:59], v[212:215]
v_mfma_f32_16x16x32_bf16 v[216:219], v[28:31], v[56:59], v[216:219]
s_waitcnt lgkmcnt(8)
v_mfma_f32_16x16x32_bf16 v[220:223], v[16:19], v[60:63], v[220:223]
ds_read_b64_tr_b16 v[72:73], v90 offset:43008
v_mfma_f32_16x16x32_bf16 v[224:227], v[20:23], v[60:63], v[224:227]
ds_read_b64_tr_b16 v[74:75], v90 offset:44032
v_mfma_f32_16x16x32_bf16 v[228:231], v[24:27], v[60:63], v[228:231]
v_mfma_f32_16x16x32_bf16 v[232:235], v[28:31], v[60:63], v[232:235]
s_waitcnt lgkmcnt(4)
v_mfma_f32_16x16x32_bf16 v[172:175], v[32:35], v[64:67], v[172:175]
ds_read_b64_tr_b16 v[76:77], v91 offset:43008
v_mfma_f32_16x16x32_bf16 v[176:179], v[36:39], v[64:67], v[176:179]
ds_read_b64_tr_b16 v[78:79], v91 offset:44032
v_mfma_f32_16x16x32_bf16 v[180:183], v[40:43], v[64:67], v[180:183]
v_mfma_f32_16x16x32_bf16 v[184:187], v[44:47], v[64:67], v[184:187]
s_waitcnt lgkmcnt(4)
v_mfma_f32_16x16x32_bf16 v[188:191], v[32:35], v[68:71], v[188:191]
v_mfma_f32_16x16x32_bf16 v[192:195], v[36:39], v[68:71], v[192:195]
v_mfma_f32_16x16x32_bf16 v[196:199], v[40:43], v[68:71], v[196:199]
v_mfma_f32_16x16x32_bf16 v[200:203], v[44:47], v[68:71], v[200:203]
s_waitcnt lgkmcnt(0)
s_barrier
v_mfma_f32_16x16x32_bf16 v[204:207], v[32:35], v[72:75], v[204:207]
ds_read_b128 v[16:19], v2 offset:0
ds_read_b64_tr_b16 v[48:49], v90 offset:0
v_mfma_f32_16x16x32_bf16 v[208:211], v[36:39], v[72:75], v[208:211]
ds_read_b64_tr_b16 v[50:51], v90 offset:1024
ds_read_b128 v[20:23], v2 offset:2048
v_mfma_f32_16x16x32_bf16 v[212:215], v[40:43], v[72:75], v[212:215]
ds_read_b128 v[24:27], v2 offset:4096
v_mfma_f32_16x16x32_bf16 v[216:219], v[44:47], v[72:75], v[216:219]
v_mfma_f32_16x16x32_bf16 v[220:223], v[32:35], v[76:79], v[220:223]
ds_read_b128 v[28:31], v2 offset:6144
ds_read_b64_tr_b16 v[52:53], v91 offset:0
v_mfma_f32_16x16x32_bf16 v[224:227], v[36:39], v[76:79], v[224:227]
ds_read_b64_tr_b16 v[54:55], v91 offset:1024
ds_read_b64_tr_b16 v[56:57], v90 offset:2048
v_mfma_f32_16x16x32_bf16 v[228:231], v[40:43], v[76:79], v[228:231]
ds_read_b64_tr_b16 v[58:59], v90 offset:3072
v_mfma_f32_16x16x32_bf16 v[232:235], v[44:47], v[76:79], v[232:235]
s_waitcnt lgkmcnt(4)
v_mfma_f32_16x16x32_bf16 v[172:175], v[16:19], v[48:51], v[172:175]
ds_read_b64_tr_b16 v[60:61], v91 offset:2048
ds_read_b64_tr_b16 v[62:63], v91 offset:3072
v_mfma_f32_16x16x32_bf16 v[176:179], v[20:23], v[48:51], v[176:179]
ds_read_b128 v[32:35], v3 offset:0
ds_read_b128 v[36:39], v3 offset:2048
v_mfma_f32_16x16x32_bf16 v[180:183], v[24:27], v[48:51], v[180:183]
ds_read_b128 v[40:43], v3 offset:4096
ds_read_b128 v[44:47], v3 offset:6144
v_mfma_f32_16x16x32_bf16 v[184:187], v[28:31], v[48:51], v[184:187]
s_waitcnt lgkmcnt(8)
v_mfma_f32_16x16x32_bf16 v[188:191], v[16:19], v[52:55], v[188:191]
ds_read_b64_tr_b16 v[64:65], v90 offset:8192
v_mfma_f32_16x16x32_bf16 v[192:195], v[20:23], v[52:55], v[192:195]
ds_read_b64_tr_b16 v[66:67], v90 offset:9216
v_mfma_f32_16x16x32_bf16 v[196:199], v[24:27], v[52:55], v[196:199]
v_mfma_f32_16x16x32_bf16 v[200:203], v[28:31], v[52:55], v[200:203]
s_waitcnt lgkmcnt(8)
v_mfma_f32_16x16x32_bf16 v[204:207], v[16:19], v[56:59], v[204:207]
ds_read_b64_tr_b16 v[68:69], v91 offset:8192
v_mfma_f32_16x16x32_bf16 v[208:211], v[20:23], v[56:59], v[208:211]
ds_read_b64_tr_b16 v[70:71], v91 offset:9216
v_mfma_f32_16x16x32_bf16 v[212:215], v[24:27], v[56:59], v[212:215]
v_mfma_f32_16x16x32_bf16 v[216:219], v[28:31], v[56:59], v[216:219]
s_waitcnt lgkmcnt(8)
v_mfma_f32_16x16x32_bf16 v[220:223], v[16:19], v[60:63], v[220:223]
ds_read_b64_tr_b16 v[72:73], v90 offset:10240
v_mfma_f32_16x16x32_bf16 v[224:227], v[20:23], v[60:63], v[224:227]
ds_read_b64_tr_b16 v[74:75], v90 offset:11264
v_mfma_f32_16x16x32_bf16 v[228:231], v[24:27], v[60:63], v[228:231]
v_mfma_f32_16x16x32_bf16 v[232:235], v[28:31], v[60:63], v[232:235]
s_waitcnt lgkmcnt(4)
v_mfma_f32_16x16x32_bf16 v[172:175], v[32:35], v[64:67], v[172:175]
ds_read_b64_tr_b16 v[76:77], v91 offset:10240
v_mfma_f32_16x16x32_bf16 v[176:179], v[36:39], v[64:67], v[176:179]
ds_read_b64_tr_b16 v[78:79], v91 offset:11264
v_mfma_f32_16x16x32_bf16 v[180:183], v[40:43], v[64:67], v[180:183]
v_mfma_f32_16x16x32_bf16 v[184:187], v[44:47], v[64:67], v[184:187]
s_waitcnt lgkmcnt(4)
v_mfma_f32_16x16x32_bf16 v[188:191], v[32:35], v[68:71], v[188:191]
v_mfma_f32_16x16x32_bf16 v[192:195], v[36:39], v[68:71], v[192:195]
v_mfma_f32_16x16x32_bf16 v[196:199], v[40:43], v[68:71], v[196:199]
v_mfma_f32_16x16x32_bf16 v[200:203], v[44:47], v[68:71], v[200:203]
s_waitcnt lgkmcnt(0)
s_barrier
v_mfma_f32_16x16x32_bf16 v[204:207], v[32:35], v[72:75], v[204:207]
ds_read_b128 v[16:19], v2 offset:16384
ds_read_b64_tr_b16 v[48:49], v90 offset:16384
v_mfma_f32_16x16x32_bf16 v[208:211], v[36:39], v[72:75], v[208:211]
ds_read_b64_tr_b16 v[50:51], v90 offset:17408
ds_read_b128 v[20:23], v2 offset:18432
v_mfma_f32_16x16x32_bf16 v[212:215], v[40:43], v[72:75], v[212:215]
ds_read_b128 v[24:27], v2 offset:20480
v_mfma_f32_16x16x32_bf16 v[216:219], v[44:47], v[72:75], v[216:219]
v_mfma_f32_16x16x32_bf16 v[220:223], v[32:35], v[76:79], v[220:223]
ds_read_b128 v[28:31], v2 offset:22528
ds_read_b64_tr_b16 v[52:53], v91 offset:16384
v_mfma_f32_16x16x32_bf16 v[224:227], v[36:39], v[76:79], v[224:227]
ds_read_b64_tr_b16 v[54:55], v91 offset:17408
ds_read_b64_tr_b16 v[56:57], v90 offset:18432
v_mfma_f32_16x16x32_bf16 v[228:231], v[40:43], v[76:79], v[228:231]
ds_read_b64_tr_b16 v[58:59], v90 offset:19456
v_mfma_f32_16x16x32_bf16 v[232:235], v[44:47], v[76:79], v[232:235]
s_waitcnt lgkmcnt(4)
v_mfma_f32_16x16x32_bf16 v[172:175], v[16:19], v[48:51], v[172:175]
ds_read_b64_tr_b16 v[60:61], v91 offset:18432
ds_read_b64_tr_b16 v[62:63], v91 offset:19456
v_mfma_f32_16x16x32_bf16 v[176:179], v[20:23], v[48:51], v[176:179]
ds_read_b128 v[32:35], v3 offset:16384
ds_read_b128 v[36:39], v3 offset:18432
v_mfma_f32_16x16x32_bf16 v[180:183], v[24:27], v[48:51], v[180:183]
ds_read_b128 v[40:43], v3 offset:20480
ds_read_b128 v[44:47], v3 offset:22528
v_mfma_f32_16x16x32_bf16 v[184:187], v[28:31], v[48:51], v[184:187]
s_waitcnt lgkmcnt(8)
v_mfma_f32_16x16x32_bf16 v[188:191], v[16:19], v[52:55], v[188:191]
ds_read_b64_tr_b16 v[64:65], v90 offset:24576
v_mfma_f32_16x16x32_bf16 v[192:195], v[20:23], v[52:55], v[192:195]
ds_read_b64_tr_b16 v[66:67], v90 offset:25600
v_mfma_f32_16x16x32_bf16 v[196:199], v[24:27], v[52:55], v[196:199]
v_mfma_f32_16x16x32_bf16 v[200:203], v[28:31], v[52:55], v[200:203]
s_waitcnt lgkmcnt(8)
v_mfma_f32_16x16x32_bf16 v[204:207], v[16:19], v[56:59], v[204:207]
ds_read_b64_tr_b16 v[68:69], v91 offset:24576
v_mfma_f32_16x16x32_bf16 v[208:211], v[20:23], v[56:59], v[208:211]
ds_read_b64_tr_b16 v[70:71], v91 offset:25600
v_mfma_f32_16x16x32_bf16 v[212:215], v[24:27], v[56:59], v[212:215]
v_mfma_f32_16x16x32_bf16 v[216:219], v[28:31], v[56:59], v[216:219]
s_waitcnt lgkmcnt(8)
v_mfma_f32_16x16x32_bf16 v[220:223], v[16:19], v[60:63], v[220:223]
ds_read_b64_tr_b16 v[72:73], v90 offset:26624
v_mfma_f32_16x16x32_bf16 v[224:227], v[20:23], v[60:63], v[224:227]
ds_read_b64_tr_b16 v[74:75], v90 offset:27648
v_mfma_f32_16x16x32_bf16 v[228:231], v[24:27], v[60:63], v[228:231]
v_mfma_f32_16x16x32_bf16 v[232:235], v[28:31], v[60:63], v[232:235]
s_waitcnt lgkmcnt(4)
v_mfma_f32_16x16x32_bf16 v[172:175], v[32:35], v[64:67], v[172:175]
ds_read_b64_tr_b16 v[76:77], v91 offset:26624
v_mfma_f32_16x16x32_bf16 v[176:179], v[36:39], v[64:67], v[176:179]
ds_read_b64_tr_b16 v[78:79], v91 offset:27648
v_mfma_f32_16x16x32_bf16 v[180:183], v[40:43], v[64:67], v[180:183]
v_mfma_f32_16x16x32_bf16 v[184:187], v[44:47], v[64:67], v[184:187]
s_waitcnt lgkmcnt(4)
v_mfma_f32_16x16x32_bf16 v[188:191], v[32:35], v[68:71], v[188:191]
v_mfma_f32_16x16x32_bf16 v[192:195], v[36:39], v[68:71], v[192:195]
v_mfma_f32_16x16x32_bf16 v[196:199], v[40:43], v[68:71], v[196:199]
v_mfma_f32_16x16x32_bf16 v[200:203], v[44:47], v[68:71], v[200:203]
s_waitcnt lgkmcnt(0)
s_barrier
s_lshl_b32 s72, s27, 1
s_add_u32 s72, s72, s61
s_lshr_b32 s73, s72, 3
s_lshl_b32 s73, s73, 7
s_and_b32 s72, s72, 7
s_lshl_b32 s72, s72, 2
s_add_u32 s72, s72, s73
s_lshl_b32 s73, s60, 9
s_add_u32 s72, s72, s73
s_add_u32 s72, s72, 12402688
s_waitcnt vmcnt(0)
s_mov_b64 exec, 1
buffer_store_dword v14, v15, s[44:47], s72 offen sc1
s_mov_b64 exec, -1
v_mfma_f32_16x16x32_bf16 v[204:207], v[32:35], v[72:75], v[204:207]
ds_read_b128 v[16:19], v2 offset:32768
ds_read_b64_tr_b16 v[48:49], v90 offset:32768
v_mfma_f32_16x16x32_bf16 v[208:211], v[36:39], v[72:75], v[208:211]
ds_read_b64_tr_b16 v[50:51], v90 offset:33792
ds_read_b128 v[20:23], v2 offset:34816
v_mfma_f32_16x16x32_bf16 v[212:215], v[40:43], v[72:75], v[212:215]
ds_read_b128 v[24:27], v2 offset:36864
v_mfma_f32_16x16x32_bf16 v[216:219], v[44:47], v[72:75], v[216:219]
v_mfma_f32_16x16x32_bf16 v[220:223], v[32:35], v[76:79], v[220:223]
ds_read_b128 v[28:31], v2 offset:38912
ds_read_b64_tr_b16 v[52:53], v91 offset:32768
v_mfma_f32_16x16x32_bf16 v[224:227], v[36:39], v[76:79], v[224:227]
ds_read_b64_tr_b16 v[54:55], v91 offset:33792
ds_read_b64_tr_b16 v[56:57], v90 offset:34816
v_mfma_f32_16x16x32_bf16 v[228:231], v[40:43], v[76:79], v[228:231]
ds_read_b64_tr_b16 v[58:59], v90 offset:35840
v_mfma_f32_16x16x32_bf16 v[232:235], v[44:47], v[76:79], v[232:235]
s_waitcnt lgkmcnt(4)
v_mfma_f32_16x16x32_bf16 v[172:175], v[16:19], v[48:51], v[172:175]
ds_read_b64_tr_b16 v[60:61], v91 offset:34816
ds_read_b64_tr_b16 v[62:63], v91 offset:35840
v_mfma_f32_16x16x32_bf16 v[176:179], v[20:23], v[48:51], v[176:179]
ds_read_b128 v[32:35], v3 offset:32768
ds_read_b128 v[36:39], v3 offset:34816
v_mfma_f32_16x16x32_bf16 v[180:183], v[24:27], v[48:51], v[180:183]
ds_read_b128 v[40:43], v3 offset:36864
ds_read_b128 v[44:47], v3 offset:38912
v_mfma_f32_16x16x32_bf16 v[184:187], v[28:31], v[48:51], v[184:187]
s_waitcnt lgkmcnt(8)
v_mfma_f32_16x16x32_bf16 v[188:191], v[16:19], v[52:55], v[188:191]
ds_read_b64_tr_b16 v[64:65], v90 offset:40960
v_mfma_f32_16x16x32_bf16 v[192:195], v[20:23], v[52:55], v[192:195]
ds_read_b64_tr_b16 v[66:67], v90 offset:41984
v_mfma_f32_16x16x32_bf16 v[196:199], v[24:27], v[52:55], v[196:199]
v_mfma_f32_16x16x32_bf16 v[200:203], v[28:31], v[52:55], v[200:203]
s_waitcnt lgkmcnt(8)
v_mfma_f32_16x16x32_bf16 v[204:207], v[16:19], v[56:59], v[204:207]
ds_read_b64_tr_b16 v[68:69], v91 offset:40960
v_mfma_f32_16x16x32_bf16 v[208:211], v[20:23], v[56:59], v[208:211]
ds_read_b64_tr_b16 v[70:71], v91 offset:41984
v_mfma_f32_16x16x32_bf16 v[212:215], v[24:27], v[56:59], v[212:215]
v_mfma_f32_16x16x32_bf16 v[216:219], v[28:31], v[56:59], v[216:219]
s_waitcnt lgkmcnt(8)
v_mfma_f32_16x16x32_bf16 v[220:223], v[16:19], v[60:63], v[220:223]
ds_read_b64_tr_b16 v[72:73], v90 offset:43008
v_mfma_f32_16x16x32_bf16 v[224:227], v[20:23], v[60:63], v[224:227]
ds_read_b64_tr_b16 v[74:75], v90 offset:44032
v_mfma_f32_16x16x32_bf16 v[228:231], v[24:27], v[60:63], v[228:231]
v_mfma_f32_16x16x32_bf16 v[232:235], v[28:31], v[60:63], v[232:235]
s_waitcnt lgkmcnt(4)
v_mfma_f32_16x16x32_bf16 v[172:175], v[32:35], v[64:67], v[172:175]
ds_read_b64_tr_b16 v[76:77], v91 offset:43008
v_mfma_f32_16x16x32_bf16 v[176:179], v[36:39], v[64:67], v[176:179]
ds_read_b64_tr_b16 v[78:79], v91 offset:44032
v_mfma_f32_16x16x32_bf16 v[180:183], v[40:43], v[64:67], v[180:183]
v_mfma_f32_16x16x32_bf16 v[184:187], v[44:47], v[64:67], v[184:187]
s_waitcnt lgkmcnt(4)
v_mfma_f32_16x16x32_bf16 v[188:191], v[32:35], v[68:71], v[188:191]
v_mfma_f32_16x16x32_bf16 v[192:195], v[36:39], v[68:71], v[192:195]
v_mfma_f32_16x16x32_bf16 v[196:199], v[40:43], v[68:71], v[196:199]
v_mfma_f32_16x16x32_bf16 v[200:203], v[44:47], v[68:71], v[200:203]
s_waitcnt lgkmcnt(0)
s_barrier
v_mfma_f32_16x16x32_bf16 v[204:207], v[32:35], v[72:75], v[204:207]
ds_read_b128 v[16:19], v88 offset:0
ds_read_b64_tr_b16 v[48:49], v90 offset:0
v_mfma_f32_16x16x32_bf16 v[208:211], v[36:39], v[72:75], v[208:211]
ds_read_b64_tr_b16 v[50:51], v90 offset:1024
ds_read_b128 v[20:23], v88 offset:2048
v_mfma_f32_16x16x32_bf16 v[212:215], v[40:43], v[72:75], v[212:215]
ds_read_b128 v[24:27], v88 offset:4096
v_mfma_f32_16x16x32_bf16 v[216:219], v[44:47], v[72:75], v[216:219]
v_mfma_f32_16x16x32_bf16 v[220:223], v[32:35], v[76:79], v[220:223]
ds_read_b128 v[28:31], v88 offset:6144
ds_read_b64_tr_b16 v[52:53], v91 offset:0
v_mfma_f32_16x16x32_bf16 v[224:227], v[36:39], v[76:79], v[224:227]
ds_read_b64_tr_b16 v[54:55], v91 offset:1024
ds_read_b64_tr_b16 v[56:57], v90 offset:2048
v_mfma_f32_16x16x32_bf16 v[228:231], v[40:43], v[76:79], v[228:231]
ds_read_b64_tr_b16 v[58:59], v90 offset:3072
v_mfma_f32_16x16x32_bf16 v[232:235], v[44:47], v[76:79], v[232:235]
s_waitcnt lgkmcnt(4)
v_mfma_f32_16x16x32_bf16 v[172:175], v[16:19], v[48:51], v[172:175]
ds_read_b64_tr_b16 v[60:61], v91 offset:2048
ds_read_b64_tr_b16 v[62:63], v91 offset:3072
v_mfma_f32_16x16x32_bf16 v[176:179], v[20:23], v[48:51], v[176:179]
ds_read_b128 v[32:35], v89 offset:0
ds_read_b128 v[36:39], v89 offset:2048
v_mfma_f32_16x16x32_bf16 v[180:183], v[24:27], v[48:51], v[180:183]
ds_read_b128 v[40:43], v89 offset:4096
ds_read_b128 v[44:47], v89 offset:6144
v_mfma_f32_16x16x32_bf16 v[184:187], v[28:31], v[48:51], v[184:187]
s_waitcnt lgkmcnt(8)
v_mfma_f32_16x16x32_bf16 v[188:191], v[16:19], v[52:55], v[188:191]
ds_read_b64_tr_b16 v[64:65], v90 offset:8192
v_mfma_f32_16x16x32_bf16 v[192:195], v[20:23], v[52:55], v[192:195]
ds_read_b64_tr_b16 v[66:67], v90 offset:9216
v_mfma_f32_16x16x32_bf16 v[196:199], v[24:27], v[52:55], v[196:199]
v_mfma_f32_16x16x32_bf16 v[200:203], v[28:31], v[52:55], v[200:203]
s_waitcnt lgkmcnt(8)
v_mfma_f32_16x16x32_bf16 v[204:207], v[16:19], v[56:59], v[204:207]
ds_read_b64_tr_b16 v[68:69], v91 offset:8192
v_mfma_f32_16x16x32_bf16 v[208:211], v[20:23], v[56:59], v[208:211]
ds_read_b64_tr_b16 v[70:71], v91 offset:9216
v_mfma_f32_16x16x32_bf16 v[212:215], v[24:27], v[56:59], v[212:215]
v_mfma_f32_16x16x32_bf16 v[216:219], v[28:31], v[56:59], v[216:219]
s_waitcnt lgkmcnt(8)
v_mfma_f32_16x16x32_bf16 v[220:223], v[16:19], v[60:63], v[220:223]
ds_read_b64_tr_b16 v[72:73], v90 offset:10240
v_mfma_f32_16x16x32_bf16 v[224:227], v[20:23], v[60:63], v[224:227]
ds_read_b64_tr_b16 v[74:75], v90 offset:11264
v_mfma_f32_16x16x32_bf16 v[228:231], v[24:27], v[60:63], v[228:231]
v_mfma_f32_16x16x32_bf16 v[232:235], v[28:31], v[60:63], v[232:235]
s_waitcnt lgkmcnt(4)
v_mfma_f32_16x16x32_bf16 v[172:175], v[32:35], v[64:67], v[172:175]
ds_read_b64_tr_b16 v[76:77], v91 offset:10240
v_mfma_f32_16x16x32_bf16 v[176:179], v[36:39], v[64:67], v[176:179]
ds_read_b64_tr_b16 v[78:79], v91 offset:11264
v_mfma_f32_16x16x32_bf16 v[180:183], v[40:43], v[64:67], v[180:183]
v_mfma_f32_16x16x32_bf16 v[184:187], v[44:47], v[64:67], v[184:187]
s_waitcnt lgkmcnt(4)
v_mfma_f32_16x16x32_bf16 v[188:191], v[32:35], v[68:71], v[188:191]
v_mfma_f32_16x16x32_bf16 v[192:195], v[36:39], v[68:71], v[192:195]
v_mfma_f32_16x16x32_bf16 v[196:199], v[40:43], v[68:71], v[196:199]
v_mfma_f32_16x16x32_bf16 v[200:203], v[44:47], v[68:71], v[200:203]
s_waitcnt lgkmcnt(0)
s_barrier
v_mfma_f32_16x16x32_bf16 v[204:207], v[32:35], v[72:75], v[204:207]
v_mfma_f32_16x16x32_bf16 v[208:211], v[36:39], v[72:75], v[208:211]
v_mfma_f32_16x16x32_bf16 v[212:215], v[40:43], v[72:75], v[212:215]
v_mfma_f32_16x16x32_bf16 v[216:219], v[44:47], v[72:75], v[216:219]
v_mfma_f32_16x16x32_bf16 v[220:223], v[32:35], v[76:79], v[220:223]
v_mfma_f32_16x16x32_bf16 v[224:227], v[36:39], v[76:79], v[224:227]
v_mfma_f32_16x16x32_bf16 v[228:231], v[40:43], v[76:79], v[228:231]
v_mfma_f32_16x16x32_bf16 v[232:235], v[44:47], v[76:79], v[232:235]
s_lshl_b32 s72, s68, 8
s_add_u32 s72, s72, 147456
v_lshl_add_u32 v104, v102, 4, s72
ds_read_b128 v[16:19], v104 offset:0
ds_read_b128 v[32:35], v104 offset:512
ds_read_b128 v[20:23], v104 offset:64
ds_read_b128 v[36:39], v104 offset:576
ds_read_b128 v[24:27], v104 offset:128
ds_read_b128 v[40:43], v104 offset:640
ds_read_b128 v[28:31], v104 offset:192
ds_read_b128 v[44:47], v104 offset:704
s_lshl_b32 s72, s61, 7
s_add_u32 s72, s72, 148480
v_lshl_add_u32 v104, v100, 2, s72
ds_read2_b32 v[48:49], v104 offset0:128 offset1:144
ds_read2_b32 v[50:51], v104 offset0:192 offset1:208
v_mov_b32 v92, 0x3f803f80
v_mov_b32 v93, 0x3f803f80
v_mov_b32 v94, 0x3f803f80
v_mov_b32 v95, 0x3f803f80
s_waitcnt lgkmcnt(0)
v_pk_mul_f32 v[236:237], v[16:17], v[48:49] op_sel:[0,0] op_sel_hi:[1,0] neg_lo:[0,1] neg_hi:[0,1]
v_pk_mul_f32 v[238:239], v[18:19], v[48:49] op_sel:[0,0] op_sel_hi:[1,0] neg_lo:[0,1] neg_hi:[0,1]
v_pk_mul_f32 v[240:241], v[20:21], v[48:49] op_sel:[0,0] op_sel_hi:[1,0] neg_lo:[0,1] neg_hi:[0,1]
v_pk_mul_f32 v[242:243], v[22:23], v[48:49] op_sel:[0,0] op_sel_hi:[1,0] neg_lo:[0,1] neg_hi:[0,1]
v_pk_fma_f32 v[236:237], v[172:173], v[32:33], v[236:237]
v_pk_fma_f32 v[238:239], v[174:175], v[34:35], v[238:239]
v_pk_fma_f32 v[240:241], v[176:177], v[36:37], v[240:241]
v_pk_fma_f32 v[242:243], v[178:179], v[38:39], v[242:243]
v_pk_mul_f32 v[120:121], v[16:17], v[50:51] op_sel:[0,0] op_sel_hi:[1,0] neg_lo:[0,1] neg_hi:[0,1]
v_pk_mul_f32 v[122:123], v[18:19], v[50:51] op_sel:[0,0] op_sel_hi:[1,0] neg_lo:[0,1] neg_hi:[0,1]
v_pk_mul_f32 v[124:125], v[20:21], v[50:51] op_sel:[0,0] op_sel_hi:[1,0] neg_lo:[0,1] neg_hi:[0,1]
v_pk_mul_f32 v[126:127], v[22:23], v[50:51] op_sel:[0,0] op_sel_hi:[1,0] neg_lo:[0,1] neg_hi:[0,1]
v_pk_fma_f32 v[120:121], v[204:205], v[32:33], v[120:121]
v_pk_fma_f32 v[122:123], v[206:207], v[34:35], v[122:123]
v_pk_fma_f32 v[124:125], v[208:209], v[36:37], v[124:125]
v_pk_fma_f32 v[126:127], v[210:211], v[38:39], v[126:127]
v_pk_mul_f32 v[244:245], v[236:237], s[62:63]
v_pk_mul_f32 v[246:247], v[238:239], s[62:63]
v_pk_mul_f32 v[248:249], v[240:241], s[62:63]
v_pk_mul_f32 v[250:251], v[242:243], s[62:63]
v_pk_add_f32 v[236:237], v[236:237], 1.0 op_sel_hi:[1,0]
v_pk_add_f32 v[238:239], v[238:239], 1.0 op_sel_hi:[1,0]
v_pk_add_f32 v[240:241], v[240:241], 1.0 op_sel_hi:[1,0]
v_pk_add_f32 v[242:243], v[242:243], 1.0 op_sel_hi:[1,0]
v_exp_f32 v244, v244
v_exp_f32 v245, v245
v_exp_f32 v246, v246
v_exp_f32 v247, v247
v_exp_f32 v248, v248
v_exp_f32 v249, v249
v_exp_f32 v250, v250
v_exp_f32 v251, v251
v_med3_f32 v236, v244, v236, 1.0
v_med3_f32 v237, v245, v237, 1.0
v_med3_f32 v238, v246, v238, 1.0
v_med3_f32 v239, v247, v239, 1.0
v_med3_f32 v240, v248, v240, 1.0
v_med3_f32 v241, v249, v241, 1.0
v_med3_f32 v242, v250, v242, 1.0
v_med3_f32 v243, v251, v243, 1.0
v_pk_add_f32 v[236:237], v[236:237], s[64:65]
v_pk_add_f32 v[238:239], v[238:239], s[64:65]
v_pk_add_f32 v[240:241], v[240:241], s[64:65]
v_pk_add_f32 v[242:243], v[242:243], s[64:65]
v_cvt_pk_bf16_f32 v52, v236, v237
v_cvt_pk_bf16_f32 v53, v238, v239
v_cvt_pk_bf16_f32 v54, v240, v241
v_cvt_pk_bf16_f32 v55, v242, v243
v_cvt_pk_bf16_f32 v56, v120, v121
v_cvt_pk_bf16_f32 v57, v122, v123
v_cvt_pk_bf16_f32 v58, v124, v125
v_cvt_pk_bf16_f32 v59, v126, v127
s_nop 1
v_mfma_f32_16x16x32_bf16 v[64:67], v[52:55], v[56:59], 0
v_mfma_f32_16x16x32_bf16 v[68:71], v[52:55], v[92:95], 0
v_pk_mul_f32 v[236:237], v[24:25], v[48:49] op_sel:[0,0] op_sel_hi:[1,0] neg_lo:[0,1] neg_hi:[0,1]
v_pk_mul_f32 v[238:239], v[26:27], v[48:49] op_sel:[0,0] op_sel_hi:[1,0] neg_lo:[0,1] neg_hi:[0,1]
v_pk_mul_f32 v[240:241], v[28:29], v[48:49] op_sel:[0,0] op_sel_hi:[1,0] neg_lo:[0,1] neg_hi:[0,1]
v_pk_mul_f32 v[242:243], v[30:31], v[48:49] op_sel:[0,0] op_sel_hi:[1,0] neg_lo:[0,1] neg_hi:[0,1]
v_pk_fma_f32 v[236:237], v[180:181], v[40:41], v[236:237]
v_pk_fma_f32 v[238:239], v[182:183], v[42:43], v[238:239]
v_pk_fma_f32 v[240:241], v[184:185], v[44:45], v[240:241]
v_pk_fma_f32 v[242:243], v[186:187], v[46:47], v[242:243]
v_pk_mul_f32 v[120:121], v[24:25], v[50:51] op_sel:[0,0] op_sel_hi:[1,0] neg_lo:[0,1] neg_hi:[0,1]
v_pk_mul_f32 v[122:123], v[26:27], v[50:51] op_sel:[0,0] op_sel_hi:[1,0] neg_lo:[0,1] neg_hi:[0,1]
v_pk_mul_f32 v[124:125], v[28:29], v[50:51] op_sel:[0,0] op_sel_hi:[1,0] neg_lo:[0,1] neg_hi:[0,1]
v_pk_mul_f32 v[126:127], v[30:31], v[50:51] op_sel:[0,0] op_sel_hi:[1,0] neg_lo:[0,1] neg_hi:[0,1]
v_pk_fma_f32 v[120:121], v[212:213], v[40:41], v[120:121]
v_pk_fma_f32 v[122:123], v[214:215], v[42:43], v[122:123]
v_pk_fma_f32 v[124:125], v[216:217], v[44:45], v[124:125]
v_pk_fma_f32 v[126:127], v[218:219], v[46:47], v[126:127]
v_pk_mul_f32 v[244:245], v[236:237], s[62:63]
v_pk_mul_f32 v[246:247], v[238:239], s[62:63]
v_pk_mul_f32 v[248:249], v[240:241], s[62:63]
v_pk_mul_f32 v[250:251], v[242:243], s[62:63]
v_pk_add_f32 v[236:237], v[236:237], 1.0 op_sel_hi:[1,0]
v_pk_add_f32 v[238:239], v[238:239], 1.0 op_sel_hi:[1,0]
v_pk_add_f32 v[240:241], v[240:241], 1.0 op_sel_hi:[1,0]
v_pk_add_f32 v[242:243], v[242:243], 1.0 op_sel_hi:[1,0]
v_exp_f32 v244, v244
v_exp_f32 v245, v245
v_exp_f32 v246, v246
v_exp_f32 v247, v247
v_exp_f32 v248, v248
v_exp_f32 v249, v249
v_exp_f32 v250, v250
v_exp_f32 v251, v251
v_med3_f32 v236, v244, v236, 1.0
v_med3_f32 v237, v245, v237, 1.0
v_med3_f32 v238, v246, v238, 1.0
v_med3_f32 v239, v247, v239, 1.0
v_med3_f32 v240, v248, v240, 1.0
v_med3_f32 v241, v249, v241, 1.0
v_med3_f32 v242, v250, v242, 1.0
v_med3_f32 v243, v251, v243, 1.0
v_pk_add_f32 v[236:237], v[236:237], s[64:65]
v_pk_add_f32 v[238:239], v[238:239], s[64:65]
v_pk_add_f32 v[240:241], v[240:241], s[64:65]
v_pk_add_f32 v[242:243], v[242:243], s[64:65]
v_cvt_pk_bf16_f32 v52, v236, v237
v_cvt_pk_bf16_f32 v53, v238, v239
v_cvt_pk_bf16_f32 v54, v240, v241
v_cvt_pk_bf16_f32 v55, v242, v243
v_cvt_pk_bf16_f32 v56, v120, v121
v_cvt_pk_bf16_f32 v57, v122, v123
v_cvt_pk_bf16_f32 v58, v124, v125
v_cvt_pk_bf16_f32 v59, v126, v127
s_nop 1
v_mfma_f32_16x16x32_bf16 v[64:67], v[52:55], v[56:59], v[64:67]
v_mfma_f32_16x16x32_bf16 v[68:71], v[52:55], v[92:95], v[68:71]
v_pk_mul_f32 v[236:237], v[16:17], v[48:49] op_sel:[0,1] op_sel_hi:[1,1] neg_lo:[0,1] neg_hi:[0,1]
v_pk_mul_f32 v[238:239], v[18:19], v[48:49] op_sel:[0,1] op_sel_hi:[1,1] neg_lo:[0,1] neg_hi:[0,1]
v_pk_mul_f32 v[240:241], v[20:21], v[48:49] op_sel:[0,1] op_sel_hi:[1,1] neg_lo:[0,1] neg_hi:[0,1]
v_pk_mul_f32 v[242:243], v[22:23], v[48:49] op_sel:[0,1] op_sel_hi:[1,1] neg_lo:[0,1] neg_hi:[0,1]
v_pk_fma_f32 v[236:237], v[188:189], v[32:33], v[236:237]
v_pk_fma_f32 v[238:239], v[190:191], v[34:35], v[238:239]
v_pk_fma_f32 v[240:241], v[192:193], v[36:37], v[240:241]
v_pk_fma_f32 v[242:243], v[194:195], v[38:39], v[242:243]
v_pk_mul_f32 v[120:121], v[16:17], v[50:51] op_sel:[0,1] op_sel_hi:[1,1] neg_lo:[0,1] neg_hi:[0,1]
v_pk_mul_f32 v[122:123], v[18:19], v[50:51] op_sel:[0,1] op_sel_hi:[1,1] neg_lo:[0,1] neg_hi:[0,1]
v_pk_mul_f32 v[124:125], v[20:21], v[50:51] op_sel:[0,1] op_sel_hi:[1,1] neg_lo:[0,1] neg_hi:[0,1]
v_pk_mul_f32 v[126:127], v[22:23], v[50:51] op_sel:[0,1] op_sel_hi:[1,1] neg_lo:[0,1] neg_hi:[0,1]
v_pk_fma_f32 v[120:121], v[220:221], v[32:33], v[120:121]
v_pk_fma_f32 v[122:123], v[222:223], v[34:35], v[122:123]
v_pk_fma_f32 v[124:125], v[224:225], v[36:37], v[124:125]
v_pk_fma_f32 v[126:127], v[226:227], v[38:39], v[126:127]
v_pk_mul_f32 v[244:245], v[236:237], s[62:63]
v_pk_mul_f32 v[246:247], v[238:239], s[62:63]
v_pk_mul_f32 v[248:249], v[240:241], s[62:63]
v_pk_mul_f32 v[250:251], v[242:243], s[62:63]
v_pk_add_f32 v[236:237], v[236:237], 1.0 op_sel_hi:[1,0]
v_pk_add_f32 v[238:239], v[238:239], 1.0 op_sel_hi:[1,0]
v_pk_add_f32 v[240:241], v[240:241], 1.0 op_sel_hi:[1,0]
v_pk_add_f32 v[242:243], v[242:243], 1.0 op_sel_hi:[1,0]
v_exp_f32 v244, v244
v_exp_f32 v245, v245
v_exp_f32 v246, v246
v_exp_f32 v247, v247
v_exp_f32 v248, v248
v_exp_f32 v249, v249
v_exp_f32 v250, v250
v_exp_f32 v251, v251
v_med3_f32 v236, v244, v236, 1.0
v_med3_f32 v237, v245, v237, 1.0
v_med3_f32 v238, v246, v238, 1.0
v_med3_f32 v239, v247, v239, 1.0
v_med3_f32 v240, v248, v240, 1.0
v_med3_f32 v241, v249, v241, 1.0
v_med3_f32 v242, v250, v242, 1.0
v_med3_f32 v243, v251, v243, 1.0
v_pk_add_f32 v[236:237], v[236:237], s[64:65]
v_pk_add_f32 v[238:239], v[238:239], s[64:65]
v_pk_add_f32 v[240:241], v[240:241], s[64:65]
v_pk_add_f32 v[242:243], v[242:243], s[64:65]
v_cvt_pk_bf16_f32 v52, v236, v237
v_cvt_pk_bf16_f32 v53, v238, v239
v_cvt_pk_bf16_f32 v54, v240, v241
v_cvt_pk_bf16_f32 v55, v242, v243
v_cvt_pk_bf16_f32 v56, v120, v121
v_cvt_pk_bf16_f32 v57, v122, v123
v_cvt_pk_bf16_f32 v58, v124, v125
v_cvt_pk_bf16_f32 v59, v126, v127
s_nop 1
v_mfma_f32_16x16x32_bf16 v[72:75], v[52:55], v[56:59], 0
v_mfma_f32_16x16x32_bf16 v[76:79], v[52:55], v[92:95], 0
v_pk_mul_f32 v[236:237], v[24:25], v[48:49] op_sel:[0,1] op_sel_hi:[1,1] neg_lo:[0,1] neg_hi:[0,1]
v_pk_mul_f32 v[238:239], v[26:27], v[48:49] op_sel:[0,1] op_sel_hi:[1,1] neg_lo:[0,1] neg_hi:[0,1]
v_pk_mul_f32 v[240:241], v[28:29], v[48:49] op_sel:[0,1] op_sel_hi:[1,1] neg_lo:[0,1] neg_hi:[0,1]
v_pk_mul_f32 v[242:243], v[30:31], v[48:49] op_sel:[0,1] op_sel_hi:[1,1] neg_lo:[0,1] neg_hi:[0,1]
v_pk_fma_f32 v[236:237], v[196:197], v[40:41], v[236:237]
v_pk_fma_f32 v[238:239], v[198:199], v[42:43], v[238:239]
v_pk_fma_f32 v[240:241], v[200:201], v[44:45], v[240:241]
v_pk_fma_f32 v[242:243], v[202:203], v[46:47], v[242:243]
v_pk_mul_f32 v[120:121], v[24:25], v[50:51] op_sel:[0,1] op_sel_hi:[1,1] neg_lo:[0,1] neg_hi:[0,1]
v_pk_mul_f32 v[122:123], v[26:27], v[50:51] op_sel:[0,1] op_sel_hi:[1,1] neg_lo:[0,1] neg_hi:[0,1]
v_pk_mul_f32 v[124:125], v[28:29], v[50:51] op_sel:[0,1] op_sel_hi:[1,1] neg_lo:[0,1] neg_hi:[0,1]
v_pk_mul_f32 v[126:127], v[30:31], v[50:51] op_sel:[0,1] op_sel_hi:[1,1] neg_lo:[0,1] neg_hi:[0,1]
v_pk_fma_f32 v[120:121], v[228:229], v[40:41], v[120:121]
v_pk_fma_f32 v[122:123], v[230:231], v[42:43], v[122:123]
v_pk_fma_f32 v[124:125], v[232:233], v[44:45], v[124:125]
v_pk_fma_f32 v[126:127], v[234:235], v[46:47], v[126:127]
v_pk_mul_f32 v[244:245], v[236:237], s[62:63]
v_pk_mul_f32 v[246:247], v[238:239], s[62:63]
v_pk_mul_f32 v[248:249], v[240:241], s[62:63]
v_pk_mul_f32 v[250:251], v[242:243], s[62:63]
v_pk_add_f32 v[236:237], v[236:237], 1.0 op_sel_hi:[1,0]
v_pk_add_f32 v[238:239], v[238:239], 1.0 op_sel_hi:[1,0]
v_pk_add_f32 v[240:241], v[240:241], 1.0 op_sel_hi:[1,0]
v_pk_add_f32 v[242:243], v[242:243], 1.0 op_sel_hi:[1,0]
v_exp_f32 v244, v244
v_exp_f32 v245, v245
v_exp_f32 v246, v246
v_exp_f32 v247, v247
v_exp_f32 v248, v248
v_exp_f32 v249, v249
v_exp_f32 v250, v250
v_exp_f32 v251, v251
v_med3_f32 v236, v244, v236, 1.0
v_med3_f32 v237, v245, v237, 1.0
v_med3_f32 v238, v246, v238, 1.0
v_med3_f32 v239, v247, v239, 1.0
v_med3_f32 v240, v248, v240, 1.0
v_med3_f32 v241, v249, v241, 1.0
v_med3_f32 v242, v250, v242, 1.0
v_med3_f32 v243, v251, v243, 1.0
v_pk_add_f32 v[236:237], v[236:237], s[64:65]
v_pk_add_f32 v[238:239], v[238:239], s[64:65]
v_pk_add_f32 v[240:241], v[240:241], s[64:65]
v_pk_add_f32 v[242:243], v[242:243], s[64:65]
v_cvt_pk_bf16_f32 v52, v236, v237
v_cvt_pk_bf16_f32 v53, v238, v239
v_cvt_pk_bf16_f32 v54, v240, v241
v_cvt_pk_bf16_f32 v55, v242, v243
v_cvt_pk_bf16_f32 v56, v120, v121
v_cvt_pk_bf16_f32 v57, v122, v123
v_cvt_pk_bf16_f32 v58, v124, v125
v_cvt_pk_bf16_f32 v59, v126, v127
s_nop 1
v_mfma_f32_16x16x32_bf16 v[72:75], v[52:55], v[56:59], v[72:75]
v_mfma_f32_16x16x32_bf16 v[76:79], v[52:55], v[92:95], v[76:79]
s_lshl_b32 s72, s31, 11
s_add_u32 s72, s72, 151552
v_add_u32 v104, s72, v101
s_xor_b32 s73, s31, 2
s_lshl_b32 s72, s73, 11
s_add_u32 s72, s72, 151552
v_add_u32 v105, s72, v101
s_cmp_eq_u32 s68, 0
s_cselect_b64 s[74:75], -1, 0
s_lshl_b32 s72, s28, 2
s_lshl_b32 s73, s61, 1
s_add_u32 s71, s72, s73
s_add_u32 s71, s71, s68
v_cndmask_b32 v108, v64, v72, s[74:75]
v_cndmask_b32 v109, v65, v73, s[74:75]
v_cndmask_b32 v110, v66, v74, s[74:75]
v_cndmask_b32 v111, v67, v75, s[74:75]
v_cndmask_b32 v112, v68, v76, s[74:75]
v_cndmask_b32 v113, v69, v77, s[74:75]
v_cndmask_b32 v114, v70, v78, s[74:75]
v_cndmask_b32 v115, v71, v79, s[74:75]
v_cndmask_b32 v64, v72, v64, s[74:75]
v_cndmask_b32 v65, v73, v65, s[74:75]
v_cndmask_b32 v66, v74, v66, s[74:75]
v_cndmask_b32 v67, v75, v67, s[74:75]
v_cndmask_b32 v68, v76, v68, s[74:75]
v_cndmask_b32 v69, v77, v69, s[74:75]
v_cndmask_b32 v70, v78, v70, s[74:75]
v_cndmask_b32 v71, v79, v71, s[74:75]
ds_write_b128 v104, v[108:111]
s_mov_b32 exec_lo, 0x00010001
s_mov_b32 exec_hi, 0x00010001
ds_write_b128 v104, v[112:115] offset:1024
s_mov_b64 exec, -1
v_mov_b32 v106, 1
s_mov_b64 exec, 1
ds_add_u32 v6, v106 offset:4
s_mov_b64 exec, -1
s_lshl_b32 s72, s71, 10
s_add_u32 s72, s72, 11534336
v_and_b32 v16, 3, v1
v_cmp_eq_u32 s[74:75], 1, v16
v_cmp_eq_u32 s[76:77], 2, v16
v_cmp_eq_u32 s[52:53], 3, v16
v_lshlrev_b32 v16, 2, v16
v_lshl_add_u32 v16, v102, 4, v16
v_lshlrev_b32 v17, 2, v1
k_kvsync:
ds_read_b32 v106, v6 offset:4
s_waitcnt lgkmcnt(0)
v_readfirstlane_b32 s73, v106
s_cmp_lt_u32 s73, 4
s_cbranch_scc1 k_kvsync
ds_read_b128 v[72:75], v105
ds_read_b128 v[76:79], v105 offset:1024
s_waitcnt lgkmcnt(0)
v_pk_add_f32 v[64:65], v[64:65], v[72:73]
v_pk_add_f32 v[66:67], v[66:67], v[74:75]
v_pk_add_f32 v[68:69], v[68:69], v[76:77]
v_pk_add_f32 v[70:71], v[70:71], v[78:79]
buffer_atomic_add_f32 v64, v17, s[44:47], s72 offen offset:0
buffer_atomic_add_f32 v65, v17, s[44:47], s72 offen offset:256
buffer_atomic_add_f32 v66, v17, s[44:47], s72 offen offset:512
buffer_atomic_add_f32 v67, v17, s[44:47], s72 offen offset:768
v_mov_b32_dpp v72, v68 quad_perm:[0,0,0,0] row_mask:0xf bank_mask:0xf
v_mov_b32_dpp v73, v69 quad_perm:[0,0,0,0] row_mask:0xf bank_mask:0xf
v_mov_b32_dpp v74, v70 quad_perm:[0,0,0,0] row_mask:0xf bank_mask:0xf
v_mov_b32_dpp v75, v71 quad_perm:[0,0,0,0] row_mask:0xf bank_mask:0xf
v_cndmask_b32 v72, v72, v73, s[74:75]
v_cndmask_b32 v72, v72, v74, s[76:77]
v_cndmask_b32 v72, v72, v75, s[52:53]
s_lshl_b32 s72, s71, 7
s_add_u32 s72, s72, 12058624
s_mov_b32 exec_lo, 0x000f000f
s_mov_b32 exec_hi, 0x000f000f
buffer_atomic_add_f32 v72, v16, s[44:47], s72 offen
s_mov_b64 exec, -1
s_lshl_b32 s76, s71, 7
s_lshl_b32 s72, s26, 2
s_add_u32 s76, s76, s72
s_add_u32 s76, s76, 12390400
k_ph2:
s_and_b32 s62, s2, 7
s_lshl_b32 s62, s62, 2
s_lshr_b32 s63, s58, 3
s_add_u32 s62, s62, s63
s_and_b32 s63, s58, 7
s_lshl_b32 s63, s63, 7
s_lshl_b32 s64, s68, 15
s_lshl_b32 s65, s61, 6
s_add_u32 s65, s65, s63
s_add_u32 s64, s64, s65
v_lshlrev_b32 v8, 3, v102
v_lshrrev_b32 v10, 2, v1
v_lshlrev_b32 v10, 10, v10
v_and_b32 v11, 3, v1
v_lshl_add_u32 v10, v11, 4, v10
s_lshl_b32 s72, s62, 16
s_add_u32 s48, s4, s72
s_addc_u32 s49, s5, 0
s_and_b32 s49, s49, 0xffff
s_mov_b32 s50, 65536
s_mov_b32 s51, 0x00020000
s_add_u32 s52, s20, s72
s_addc_u32 s53, s21, 0
s_and_b32 s53, s53, 0xffff
s_mov_b32 s54, 65536
s_mov_b32 s55, 0x00020000
s_mov_b32 s32, s18
s_and_b32 s33, s19, 0xffff
s_mov_b32 s34, 1024
s_mov_b32 s35, 0x00020000
v_bfe_u32 v18, v1, 2, 2
v_and_b32 v19, 3, v1
v_and_b32 v20, 1, v102
v_lshrrev_b32 v21, 1, v18
v_lshl_or_b32 v21, v20, 1, v21
v_lshl_add_u32 v18, v102, 2, v18
v_lshlrev_b32 v18, 7, v18
v_lshl_add_u32 v18, v19, 3, v18
s_lshl_b32 s73, s61, 1
v_xor_b32 v21, s73, v21
v_lshl_add_u32 v18, v21, 5, v18
s_lshl_b32 s73, s68, 11
v_add_u32 v2, s73, v101
v_add_u32 v3, 0x10000, v2
v_add_u32 v4, 0x20000, v2
v_add_u32 v19, 0x10000, v18
v_add_u32 v20, 0x20000, v18
v_xor_b32 v21, 32, v18
v_xor_b32 v22, 32, v19
v_xor_b32 v23, 32, v20
v_mov_b32 v152, 0
v_mov_b32 v153, 0
v_mov_b32 v154, 0
v_mov_b32 v155, 0
v_mov_b32 v156, 0
v_mov_b32 v157, 0
v_mov_b32 v158, 0
v_mov_b32 v159, 0
v_mov_b32 v160, 0
v_mov_b32 v161, 0
v_mov_b32 v162, 0
v_mov_b32 v163, 0
v_mov_b32 v164, 0
v_mov_b32 v165, 0
v_mov_b32 v166, 0
v_mov_b32 v167, 0
v_mov_b32 v168, 0
v_mov_b32 v169, 0
v_mov_b32 v170, 0
v_mov_b32 v171, 0
v_mov_b32 v172, 0
v_mov_b32 v173, 0
v_mov_b32 v174, 0
v_mov_b32 v175, 0
v_mov_b32 v176, 0
v_mov_b32 v177, 0
v_mov_b32 v178, 0
v_mov_b32 v179, 0
v_mov_b32 v180, 0
v_mov_b32 v181, 0
v_mov_b32 v182, 0
v_mov_b32 v183, 0
s_bitcmp1_b32 s27, 0
s_cbranch_scc1 k2_kf
k2_kf_b:
s_barrier
ds_read_b64_tr_b16 v[48:49], v19 offset:49152
ds_read_b64_tr_b16 v[50:51], v19 offset:51200
ds_read_b64_tr_b16 v[52:53], v22 offset:49152
ds_read_b64_tr_b16 v[54:55], v22 offset:51200
ds_read_b128 v[32:35], v2 offset:0
ds_read_b128 v[36:39], v2 offset:1024
ds_read_b64_tr_b16 v[56:57], v19 offset:53248
ds_read_b64_tr_b16 v[58:59], v19 offset:55296
ds_read_b64_tr_b16 v[60:61], v22 offset:53248
ds_read_b64_tr_b16 v[62:63], v22 offset:55296
ds_read_b128 v[40:43], v2 offset:4096
ds_read_b128 v[44:47], v2 offset:5120
s_barrier
ds_read_b64_tr_b16 v[120:121], v19 offset:57344
ds_read_b64_tr_b16 v[122:123], v19 offset:59392
ds_read_b64_tr_b16 v[124:125], v22 offset:57344
ds_read_b64_tr_b16 v[126:127], v22 offset:59392
ds_read_b128 v[104:107], v2 offset:8192
ds_read_b128 v[108:111], v2 offset:9216
ds_read_b64_tr_b16 v[128:129], v19 offset:61440
ds_read_b64_tr_b16 v[130:131], v19 offset:63488
ds_read_b64_tr_b16 v[132:133], v22 offset:61440
ds_read_b64_tr_b16 v[134:135], v22 offset:63488
ds_read_b128 v[112:115], v2 offset:12288
ds_read_b128 v[116:119], v2 offset:13312
s_waitcnt lgkmcnt(12)
s_barrier
v_mfma_f32_16x16x32_bf16 v[152:155], v[48:51], v[32:35], v[152:155]
ds_read_b64_tr_b16 v[80:81], v20 offset:0
v_mfma_f32_16x16x32_bf16 v[156:159], v[52:55], v[32:35], v[156:159]
ds_read_b64_tr_b16 v[82:83], v20 offset:2048
ds_read_b64_tr_b16 v[24:25], v23 offset:0
v_mfma_f32_16x16x32_bf16 v[160:163], v[48:51], v[36:39], v[160:163]
ds_read_b64_tr_b16 v[26:27], v23 offset:2048
ds_read_b128 v[64:67], v2 offset:16384
v_mfma_f32_16x16x32_bf16 v[164:167], v[52:55], v[36:39], v[164:167]
ds_read_b128 v[68:71], v2 offset:17408
ds_read_b64_tr_b16 v[136:137], v20 offset:4096
v_mfma_f32_16x16x32_bf16 v[152:155], v[56:59], v[40:43], v[152:155]
ds_read_b64_tr_b16 v[138:139], v20 offset:6144
ds_read_b64_tr_b16 v[248:249], v23 offset:4096
v_mfma_f32_16x16x32_bf16 v[156:159], v[60:63], v[40:43], v[156:159]
ds_read_b64_tr_b16 v[250:251], v23 offset:6144
ds_read_b128 v[72:75], v2 offset:20480
v_mfma_f32_16x16x32_bf16 v[160:163], v[56:59], v[44:47], v[160:163]
ds_read_b128 v[76:79], v2 offset:21504
v_mfma_f32_16x16x32_bf16 v[164:167], v[60:63], v[44:47], v[164:167]
s_waitcnt lgkmcnt(12)
s_barrier
v_mfma_f32_16x16x32_bf16 v[152:155], v[120:123], v[104:107], v[152:155]
ds_read_b64_tr_b16 v[48:49], v20 offset:8192
v_mfma_f32_16x16x32_bf16 v[156:159], v[124:127], v[104:107], v[156:159]
ds_read_b64_tr_b16 v[50:51], v20 offset:10240
ds_read_b64_tr_b16 v[52:53], v23 offset:8192
v_mfma_f32_16x16x32_bf16 v[160:163], v[120:123], v[108:111], v[160:163]
ds_read_b64_tr_b16 v[54:55], v23 offset:10240
ds_read_b128 v[32:35], v2 offset:24576
v_mfma_f32_16x16x32_bf16 v[164:167], v[124:127], v[108:111], v[164:167]
ds_read_b128 v[36:39], v2 offset:25600
ds_read_b64_tr_b16 v[56:57], v20 offset:12288
v_mfma_f32_16x16x32_bf16 v[152:155], v[128:131], v[112:115], v[152:155]
ds_read_b64_tr_b16 v[58:59], v20 offset:14336
ds_read_b64_tr_b16 v[60:61], v23 offset:12288
v_mfma_f32_16x16x32_bf16 v[156:159], v[132:135], v[112:115], v[156:159]
ds_read_b64_tr_b16 v[62:63], v23 offset:14336
ds_read_b128 v[40:43], v2 offset:28672
v_mfma_f32_16x16x32_bf16 v[160:163], v[128:131], v[116:119], v[160:163]
ds_read_b128 v[44:47], v2 offset:29696
v_mfma_f32_16x16x32_bf16 v[164:167], v[132:135], v[116:119], v[164:167]
s_waitcnt lgkmcnt(12)
s_barrier
v_mfma_f32_16x16x32_bf16 v[152:155], v[80:83], v[64:67], v[152:155]
ds_read_b64_tr_b16 v[120:121], v18 offset:49152
v_mfma_f32_16x16x32_bf16 v[156:159], v[24:27], v[64:67], v[156:159]
ds_read_b64_tr_b16 v[122:123], v18 offset:51200
ds_read_b64_tr_b16 v[124:125], v21 offset:49152
v_mfma_f32_16x16x32_bf16 v[160:163], v[80:83], v[68:71], v[160:163]
ds_read_b64_tr_b16 v[126:127], v21 offset:51200
ds_read_b128 v[104:107], v2 offset:0
v_mfma_f32_16x16x32_bf16 v[164:167], v[24:27], v[68:71], v[164:167]
ds_read_b128 v[108:111], v2 offset:1024
ds_read_b64_tr_b16 v[128:129], v18 offset:53248
v_mfma_f32_16x16x32_bf16 v[152:155], v[136:139], v[72:75], v[152:155]
ds_read_b64_tr_b16 v[130:131], v18 offset:55296
ds_read_b64_tr_b16 v[132:133], v21 offset:53248
v_mfma_f32_16x16x32_bf16 v[156:159], v[248:251], v[72:75], v[156:159]
ds_read_b64_tr_b16 v[134:135], v21 offset:55296
ds_read_b128 v[112:115], v2 offset:4096
v_mfma_f32_16x16x32_bf16 v[160:163], v[136:139], v[76:79], v[160:163]
ds_read_b128 v[116:119], v2 offset:5120
v_mfma_f32_16x16x32_bf16 v[164:167], v[248:251], v[76:79], v[164:167]
s_waitcnt lgkmcnt(12)
s_barrier
v_mfma_f32_16x16x32_bf16 v[152:155], v[48:51], v[32:35], v[152:155]
ds_read_b64_tr_b16 v[80:81], v18 offset:57344
v_mfma_f32_16x16x32_bf16 v[156:159], v[52:55], v[32:35], v[156:159]
ds_read_b64_tr_b16 v[82:83], v18 offset:59392
ds_read_b64_tr_b16 v[24:25], v21 offset:57344
v_mfma_f32_16x16x32_bf16 v[160:163], v[48:51], v[36:39], v[160:163]
ds_read_b64_tr_b16 v[26:27], v21 offset:59392
ds_read_b128 v[64:67], v3 offset:49152
v_mfma_f32_16x16x32_bf16 v[164:167], v[52:55], v[36:39], v[164:167]
ds_read_b128 v[68:71], v3 offset:50176
ds_read_b64_tr_b16 v[136:137], v18 offset:61440
v_mfma_f32_16x16x32_bf16 v[152:155], v[56:59], v[40:43], v[152:155]
ds_read_b64_tr_b16 v[138:139], v18 offset:63488
ds_read_b64_tr_b16 v[248:249], v21 offset:61440
v_mfma_f32_16x16x32_bf16 v[156:159], v[60:63], v[40:43], v[156:159]
ds_read_b64_tr_b16 v[250:251], v21 offset:63488
ds_read_b128 v[72:75], v3 offset:53248
v_mfma_f32_16x16x32_bf16 v[160:163], v[56:59], v[44:47], v[160:163]
ds_read_b128 v[76:79], v3 offset:54272
v_mfma_f32_16x16x32_bf16 v[164:167], v[60:63], v[44:47], v[164:167]
s_waitcnt lgkmcnt(12)
s_barrier
s_add_u32 s73, s64, 16384
buffer_load_dwordx4 v[140:143], v10, s[48:51], s64 offen
buffer_load_dwordx4 v[144:147], v10, s[48:51], s73 offen
buffer_load_dwordx2 v[148:149], v8, s[32:35], s65 offen
buffer_load_dwordx2 v[150:151], v8, s[32:35], s65 offen offset:32
v_mfma_f32_16x16x32_bf16 v[152:155], v[120:123], v[104:107], v[152:155]
ds_read_b64_tr_b16 v[48:49], v19 offset:0
v_mfma_f32_16x16x32_bf16 v[156:159], v[124:127], v[104:107], v[156:159]
ds_read_b64_tr_b16 v[50:51], v19 offset:2048
ds_read_b64_tr_b16 v[52:53], v22 offset:0
v_mfma_f32_16x16x32_bf16 v[160:163], v[120:123], v[108:111], v[160:163]
ds_read_b64_tr_b16 v[54:55], v22 offset:2048
ds_read_b128 v[32:35], v2 offset:8192
v_mfma_f32_16x16x32_bf16 v[164:167], v[124:127], v[108:111], v[164:167]
ds_read_b128 v[36:39], v2 offset:9216
ds_read_b64_tr_b16 v[56:57], v19 offset:4096
v_mfma_f32_16x16x32_bf16 v[152:155], v[128:131], v[112:115], v[152:155]
ds_read_b64_tr_b16 v[58:59], v19 offset:6144
ds_read_b64_tr_b16 v[60:61], v22 offset:4096
v_mfma_f32_16x16x32_bf16 v[156:159], v[132:135], v[112:115], v[156:159]
ds_read_b64_tr_b16 v[62:63], v22 offset:6144
ds_read_b128 v[40:43], v2 offset:12288
v_mfma_f32_16x16x32_bf16 v[160:163], v[128:131], v[116:119], v[160:163]
ds_read_b128 v[44:47], v2 offset:13312
v_mfma_f32_16x16x32_bf16 v[164:167], v[132:135], v[116:119], v[164:167]
s_waitcnt lgkmcnt(12)
s_barrier
v_mfma_f32_16x16x32_bf16 v[152:155], v[80:83], v[64:67], v[152:155]
ds_read_b64_tr_b16 v[120:121], v19 offset:8192
v_mfma_f32_16x16x32_bf16 v[156:159], v[24:27], v[64:67], v[156:159]
ds_read_b64_tr_b16 v[122:123], v19 offset:10240
ds_read_b64_tr_b16 v[124:125], v22 offset:8192
v_mfma_f32_16x16x32_bf16 v[160:163], v[80:83], v[68:71], v[160:163]
ds_read_b64_tr_b16 v[126:127], v22 offset:10240
ds_read_b128 v[104:107], v3 offset:57344
v_mfma_f32_16x16x32_bf16 v[164:167], v[24:27], v[68:71], v[164:167]
ds_read_b128 v[108:111], v3 offset:58368
ds_read_b64_tr_b16 v[128:129], v19 offset:12288
v_mfma_f32_16x16x32_bf16 v[152:155], v[136:139], v[72:75], v[152:155]
ds_read_b64_tr_b16 v[130:131], v19 offset:14336
ds_read_b64_tr_b16 v[132:133], v22 offset:12288
v_mfma_f32_16x16x32_bf16 v[156:159], v[248:251], v[72:75], v[156:159]
ds_read_b64_tr_b16 v[134:135], v22 offset:14336
ds_read_b128 v[112:115], v3 offset:61440
v_mfma_f32_16x16x32_bf16 v[160:163], v[136:139], v[76:79], v[160:163]
ds_read_b128 v[116:119], v3 offset:62464
v_mfma_f32_16x16x32_bf16 v[164:167], v[248:251], v[76:79], v[164:167]
s_waitcnt lgkmcnt(12)
s_barrier
v_mfma_f32_16x16x32_bf16 v[152:155], v[48:51], v[32:35], v[152:155]
ds_read_b64_tr_b16 v[80:81], v19 offset:16384
v_mfma_f32_16x16x32_bf16 v[156:159], v[52:55], v[32:35], v[156:159]
ds_read_b64_tr_b16 v[82:83], v19 offset:18432
ds_read_b64_tr_b16 v[24:25], v22 offset:16384
v_mfma_f32_16x16x32_bf16 v[160:163], v[48:51], v[36:39], v[160:163]
ds_read_b64_tr_b16 v[26:27], v22 offset:18432
ds_read_b128 v[64:67], v2 offset:16384
v_mfma_f32_16x16x32_bf16 v[164:167], v[52:55], v[36:39], v[164:167]
ds_read_b128 v[68:71], v2 offset:17408
ds_read_b64_tr_b16 v[136:137], v19 offset:20480
v_mfma_f32_16x16x32_bf16 v[152:155], v[56:59], v[40:43], v[152:155]
ds_read_b64_tr_b16 v[138:139], v19 offset:22528
ds_read_b64_tr_b16 v[248:249], v22 offset:20480
v_mfma_f32_16x16x32_bf16 v[156:159], v[60:63], v[40:43], v[156:159]
ds_read_b64_tr_b16 v[250:251], v22 offset:22528
ds_read_b128 v[72:75], v2 offset:20480
v_mfma_f32_16x16x32_bf16 v[160:163], v[56:59], v[44:47], v[160:163]
ds_read_b128 v[76:79], v2 offset:21504
v_mfma_f32_16x16x32_bf16 v[164:167], v[60:63], v[44:47], v[164:167]
s_waitcnt lgkmcnt(12)
s_barrier
v_mfma_f32_16x16x32_bf16 v[152:155], v[120:123], v[104:107], v[152:155]
ds_read_b64_tr_b16 v[48:49], v19 offset:24576
v_mfma_f32_16x16x32_bf16 v[156:159], v[124:127], v[104:107], v[156:159]
ds_read_b64_tr_b16 v[50:51], v19 offset:26624
ds_read_b64_tr_b16 v[52:53], v22 offset:24576
v_mfma_f32_16x16x32_bf16 v[160:163], v[120:123], v[108:111], v[160:163]
ds_read_b64_tr_b16 v[54:55], v22 offset:26624
ds_read_b128 v[32:35], v4 offset:0
v_mfma_f32_16x16x32_bf16 v[164:167], v[124:127], v[108:111], v[164:167]
ds_read_b128 v[36:39], v4 offset:1024
ds_read_b64_tr_b16 v[56:57], v19 offset:28672
v_mfma_f32_16x16x32_bf16 v[152:155], v[128:131], v[112:115], v[152:155]
ds_read_b64_tr_b16 v[58:59], v19 offset:30720
ds_read_b64_tr_b16 v[60:61], v22 offset:28672
v_mfma_f32_16x16x32_bf16 v[156:159], v[132:135], v[112:115], v[156:159]
ds_read_b64_tr_b16 v[62:63], v22 offset:30720
ds_read_b128 v[40:43], v4 offset:4096
v_mfma_f32_16x16x32_bf16 v[160:163], v[128:131], v[116:119], v[160:163]
ds_read_b128 v[44:47], v4 offset:5120
v_mfma_f32_16x16x32_bf16 v[164:167], v[132:135], v[116:119], v[164:167]
s_waitcnt lgkmcnt(12)
s_barrier
v_mfma_f32_16x16x32_bf16 v[152:155], v[80:83], v[64:67], v[152:155]
ds_read_b64_tr_b16 v[120:121], v19 offset:32768
v_mfma_f32_16x16x32_bf16 v[156:159], v[24:27], v[64:67], v[156:159]
ds_read_b64_tr_b16 v[122:123], v19 offset:34816
ds_read_b64_tr_b16 v[124:125], v22 offset:32768
v_mfma_f32_16x16x32_bf16 v[160:163], v[80:83], v[68:71], v[160:163]
ds_read_b64_tr_b16 v[126:127], v22 offset:34816
ds_read_b128 v[104:107], v2 offset:24576
v_mfma_f32_16x16x32_bf16 v[164:167], v[24:27], v[68:71], v[164:167]
ds_read_b128 v[108:111], v2 offset:25600
ds_read_b64_tr_b16 v[128:129], v19 offset:36864
v_mfma_f32_16x16x32_bf16 v[152:155], v[136:139], v[72:75], v[152:155]
ds_read_b64_tr_b16 v[130:131], v19 offset:38912
ds_read_b64_tr_b16 v[132:133], v22 offset:36864
v_mfma_f32_16x16x32_bf16 v[156:159], v[248:251], v[72:75], v[156:159]
ds_read_b64_tr_b16 v[134:135], v22 offset:38912
ds_read_b128 v[112:115], v2 offset:28672
v_mfma_f32_16x16x32_bf16 v[160:163], v[136:139], v[76:79], v[160:163]
ds_read_b128 v[116:119], v2 offset:29696
v_mfma_f32_16x16x32_bf16 v[164:167], v[248:251], v[76:79], v[164:167]
s_waitcnt lgkmcnt(12)
s_barrier
s_bitcmp0_b32 s27, 0
s_cbranch_scc1 k2_kc
k2_kc_b:
v_mfma_f32_16x16x32_bf16 v[152:155], v[48:51], v[32:35], v[152:155]
ds_read_b64_tr_b16 v[80:81], v19 offset:40960
v_mfma_f32_16x16x32_bf16 v[156:159], v[52:55], v[32:35], v[156:159]
ds_read_b64_tr_b16 v[82:83], v19 offset:43008
ds_read_b64_tr_b16 v[24:25], v22 offset:40960
v_mfma_f32_16x16x32_bf16 v[160:163], v[48:51], v[36:39], v[160:163]
ds_read_b64_tr_b16 v[26:27], v22 offset:43008
ds_read_b128 v[64:67], v4 offset:8192
v_mfma_f32_16x16x32_bf16 v[164:167], v[52:55], v[36:39], v[164:167]
ds_read_b128 v[68:71], v4 offset:9216
ds_read_b64_tr_b16 v[136:137], v19 offset:45056
v_mfma_f32_16x16x32_bf16 v[152:155], v[56:59], v[40:43], v[152:155]
ds_read_b64_tr_b16 v[138:139], v19 offset:47104
ds_read_b64_tr_b16 v[248:249], v22 offset:45056
v_mfma_f32_16x16x32_bf16 v[156:159], v[60:63], v[40:43], v[156:159]
ds_read_b64_tr_b16 v[250:251], v22 offset:47104
ds_read_b128 v[72:75], v4 offset:12288
v_mfma_f32_16x16x32_bf16 v[160:163], v[56:59], v[44:47], v[160:163]
ds_read_b128 v[76:79], v4 offset:13312
v_mfma_f32_16x16x32_bf16 v[164:167], v[60:63], v[44:47], v[164:167]
s_waitcnt lgkmcnt(12)
s_barrier
v_mfma_f32_16x16x32_bf16 v[152:155], v[120:123], v[104:107], v[152:155]
ds_read_b64_tr_b16 v[48:49], v18 offset:32768
v_mfma_f32_16x16x32_bf16 v[156:159], v[124:127], v[104:107], v[156:159]
ds_read_b64_tr_b16 v[50:51], v18 offset:34816
ds_read_b64_tr_b16 v[52:53], v21 offset:32768
v_mfma_f32_16x16x32_bf16 v[160:163], v[120:123], v[108:111], v[160:163]
ds_read_b64_tr_b16 v[54:55], v21 offset:34816
ds_read_b128 v[32:35], v2 offset:0
v_mfma_f32_16x16x32_bf16 v[164:167], v[124:127], v[108:111], v[164:167]
ds_read_b128 v[36:39], v2 offset:1024
ds_read_b64_tr_b16 v[56:57], v18 offset:36864
v_mfma_f32_16x16x32_bf16 v[152:155], v[128:131], v[112:115], v[152:155]
ds_read_b64_tr_b16 v[58:59], v18 offset:38912
ds_read_b64_tr_b16 v[60:61], v21 offset:36864
v_mfma_f32_16x16x32_bf16 v[156:159], v[132:135], v[112:115], v[156:159]
ds_read_b64_tr_b16 v[62:63], v21 offset:38912
ds_read_b128 v[40:43], v2 offset:4096
v_mfma_f32_16x16x32_bf16 v[160:163], v[128:131], v[116:119], v[160:163]
ds_read_b128 v[44:47], v2 offset:5120
v_mfma_f32_16x16x32_bf16 v[164:167], v[132:135], v[116:119], v[164:167]
s_waitcnt lgkmcnt(12)
s_barrier
s_bitcmp0_b32 s27, 0
s_cbranch_scc1 k2_ko
k2_ko_b:
v_mfma_f32_16x16x32_bf16 v[152:155], v[80:83], v[64:67], v[152:155]
ds_read_b64_tr_b16 v[120:121], v18 offset:40960
v_mfma_f32_16x16x32_bf16 v[156:159], v[24:27], v[64:67], v[156:159]
ds_read_b64_tr_b16 v[122:123], v18 offset:43008
ds_read_b64_tr_b16 v[124:125], v21 offset:40960
v_mfma_f32_16x16x32_bf16 v[160:163], v[80:83], v[68:71], v[160:163]
ds_read_b64_tr_b16 v[126:127], v21 offset:43008
ds_read_b128 v[104:107], v2 offset:49152
v_mfma_f32_16x16x32_bf16 v[164:167], v[24:27], v[68:71], v[164:167]
ds_read_b128 v[108:111], v2 offset:50176
ds_read_b64_tr_b16 v[128:129], v18 offset:45056
v_mfma_f32_16x16x32_bf16 v[152:155], v[136:139], v[72:75], v[152:155]
ds_read_b64_tr_b16 v[130:131], v18 offset:47104
ds_read_b64_tr_b16 v[132:133], v21 offset:45056
v_mfma_f32_16x16x32_bf16 v[156:159], v[248:251], v[72:75], v[156:159]
ds_read_b64_tr_b16 v[134:135], v21 offset:47104
ds_read_b128 v[112:115], v2 offset:53248
v_mfma_f32_16x16x32_bf16 v[160:163], v[136:139], v[76:79], v[160:163]
ds_read_b128 v[116:119], v2 offset:54272
v_mfma_f32_16x16x32_bf16 v[164:167], v[248:251], v[76:79], v[164:167]
s_waitcnt lgkmcnt(12)
s_barrier
v_mfma_f32_16x16x32_bf16 v[152:155], v[48:51], v[32:35], v[152:155]
ds_read_b64_tr_b16 v[80:81], v20 offset:16384
v_mfma_f32_16x16x32_bf16 v[156:159], v[52:55], v[32:35], v[156:159]
ds_read_b64_tr_b16 v[82:83], v20 offset:18432
ds_read_b64_tr_b16 v[24:25], v23 offset:16384
v_mfma_f32_16x16x32_bf16 v[160:163], v[48:51], v[36:39], v[160:163]
ds_read_b64_tr_b16 v[26:27], v23 offset:18432
ds_read_b128 v[64:67], v2 offset:57344
v_mfma_f32_16x16x32_bf16 v[164:167], v[52:55], v[36:39], v[164:167]
ds_read_b128 v[68:71], v2 offset:58368
ds_read_b64_tr_b16 v[136:137], v20 offset:20480
v_mfma_f32_16x16x32_bf16 v[152:155], v[56:59], v[40:43], v[152:155]
ds_read_b64_tr_b16 v[138:139], v20 offset:22528
ds_read_b64_tr_b16 v[248:249], v23 offset:20480
v_mfma_f32_16x16x32_bf16 v[156:159], v[60:63], v[40:43], v[156:159]
ds_read_b64_tr_b16 v[250:251], v23 offset:22528
ds_read_b128 v[72:75], v2 offset:61440
v_mfma_f32_16x16x32_bf16 v[160:163], v[56:59], v[44:47], v[160:163]
ds_read_b128 v[76:79], v2 offset:62464
v_mfma_f32_16x16x32_bf16 v[164:167], v[60:63], v[44:47], v[164:167]
s_waitcnt lgkmcnt(12)
s_barrier
v_mfma_f32_16x16x32_bf16 v[152:155], v[120:123], v[104:107], v[152:155]
ds_read_b64_tr_b16 v[48:49], v20 offset:24576
v_mfma_f32_16x16x32_bf16 v[156:159], v[124:127], v[104:107], v[156:159]
ds_read_b64_tr_b16 v[50:51], v20 offset:26624
ds_read_b64_tr_b16 v[52:53], v23 offset:24576
v_mfma_f32_16x16x32_bf16 v[160:163], v[120:123], v[108:111], v[160:163]
ds_read_b64_tr_b16 v[54:55], v23 offset:26624
ds_read_b128 v[32:35], v3 offset:0
v_mfma_f32_16x16x32_bf16 v[164:167], v[124:127], v[108:111], v[164:167]
ds_read_b128 v[36:39], v3 offset:1024
ds_read_b64_tr_b16 v[56:57], v20 offset:28672
v_mfma_f32_16x16x32_bf16 v[152:155], v[128:131], v[112:115], v[152:155]
ds_read_b64_tr_b16 v[58:59], v20 offset:30720
ds_read_b64_tr_b16 v[60:61], v23 offset:28672
v_mfma_f32_16x16x32_bf16 v[156:159], v[132:135], v[112:115], v[156:159]
ds_read_b64_tr_b16 v[62:63], v23 offset:30720
ds_read_b128 v[40:43], v3 offset:4096
v_mfma_f32_16x16x32_bf16 v[160:163], v[128:131], v[116:119], v[160:163]
ds_read_b128 v[44:47], v3 offset:5120
v_mfma_f32_16x16x32_bf16 v[164:167], v[132:135], v[116:119], v[164:167]
s_waitcnt lgkmcnt(12)
s_barrier
s_bitcmp0_b32 s27, 0
s_cbranch_scc1 k2_of
k2_of_b:
v_mfma_f32_16x16x32_bf16 v[152:155], v[80:83], v[64:67], v[152:155]
ds_read_b64_tr_b16 v[120:121], v19 offset:49152
v_mfma_f32_16x16x32_bf16 v[156:159], v[24:27], v[64:67], v[156:159]
ds_read_b64_tr_b16 v[122:123], v19 offset:51200
ds_read_b64_tr_b16 v[124:125], v22 offset:49152
v_mfma_f32_16x16x32_bf16 v[160:163], v[80:83], v[68:71], v[160:163]
ds_read_b64_tr_b16 v[126:127], v22 offset:51200
ds_read_b128 v[104:107], v3 offset:8192
v_mfma_f32_16x16x32_bf16 v[164:167], v[24:27], v[68:71], v[164:167]
ds_read_b128 v[108:111], v3 offset:9216
ds_read_b64_tr_b16 v[128:129], v19 offset:53248
v_mfma_f32_16x16x32_bf16 v[152:155], v[136:139], v[72:75], v[152:155]
ds_read_b64_tr_b16 v[130:131], v19 offset:55296
ds_read_b64_tr_b16 v[132:133], v22 offset:53248
v_mfma_f32_16x16x32_bf16 v[156:159], v[248:251], v[72:75], v[156:159]
ds_read_b64_tr_b16 v[134:135], v22 offset:55296
ds_read_b128 v[112:115], v3 offset:12288
v_mfma_f32_16x16x32_bf16 v[160:163], v[136:139], v[76:79], v[160:163]
ds_read_b128 v[116:119], v3 offset:13312
v_mfma_f32_16x16x32_bf16 v[164:167], v[248:251], v[76:79], v[164:167]
s_waitcnt lgkmcnt(12)
s_barrier
v_mfma_f32_16x16x32_bf16 v[152:155], v[48:51], v[32:35], v[152:155]
ds_read_b64_tr_b16 v[80:81], v18 offset:8192
v_mfma_f32_16x16x32_bf16 v[156:159], v[52:55], v[32:35], v[156:159]
ds_read_b64_tr_b16 v[82:83], v18 offset:10240
ds_read_b64_tr_b16 v[24:25], v21 offset:8192
v_mfma_f32_16x16x32_bf16 v[160:163], v[48:51], v[36:39], v[160:163]
ds_read_b64_tr_b16 v[26:27], v21 offset:10240
ds_read_b128 v[64:67], v3 offset:16384
v_mfma_f32_16x16x32_bf16 v[164:167], v[52:55], v[36:39], v[164:167]
ds_read_b128 v[68:71], v3 offset:17408
ds_read_b64_tr_b16 v[136:137], v18 offset:12288
v_mfma_f32_16x16x32_bf16 v[152:155], v[56:59], v[40:43], v[152:155]
ds_read_b64_tr_b16 v[138:139], v18 offset:14336
ds_read_b64_tr_b16 v[248:249], v21 offset:12288
v_mfma_f32_16x16x32_bf16 v[156:159], v[60:63], v[40:43], v[156:159]
ds_read_b64_tr_b16 v[250:251], v21 offset:14336
ds_read_b128 v[72:75], v3 offset:20480
v_mfma_f32_16x16x32_bf16 v[160:163], v[56:59], v[44:47], v[160:163]
ds_read_b128 v[76:79], v3 offset:21504
v_mfma_f32_16x16x32_bf16 v[164:167], v[60:63], v[44:47], v[164:167]
s_waitcnt lgkmcnt(12)
s_barrier
v_mfma_f32_16x16x32_bf16 v[152:155], v[120:123], v[104:107], v[152:155]
ds_read_b64_tr_b16 v[48:49], v19 offset:57344
v_mfma_f32_16x16x32_bf16 v[156:159], v[124:127], v[104:107], v[156:159]
ds_read_b64_tr_b16 v[50:51], v19 offset:59392
ds_read_b64_tr_b16 v[52:53], v22 offset:57344
v_mfma_f32_16x16x32_bf16 v[160:163], v[120:123], v[108:111], v[160:163]
ds_read_b64_tr_b16 v[54:55], v22 offset:59392
ds_read_b128 v[32:35], v3 offset:24576
v_mfma_f32_16x16x32_bf16 v[164:167], v[124:127], v[108:111], v[164:167]
ds_read_b128 v[36:39], v3 offset:25600
ds_read_b64_tr_b16 v[56:57], v19 offset:61440
v_mfma_f32_16x16x32_bf16 v[152:155], v[128:131], v[112:115], v[152:155]
ds_read_b64_tr_b16 v[58:59], v19 offset:63488
ds_read_b64_tr_b16 v[60:61], v22 offset:61440
v_mfma_f32_16x16x32_bf16 v[156:159], v[132:135], v[112:115], v[156:159]
ds_read_b64_tr_b16 v[62:63], v22 offset:63488
ds_read_b128 v[40:43], v3 offset:28672
v_mfma_f32_16x16x32_bf16 v[160:163], v[128:131], v[116:119], v[160:163]
ds_read_b128 v[44:47], v3 offset:29696
v_mfma_f32_16x16x32_bf16 v[164:167], v[132:135], v[116:119], v[164:167]
s_waitcnt lgkmcnt(12)
s_barrier
v_mfma_f32_16x16x32_bf16 v[152:155], v[80:83], v[64:67], v[152:155]
ds_read_b64_tr_b16 v[120:121], v18 offset:16384
v_mfma_f32_16x16x32_bf16 v[156:159], v[24:27], v[64:67], v[156:159]
ds_read_b64_tr_b16 v[122:123], v18 offset:18432
ds_read_b64_tr_b16 v[124:125], v21 offset:16384
v_mfma_f32_16x16x32_bf16 v[160:163], v[80:83], v[68:71], v[160:163]
ds_read_b64_tr_b16 v[126:127], v21 offset:18432
ds_read_b128 v[104:107], v3 offset:32768
v_mfma_f32_16x16x32_bf16 v[164:167], v[24:27], v[68:71], v[164:167]
ds_read_b128 v[108:111], v3 offset:33792
ds_read_b64_tr_b16 v[128:129], v18 offset:20480
v_mfma_f32_16x16x32_bf16 v[152:155], v[136:139], v[72:75], v[152:155]
ds_read_b64_tr_b16 v[130:131], v18 offset:22528
ds_read_b64_tr_b16 v[132:133], v21 offset:20480
v_mfma_f32_16x16x32_bf16 v[156:159], v[248:251], v[72:75], v[156:159]
ds_read_b64_tr_b16 v[134:135], v21 offset:22528
ds_read_b128 v[112:115], v3 offset:36864
v_mfma_f32_16x16x32_bf16 v[160:163], v[136:139], v[76:79], v[160:163]
ds_read_b128 v[116:119], v3 offset:37888
v_mfma_f32_16x16x32_bf16 v[164:167], v[248:251], v[76:79], v[164:167]
s_waitcnt lgkmcnt(12)
s_barrier
v_mfma_f32_16x16x32_bf16 v[152:155], v[48:51], v[32:35], v[152:155]
ds_read_b64_tr_b16 v[80:81], v20 offset:0
v_mfma_f32_16x16x32_bf16 v[156:159], v[52:55], v[32:35], v[156:159]
ds_read_b64_tr_b16 v[82:83], v20 offset:2048
ds_read_b64_tr_b16 v[24:25], v23 offset:0
v_mfma_f32_16x16x32_bf16 v[160:163], v[48:51], v[36:39], v[160:163]
ds_read_b64_tr_b16 v[26:27], v23 offset:2048
ds_read_b128 v[64:67], v3 offset:40960
v_mfma_f32_16x16x32_bf16 v[164:167], v[52:55], v[36:39], v[164:167]
ds_read_b128 v[68:71], v3 offset:41984
ds_read_b64_tr_b16 v[136:137], v20 offset:4096
v_mfma_f32_16x16x32_bf16 v[152:155], v[56:59], v[40:43], v[152:155]
ds_read_b64_tr_b16 v[138:139], v20 offset:6144
ds_read_b64_tr_b16 v[248:249], v23 offset:4096
v_mfma_f32_16x16x32_bf16 v[156:159], v[60:63], v[40:43], v[156:159]
ds_read_b64_tr_b16 v[250:251], v23 offset:6144
ds_read_b128 v[72:75], v3 offset:45056
v_mfma_f32_16x16x32_bf16 v[160:163], v[56:59], v[44:47], v[160:163]
ds_read_b128 v[76:79], v3 offset:46080
v_mfma_f32_16x16x32_bf16 v[164:167], v[60:63], v[44:47], v[164:167]
s_waitcnt lgkmcnt(12)
s_barrier
v_mfma_f32_16x16x32_bf16 v[152:155], v[120:123], v[104:107], v[152:155]
ds_read_b64_tr_b16 v[48:49], v18 offset:24576
v_mfma_f32_16x16x32_bf16 v[156:159], v[124:127], v[104:107], v[156:159]
ds_read_b64_tr_b16 v[50:51], v18 offset:26624
ds_read_b64_tr_b16 v[52:53], v21 offset:24576
v_mfma_f32_16x16x32_bf16 v[160:163], v[120:123], v[108:111], v[160:163]
ds_read_b64_tr_b16 v[54:55], v21 offset:26624
ds_read_b128 v[32:35], v2 offset:32768
v_mfma_f32_16x16x32_bf16 v[164:167], v[124:127], v[108:111], v[164:167]
ds_read_b128 v[36:39], v2 offset:33792
ds_read_b64_tr_b16 v[56:57], v18 offset:28672
v_mfma_f32_16x16x32_bf16 v[152:155], v[128:131], v[112:115], v[152:155]
ds_read_b64_tr_b16 v[58:59], v18 offset:30720
ds_read_b64_tr_b16 v[60:61], v21 offset:28672
v_mfma_f32_16x16x32_bf16 v[156:159], v[132:135], v[112:115], v[156:159]
ds_read_b64_tr_b16 v[62:63], v21 offset:30720
ds_read_b128 v[40:43], v2 offset:36864
v_mfma_f32_16x16x32_bf16 v[160:163], v[128:131], v[116:119], v[160:163]
ds_read_b128 v[44:47], v2 offset:37888
v_mfma_f32_16x16x32_bf16 v[164:167], v[132:135], v[116:119], v[164:167]
s_waitcnt lgkmcnt(12)
s_barrier
v_mfma_f32_16x16x32_bf16 v[152:155], v[80:83], v[64:67], v[152:155]
ds_read_b64_tr_b16 v[120:121], v20 offset:8192
v_mfma_f32_16x16x32_bf16 v[156:159], v[24:27], v[64:67], v[156:159]
ds_read_b64_tr_b16 v[122:123], v20 offset:10240
ds_read_b64_tr_b16 v[124:125], v23 offset:8192
v_mfma_f32_16x16x32_bf16 v[160:163], v[80:83], v[68:71], v[160:163]
ds_read_b64_tr_b16 v[126:127], v23 offset:10240
ds_read_b128 v[104:107], v2 offset:40960
v_mfma_f32_16x16x32_bf16 v[164:167], v[24:27], v[68:71], v[164:167]
ds_read_b128 v[108:111], v2 offset:41984
ds_read_b64_tr_b16 v[128:129], v20 offset:12288
v_mfma_f32_16x16x32_bf16 v[152:155], v[136:139], v[72:75], v[152:155]
ds_read_b64_tr_b16 v[130:131], v20 offset:14336
ds_read_b64_tr_b16 v[132:133], v23 offset:12288
v_mfma_f32_16x16x32_bf16 v[156:159], v[248:251], v[72:75], v[156:159]
ds_read_b64_tr_b16 v[134:135], v23 offset:14336
ds_read_b128 v[112:115], v2 offset:45056
v_mfma_f32_16x16x32_bf16 v[160:163], v[136:139], v[76:79], v[160:163]
ds_read_b128 v[116:119], v2 offset:46080
v_mfma_f32_16x16x32_bf16 v[164:167], v[248:251], v[76:79], v[164:167]
s_waitcnt lgkmcnt(12)
s_barrier
v_mfma_f32_16x16x32_bf16 v[152:155], v[48:51], v[32:35], v[152:155]
ds_read_b64_tr_b16 v[80:81], v18 offset:0
v_mfma_f32_16x16x32_bf16 v[156:159], v[52:55], v[32:35], v[156:159]
ds_read_b64_tr_b16 v[82:83], v18 offset:2048
ds_read_b64_tr_b16 v[24:25], v21 offset:0
v_mfma_f32_16x16x32_bf16 v[160:163], v[48:51], v[36:39], v[160:163]
ds_read_b64_tr_b16 v[26:27], v21 offset:2048
ds_read_b128 v[64:67], v4 offset:16384
v_mfma_f32_16x16x32_bf16 v[164:167], v[52:55], v[36:39], v[164:167]
ds_read_b128 v[68:71], v4 offset:17408
ds_read_b64_tr_b16 v[136:137], v18 offset:4096
v_mfma_f32_16x16x32_bf16 v[152:155], v[56:59], v[40:43], v[152:155]
ds_read_b64_tr_b16 v[138:139], v18 offset:6144
ds_read_b64_tr_b16 v[248:249], v21 offset:4096
v_mfma_f32_16x16x32_bf16 v[156:159], v[60:63], v[40:43], v[156:159]
ds_read_b64_tr_b16 v[250:251], v21 offset:6144
ds_read_b128 v[72:75], v4 offset:20480
v_mfma_f32_16x16x32_bf16 v[160:163], v[56:59], v[44:47], v[160:163]
ds_read_b128 v[76:79], v4 offset:21504
v_mfma_f32_16x16x32_bf16 v[164:167], v[60:63], v[44:47], v[164:167]
s_waitcnt lgkmcnt(12)
s_barrier
v_mfma_f32_16x16x32_bf16 v[152:155], v[120:123], v[104:107], v[152:155]
ds_read_b64_tr_b16 v[48:49], v18 offset:49152
v_mfma_f32_16x16x32_bf16 v[156:159], v[124:127], v[104:107], v[156:159]
ds_read_b64_tr_b16 v[50:51], v18 offset:51200
ds_read_b64_tr_b16 v[52:53], v21 offset:49152
v_mfma_f32_16x16x32_bf16 v[160:163], v[120:123], v[108:111], v[160:163]
ds_read_b64_tr_b16 v[54:55], v21 offset:51200
ds_read_b128 v[32:35], v4 offset:24576
v_mfma_f32_16x16x32_bf16 v[164:167], v[124:127], v[108:111], v[164:167]
ds_read_b128 v[36:39], v4 offset:25600
ds_read_b64_tr_b16 v[56:57], v18 offset:53248
v_mfma_f32_16x16x32_bf16 v[152:155], v[128:131], v[112:115], v[152:155]
ds_read_b64_tr_b16 v[58:59], v18 offset:55296
ds_read_b64_tr_b16 v[60:61], v21 offset:53248
v_mfma_f32_16x16x32_bf16 v[156:159], v[132:135], v[112:115], v[156:159]
ds_read_b64_tr_b16 v[62:63], v21 offset:55296
ds_read_b128 v[40:43], v4 offset:28672
v_mfma_f32_16x16x32_bf16 v[160:163], v[128:131], v[116:119], v[160:163]
ds_read_b128 v[44:47], v4 offset:29696
v_mfma_f32_16x16x32_bf16 v[164:167], v[132:135], v[116:119], v[164:167]
s_waitcnt lgkmcnt(12)
s_barrier
v_mfma_f32_16x16x32_bf16 v[152:155], v[80:83], v[64:67], v[152:155]
ds_read_b64_tr_b16 v[120:121], v18 offset:57344
v_mfma_f32_16x16x32_bf16 v[156:159], v[24:27], v[64:67], v[156:159]
ds_read_b64_tr_b16 v[122:123], v18 offset:59392
ds_read_b64_tr_b16 v[124:125], v21 offset:57344
v_mfma_f32_16x16x32_bf16 v[160:163], v[80:83], v[68:71], v[160:163]
ds_read_b64_tr_b16 v[126:127], v21 offset:59392
ds_read_b128 v[104:107], v3 offset:49152
v_mfma_f32_16x16x32_bf16 v[164:167], v[24:27], v[68:71], v[164:167]
ds_read_b128 v[108:111], v3 offset:50176
ds_read_b64_tr_b16 v[128:129], v18 offset:61440
v_mfma_f32_16x16x32_bf16 v[152:155], v[136:139], v[72:75], v[152:155]
ds_read_b64_tr_b16 v[130:131], v18 offset:63488
ds_read_b64_tr_b16 v[132:133], v21 offset:61440
v_mfma_f32_16x16x32_bf16 v[156:159], v[248:251], v[72:75], v[156:159]
ds_read_b64_tr_b16 v[134:135], v21 offset:63488
ds_read_b128 v[112:115], v3 offset:53248
v_mfma_f32_16x16x32_bf16 v[160:163], v[136:139], v[76:79], v[160:163]
ds_read_b128 v[116:119], v3 offset:54272
v_mfma_f32_16x16x32_bf16 v[164:167], v[248:251], v[76:79], v[164:167]
s_waitcnt lgkmcnt(12)
s_barrier
s_waitcnt vmcnt(0)
s_mov_b32 s62, 0xbfb8aa3b
s_mov_b32 s63, 0xbfb8aa3b
v_mfma_f32_16x16x32_bf16 v[152:155], v[48:51], v[32:35], v[152:155]
ds_read_b64_tr_b16 v[80:81], v19 offset:0
v_mfma_f32_16x16x32_bf16 v[156:159], v[52:55], v[32:35], v[156:159]
ds_read_b64_tr_b16 v[82:83], v19 offset:2048
ds_read_b64_tr_b16 v[24:25], v22 offset:0
v_mfma_f32_16x16x32_bf16 v[160:163], v[48:51], v[36:39], v[160:163]
ds_read_b64_tr_b16 v[26:27], v22 offset:2048
ds_read_b128 v[64:67], v2 offset:8192
v_mfma_f32_16x16x32_bf16 v[164:167], v[52:55], v[36:39], v[164:167]
ds_read_b128 v[68:71], v2 offset:9216
ds_read_b64_tr_b16 v[136:137], v19 offset:4096
v_mfma_f32_16x16x32_bf16 v[152:155], v[56:59], v[40:43], v[152:155]
ds_read_b64_tr_b16 v[138:139], v19 offset:6144
ds_read_b64_tr_b16 v[248:249], v22 offset:4096
v_mfma_f32_16x16x32_bf16 v[156:159], v[60:63], v[40:43], v[156:159]
ds_read_b64_tr_b16 v[250:251], v22 offset:6144
ds_read_b128 v[72:75], v2 offset:12288
v_mfma_f32_16x16x32_bf16 v[160:163], v[56:59], v[44:47], v[160:163]
ds_read_b128 v[76:79], v2 offset:13312
v_mfma_f32_16x16x32_bf16 v[164:167], v[60:63], v[44:47], v[164:167]
v_lshlrev_b32 v184, 16, v148
v_and_b32 v185, 0xffff0000, v148
v_lshlrev_b32 v186, 16, v149
v_and_b32 v187, 0xffff0000, v149
v_lshlrev_b32 v188, 16, v150
v_and_b32 v189, 0xffff0000, v150
v_lshlrev_b32 v190, 16, v151
v_and_b32 v191, 0xffff0000, v151
s_waitcnt lgkmcnt(12)
s_barrier
v_mfma_f32_16x16x32_bf16 v[152:155], v[120:123], v[104:107], v[152:155]
ds_read_b64_tr_b16 v[48:49], v19 offset:8192
v_mfma_f32_16x16x32_bf16 v[156:159], v[124:127], v[104:107], v[156:159]
ds_read_b64_tr_b16 v[50:51], v19 offset:10240
ds_read_b64_tr_b16 v[52:53], v22 offset:8192
v_mfma_f32_16x16x32_bf16 v[160:163], v[120:123], v[108:111], v[160:163]
ds_read_b64_tr_b16 v[54:55], v22 offset:10240
ds_read_b128 v[32:35], v3 offset:57344
v_mfma_f32_16x16x32_bf16 v[164:167], v[124:127], v[108:111], v[164:167]
ds_read_b128 v[36:39], v3 offset:58368
ds_read_b64_tr_b16 v[56:57], v19 offset:12288
v_mfma_f32_16x16x32_bf16 v[152:155], v[128:131], v[112:115], v[152:155]
ds_read_b64_tr_b16 v[58:59], v19 offset:14336
ds_read_b64_tr_b16 v[60:61], v22 offset:12288
v_mfma_f32_16x16x32_bf16 v[156:159], v[132:135], v[112:115], v[156:159]
ds_read_b64_tr_b16 v[62:63], v22 offset:14336
ds_read_b128 v[40:43], v3 offset:61440
v_mfma_f32_16x16x32_bf16 v[160:163], v[128:131], v[116:119], v[160:163]
ds_read_b128 v[44:47], v3 offset:62464
v_mfma_f32_16x16x32_bf16 v[164:167], v[132:135], v[116:119], v[164:167]
v_lshlrev_b32 v192, 16, v140
v_and_b32 v193, 0xffff0000, v140
v_lshlrev_b32 v194, 16, v141
v_and_b32 v195, 0xffff0000, v141
v_lshlrev_b32 v196, 16, v142
v_and_b32 v197, 0xffff0000, v142
v_lshlrev_b32 v198, 16, v143
v_and_b32 v199, 0xffff0000, v143
s_waitcnt lgkmcnt(12)
s_barrier
v_mfma_f32_16x16x32_bf16 v[152:155], v[80:83], v[64:67], v[152:155]
ds_read_b64_tr_b16 v[120:121], v19 offset:16384
v_mfma_f32_16x16x32_bf16 v[156:159], v[24:27], v[64:67], v[156:159]
ds_read_b64_tr_b16 v[122:123], v19 offset:18432
ds_read_b64_tr_b16 v[124:125], v22 offset:16384
v_mfma_f32_16x16x32_bf16 v[160:163], v[80:83], v[68:71], v[160:163]
ds_read_b64_tr_b16 v[126:127], v22 offset:18432
ds_read_b128 v[104:107], v2 offset:16384
v_mfma_f32_16x16x32_bf16 v[164:167], v[24:27], v[68:71], v[164:167]
ds_read_b128 v[108:111], v2 offset:17408
ds_read_b64_tr_b16 v[128:129], v19 offset:20480
v_mfma_f32_16x16x32_bf16 v[152:155], v[136:139], v[72:75], v[152:155]
ds_read_b64_tr_b16 v[130:131], v19 offset:22528
ds_read_b64_tr_b16 v[132:133], v22 offset:20480
v_mfma_f32_16x16x32_bf16 v[156:159], v[248:251], v[72:75], v[156:159]
ds_read_b64_tr_b16 v[134:135], v22 offset:22528
ds_read_b128 v[112:115], v2 offset:20480
v_mfma_f32_16x16x32_bf16 v[160:163], v[136:139], v[76:79], v[160:163]
ds_read_b128 v[116:119], v2 offset:21504
v_mfma_f32_16x16x32_bf16 v[164:167], v[248:251], v[76:79], v[164:167]
v_lshlrev_b32 v200, 16, v144
v_and_b32 v201, 0xffff0000, v144
v_lshlrev_b32 v202, 16, v145
v_and_b32 v203, 0xffff0000, v145
v_lshlrev_b32 v204, 16, v146
v_and_b32 v205, 0xffff0000, v146
v_lshlrev_b32 v206, 16, v147
v_and_b32 v207, 0xffff0000, v147
s_waitcnt lgkmcnt(12)
s_barrier
v_mfma_f32_16x16x32_bf16 v[152:155], v[48:51], v[32:35], v[152:155]
ds_read_b64_tr_b16 v[80:81], v19 offset:24576
v_mfma_f32_16x16x32_bf16 v[156:159], v[52:55], v[32:35], v[156:159]
ds_read_b64_tr_b16 v[82:83], v19 offset:26624
ds_read_b64_tr_b16 v[24:25], v22 offset:24576
v_mfma_f32_16x16x32_bf16 v[160:163], v[48:51], v[36:39], v[160:163]
ds_read_b64_tr_b16 v[26:27], v22 offset:26624
ds_read_b128 v[64:67], v4 offset:0
v_mfma_f32_16x16x32_bf16 v[164:167], v[52:55], v[36:39], v[164:167]
ds_read_b128 v[68:71], v4 offset:1024
ds_read_b64_tr_b16 v[136:137], v19 offset:28672
v_mfma_f32_16x16x32_bf16 v[152:155], v[56:59], v[40:43], v[152:155]
ds_read_b64_tr_b16 v[138:139], v19 offset:30720
ds_read_b64_tr_b16 v[248:249], v22 offset:28672
v_mfma_f32_16x16x32_bf16 v[156:159], v[60:63], v[40:43], v[156:159]
ds_read_b64_tr_b16 v[250:251], v22 offset:30720
ds_read_b128 v[72:75], v4 offset:4096
v_mfma_f32_16x16x32_bf16 v[160:163], v[56:59], v[44:47], v[160:163]
ds_read_b128 v[76:79], v4 offset:5120
v_mfma_f32_16x16x32_bf16 v[164:167], v[60:63], v[44:47], v[164:167]
v_and_b32 v12, 7, v1
v_xor_b32 v12, v102, v12
v_lshlrev_b32 v12, 4, v12
v_lshl_add_u32 v12, v100, 7, v12
s_lshl_b32 s72, s31, 12
s_add_u32 s72, s72, 0
v_add_u32 v12, s72, v12
v_xor_b32 v13, 64, v12
v_lshrrev_b32 v5, 2, v1
v_and_b32 v6, 7, v5
v_lshlrev_b32 v7, 1, v11
v_xor_b32 v6, v6, v7
v_lshlrev_b32 v6, 4, v6
v_lshl_add_u32 v5, v5, 7, v6
v_add_u32 v5, s72, v5
v_xor_b32 v6, 16, v5
s_waitcnt lgkmcnt(12)
s_barrier
v_mfma_f32_16x16x32_bf16 v[168:171], v[120:123], v[104:107], v[168:171]
ds_read_b64_tr_b16 v[48:49], v19 offset:32768
v_mfma_f32_16x16x32_bf16 v[172:175], v[124:127], v[104:107], v[172:175]
ds_read_b64_tr_b16 v[50:51], v19 offset:34816
ds_read_b64_tr_b16 v[52:53], v22 offset:32768
v_mfma_f32_16x16x32_bf16 v[176:179], v[120:123], v[108:111], v[176:179]
ds_read_b64_tr_b16 v[54:55], v22 offset:34816
ds_read_b128 v[32:35], v2 offset:24576
v_mfma_f32_16x16x32_bf16 v[180:183], v[124:127], v[108:111], v[180:183]
ds_read_b128 v[36:39], v2 offset:25600
ds_read_b64_tr_b16 v[56:57], v19 offset:36864
v_mfma_f32_16x16x32_bf16 v[168:171], v[128:131], v[112:115], v[168:171]
ds_read_b64_tr_b16 v[58:59], v19 offset:38912
ds_read_b64_tr_b16 v[60:61], v22 offset:36864
v_mfma_f32_16x16x32_bf16 v[172:175], v[132:135], v[112:115], v[172:175]
ds_read_b64_tr_b16 v[62:63], v22 offset:38912
ds_read_b128 v[40:43], v2 offset:28672
v_mfma_f32_16x16x32_bf16 v[176:179], v[128:131], v[116:119], v[176:179]
ds_read_b128 v[44:47], v2 offset:29696
v_mfma_f32_16x16x32_bf16 v[180:183], v[132:135], v[116:119], v[180:183]
v_pk_add_f32 v[152:153], v[152:153], v[184:185]
v_pk_add_f32 v[154:155], v[154:155], v[186:187]
v_pk_add_f32 v[156:157], v[156:157], v[188:189]
v_pk_add_f32 v[158:159], v[158:159], v[190:191]
v_pk_add_f32 v[160:161], v[160:161], v[184:185]
v_pk_add_f32 v[162:163], v[162:163], v[186:187]
v_pk_add_f32 v[164:165], v[164:165], v[188:189]
v_pk_add_f32 v[166:167], v[166:167], v[190:191]
s_waitcnt lgkmcnt(12)
s_barrier
v_mfma_f32_16x16x32_bf16 v[168:171], v[80:83], v[64:67], v[168:171]
ds_read_b64_tr_b16 v[120:121], v19 offset:40960
v_mfma_f32_16x16x32_bf16 v[172:175], v[24:27], v[64:67], v[172:175]
ds_read_b64_tr_b16 v[122:123], v19 offset:43008
ds_read_b64_tr_b16 v[124:125], v22 offset:40960
v_mfma_f32_16x16x32_bf16 v[176:179], v[80:83], v[68:71], v[176:179]
ds_read_b64_tr_b16 v[126:127], v22 offset:43008
ds_read_b128 v[104:107], v4 offset:8192
v_mfma_f32_16x16x32_bf16 v[180:183], v[24:27], v[68:71], v[180:183]
ds_read_b128 v[108:111], v4 offset:9216
ds_read_b64_tr_b16 v[128:129], v19 offset:45056
v_mfma_f32_16x16x32_bf16 v[168:171], v[136:139], v[72:75], v[168:171]
ds_read_b64_tr_b16 v[130:131], v19 offset:47104
ds_read_b64_tr_b16 v[132:133], v22 offset:45056
v_mfma_f32_16x16x32_bf16 v[172:175], v[248:251], v[72:75], v[172:175]
ds_read_b64_tr_b16 v[134:135], v22 offset:47104
ds_read_b128 v[112:115], v4 offset:12288
v_mfma_f32_16x16x32_bf16 v[176:179], v[136:139], v[76:79], v[176:179]
ds_read_b128 v[116:119], v4 offset:13312
v_mfma_f32_16x16x32_bf16 v[180:183], v[248:251], v[76:79], v[180:183]
v_pk_mul_f32 v[208:209], v[152:153], s[62:63]
v_pk_mul_f32 v[210:211], v[154:155], s[62:63]
v_pk_mul_f32 v[212:213], v[156:157], s[62:63]
v_pk_mul_f32 v[214:215], v[158:159], s[62:63]
v_pk_mul_f32 v[216:217], v[160:161], s[62:63]
v_pk_mul_f32 v[218:219], v[162:163], s[62:63]
v_pk_mul_f32 v[220:221], v[164:165], s[62:63]
v_pk_mul_f32 v[222:223], v[166:167], s[62:63]
s_waitcnt lgkmcnt(12)
s_barrier
v_mfma_f32_16x16x32_bf16 v[168:171], v[48:51], v[32:35], v[168:171]
ds_read_b64_tr_b16 v[80:81], v18 offset:32768
v_mfma_f32_16x16x32_bf16 v[172:175], v[52:55], v[32:35], v[172:175]
ds_read_b64_tr_b16 v[82:83], v18 offset:34816
ds_read_b64_tr_b16 v[24:25], v21 offset:32768
v_mfma_f32_16x16x32_bf16 v[176:179], v[48:51], v[36:39], v[176:179]
ds_read_b64_tr_b16 v[26:27], v21 offset:34816
ds_read_b128 v[64:67], v2 offset:0
v_mfma_f32_16x16x32_bf16 v[180:183], v[52:55], v[36:39], v[180:183]
ds_read_b128 v[68:71], v2 offset:1024
ds_read_b64_tr_b16 v[136:137], v18 offset:36864
v_mfma_f32_16x16x32_bf16 v[168:171], v[56:59], v[40:43], v[168:171]
ds_read_b64_tr_b16 v[138:139], v18 offset:38912
ds_read_b64_tr_b16 v[248:249], v21 offset:36864
v_mfma_f32_16x16x32_bf16 v[172:175], v[60:63], v[40:43], v[172:175]
ds_read_b64_tr_b16 v[250:251], v21 offset:38912
ds_read_b128 v[72:75], v2 offset:4096
v_mfma_f32_16x16x32_bf16 v[176:179], v[56:59], v[44:47], v[176:179]
ds_read_b128 v[76:79], v2 offset:5120
v_mfma_f32_16x16x32_bf16 v[180:183], v[60:63], v[44:47], v[180:183]
v_exp_f32 v208, v208
v_exp_f32 v209, v209
v_exp_f32 v210, v210
v_exp_f32 v211, v211
v_exp_f32 v212, v212
v_exp_f32 v213, v213
v_exp_f32 v214, v214
v_exp_f32 v215, v215
s_waitcnt lgkmcnt(12)
s_barrier
v_mfma_f32_16x16x32_bf16 v[168:171], v[120:123], v[104:107], v[168:171]
ds_read_b64_tr_b16 v[48:49], v18 offset:40960
v_mfma_f32_16x16x32_bf16 v[172:175], v[124:127], v[104:107], v[172:175]
ds_read_b64_tr_b16 v[50:51], v18 offset:43008
ds_read_b64_tr_b16 v[52:53], v21 offset:40960
v_mfma_f32_16x16x32_bf16 v[176:179], v[120:123], v[108:111], v[176:179]
ds_read_b64_tr_b16 v[54:55], v21 offset:43008
ds_read_b128 v[32:35], v2 offset:49152
v_mfma_f32_16x16x32_bf16 v[180:183], v[124:127], v[108:111], v[180:183]
ds_read_b128 v[36:39], v2 offset:50176
ds_read_b64_tr_b16 v[56:57], v18 offset:45056
v_mfma_f32_16x16x32_bf16 v[168:171], v[128:131], v[112:115], v[168:171]
ds_read_b64_tr_b16 v[58:59], v18 offset:47104
ds_read_b64_tr_b16 v[60:61], v21 offset:45056
v_mfma_f32_16x16x32_bf16 v[172:175], v[132:135], v[112:115], v[172:175]
ds_read_b64_tr_b16 v[62:63], v21 offset:47104
ds_read_b128 v[40:43], v2 offset:53248
v_mfma_f32_16x16x32_bf16 v[176:179], v[128:131], v[116:119], v[176:179]
ds_read_b128 v[44:47], v2 offset:54272
v_mfma_f32_16x16x32_bf16 v[180:183], v[132:135], v[116:119], v[180:183]
v_exp_f32 v216, v216
v_exp_f32 v217, v217
v_exp_f32 v218, v218
v_exp_f32 v219, v219
v_exp_f32 v220, v220
v_exp_f32 v221, v221
v_exp_f32 v222, v222
v_exp_f32 v223, v223
s_waitcnt lgkmcnt(12)
s_barrier
v_mfma_f32_16x16x32_bf16 v[168:171], v[80:83], v[64:67], v[168:171]
ds_read_b64_tr_b16 v[120:121], v20 offset:16384
v_mfma_f32_16x16x32_bf16 v[172:175], v[24:27], v[64:67], v[172:175]
ds_read_b64_tr_b16 v[122:123], v20 offset:18432
ds_read_b64_tr_b16 v[124:125], v23 offset:16384
v_mfma_f32_16x16x32_bf16 v[176:179], v[80:83], v[68:71], v[176:179]
ds_read_b64_tr_b16 v[126:127], v23 offset:18432
ds_read_b128 v[104:107], v3 offset:49152
v_mfma_f32_16x16x32_bf16 v[180:183], v[24:27], v[68:71], v[180:183]
ds_read_b128 v[108:111], v3 offset:50176
ds_read_b64_tr_b16 v[128:129], v20 offset:20480
v_mfma_f32_16x16x32_bf16 v[168:171], v[136:139], v[72:75], v[168:171]
ds_read_b64_tr_b16 v[130:131], v20 offset:22528
ds_read_b64_tr_b16 v[132:133], v23 offset:20480
v_mfma_f32_16x16x32_bf16 v[172:175], v[248:251], v[72:75], v[172:175]
ds_read_b64_tr_b16 v[134:135], v23 offset:22528
ds_read_b128 v[112:115], v3 offset:53248
v_mfma_f32_16x16x32_bf16 v[176:179], v[136:139], v[76:79], v[176:179]
ds_read_b128 v[116:119], v3 offset:54272
v_mfma_f32_16x16x32_bf16 v[180:183], v[248:251], v[76:79], v[180:183]
v_pk_add_f32 v[208:209], v[208:209], 1.0 op_sel_hi:[1,0]
v_pk_add_f32 v[210:211], v[210:211], 1.0 op_sel_hi:[1,0]
v_pk_add_f32 v[212:213], v[212:213], 1.0 op_sel_hi:[1,0]
v_pk_add_f32 v[214:215], v[214:215], 1.0 op_sel_hi:[1,0]
v_pk_add_f32 v[216:217], v[216:217], 1.0 op_sel_hi:[1,0]
v_pk_add_f32 v[218:219], v[218:219], 1.0 op_sel_hi:[1,0]
v_pk_add_f32 v[220:221], v[220:221], 1.0 op_sel_hi:[1,0]
v_pk_add_f32 v[222:223], v[222:223], 1.0 op_sel_hi:[1,0]
s_waitcnt lgkmcnt(12)
s_barrier
v_mfma_f32_16x16x32_bf16 v[168:171], v[48:51], v[32:35], v[168:171]
ds_read_b64_tr_b16 v[80:81], v20 offset:24576
v_mfma_f32_16x16x32_bf16 v[172:175], v[52:55], v[32:35], v[172:175]
ds_read_b64_tr_b16 v[82:83], v20 offset:26624
ds_read_b64_tr_b16 v[24:25], v23 offset:24576
v_mfma_f32_16x16x32_bf16 v[176:179], v[48:51], v[36:39], v[176:179]
ds_read_b64_tr_b16 v[26:27], v23 offset:26624
ds_read_b128 v[64:67], v2 offset:57344
v_mfma_f32_16x16x32_bf16 v[180:183], v[52:55], v[36:39], v[180:183]
ds_read_b128 v[68:71], v2 offset:58368
ds_read_b64_tr_b16 v[136:137], v20 offset:28672
v_mfma_f32_16x16x32_bf16 v[168:171], v[56:59], v[40:43], v[168:171]
ds_read_b64_tr_b16 v[138:139], v20 offset:30720
ds_read_b64_tr_b16 v[248:249], v23 offset:28672
v_mfma_f32_16x16x32_bf16 v[172:175], v[60:63], v[40:43], v[172:175]
ds_read_b64_tr_b16 v[250:251], v23 offset:30720
ds_read_b128 v[72:75], v2 offset:61440
v_mfma_f32_16x16x32_bf16 v[176:179], v[56:59], v[44:47], v[176:179]
ds_read_b128 v[76:79], v2 offset:62464
v_mfma_f32_16x16x32_bf16 v[180:183], v[60:63], v[44:47], v[180:183]
v_rcp_f32 v208, v208
v_rcp_f32 v209, v209
v_rcp_f32 v210, v210
v_rcp_f32 v211, v211
v_rcp_f32 v212, v212
v_rcp_f32 v213, v213
v_rcp_f32 v214, v214
v_rcp_f32 v215, v215
s_waitcnt lgkmcnt(12)
v_mfma_f32_16x16x32_bf16 v[168:171], v[120:123], v[104:107], v[168:171]
v_mfma_f32_16x16x32_bf16 v[172:175], v[124:127], v[104:107], v[172:175]
v_mfma_f32_16x16x32_bf16 v[176:179], v[120:123], v[108:111], v[176:179]
v_mfma_f32_16x16x32_bf16 v[180:183], v[124:127], v[108:111], v[180:183]
v_mfma_f32_16x16x32_bf16 v[168:171], v[128:131], v[112:115], v[168:171]
v_mfma_f32_16x16x32_bf16 v[172:175], v[132:135], v[112:115], v[172:175]
v_mfma_f32_16x16x32_bf16 v[176:179], v[128:131], v[116:119], v[176:179]
v_mfma_f32_16x16x32_bf16 v[180:183], v[132:135], v[116:119], v[180:183]
v_rcp_f32 v216, v216
v_rcp_f32 v217, v217
v_rcp_f32 v218, v218
v_rcp_f32 v219, v219
v_rcp_f32 v220, v220
v_rcp_f32 v221, v221
v_rcp_f32 v222, v222
v_rcp_f32 v223, v223
s_waitcnt lgkmcnt(0)
v_mfma_f32_16x16x32_bf16 v[168:171], v[80:83], v[64:67], v[168:171]
v_mfma_f32_16x16x32_bf16 v[172:175], v[24:27], v[64:67], v[172:175]
v_mfma_f32_16x16x32_bf16 v[176:179], v[80:83], v[68:71], v[176:179]
v_mfma_f32_16x16x32_bf16 v[180:183], v[24:27], v[68:71], v[180:183]
v_mfma_f32_16x16x32_bf16 v[168:171], v[136:139], v[72:75], v[168:171]
v_mfma_f32_16x16x32_bf16 v[172:175], v[248:251], v[72:75], v[172:175]
v_mfma_f32_16x16x32_bf16 v[176:179], v[136:139], v[76:79], v[176:179]
v_mfma_f32_16x16x32_bf16 v[180:183], v[248:251], v[76:79], v[180:183]
v_pk_mul_f32 v[152:153], v[152:153], v[208:209]
v_pk_mul_f32 v[154:155], v[154:155], v[210:211]
v_pk_mul_f32 v[156:157], v[156:157], v[212:213]
v_pk_mul_f32 v[158:159], v[158:159], v[214:215]
v_pk_mul_f32 v[160:161], v[160:161], v[216:217]
v_pk_mul_f32 v[162:163], v[162:163], v[218:219]
v_pk_mul_f32 v[164:165], v[164:165], v[220:221]
v_pk_mul_f32 v[166:167], v[166:167], v[222:223]
v_pk_mul_f32 v[152:153], v[152:153], v[168:169]
v_pk_mul_f32 v[154:155], v[154:155], v[170:171]
ds_write_b128 v12, v[152:155] offset:0
v_pk_mul_f32 v[156:157], v[156:157], v[172:173]
v_pk_mul_f32 v[158:159], v[158:159], v[174:175]
ds_write_b128 v13, v[156:159] offset:0
v_pk_mul_f32 v[160:161], v[160:161], v[176:177]
v_pk_mul_f32 v[162:163], v[162:163], v[178:179]
ds_write_b128 v12, v[160:163] offset:2048
v_pk_mul_f32 v[164:165], v[164:165], v[180:181]
v_pk_mul_f32 v[166:167], v[166:167], v[182:183]
ds_write_b128 v13, v[164:167] offset:2048
s_add_u32 s73, s64, 16384
s_waitcnt lgkmcnt(0)
ds_read_b128 v[208:211], v5 offset:0
ds_read_b128 v[212:215], v6 offset:0
ds_read_b128 v[216:219], v5 offset:2048
ds_read_b128 v[220:223], v6 offset:2048
s_waitcnt lgkmcnt(2)
v_pk_add_f32 v[208:209], v[208:209], v[192:193]
v_pk_add_f32 v[210:211], v[210:211], v[194:195]
v_pk_add_f32 v[212:213], v[212:213], v[196:197]
v_pk_add_f32 v[214:215], v[214:215], v[198:199]
v_cvt_pk_bf16_f32 v80, v208, v209
v_cvt_pk_bf16_f32 v81, v210, v211
v_cvt_pk_bf16_f32 v82, v212, v213
v_cvt_pk_bf16_f32 v83, v214, v215
buffer_store_dwordx4 v[80:83], v10, s[52:55], s64 offen
s_waitcnt lgkmcnt(0)
v_pk_add_f32 v[216:217], v[216:217], v[200:201]
v_pk_add_f32 v[218:219], v[218:219], v[202:203]
v_pk_add_f32 v[220:221], v[220:221], v[204:205]
v_pk_add_f32 v[222:223], v[222:223], v[206:207]
v_cvt_pk_bf16_f32 v84, v216, v217
v_cvt_pk_bf16_f32 v85, v218, v219
v_cvt_pk_bf16_f32 v86, v220, v221
v_cvt_pk_bf16_f32 v87, v222, v223
buffer_store_dwordx4 v[84:87], v10, s[52:55], s73 offen
s_endpgm
k2_kf:
s_waitcnt vmcnt(0)
s_mov_b64 exec, 1
buffer_store_dword v14, v15, s[44:47], s76 offen sc1
s_mov_b64 exec, -1
s_branch k2_kf_b
k2_kc:
s_lshl_b32 s69, s28, 2
s_lshl_b32 s72, s61, 1
s_add_u32 s69, s69, s72
s_lshl_b32 s72, s69, 10
s_add_u32 s72, s72, 11534336
s_lshl_b32 s73, s69, 7
s_add_u32 s73, s73, 12058624
v_lshlrev_b32 v12, 2, v1
v_lshlrev_b32 v13, 4, v102
buffer_load_dword v184, v12, s[44:47], s72 offen offset:0 sc1
buffer_load_dword v185, v12, s[44:47], s72 offen offset:256 sc1
buffer_load_dword v186, v12, s[44:47], s72 offen offset:512 sc1
buffer_load_dword v187, v12, s[44:47], s72 offen offset:768 sc1
buffer_load_dwordx4 v[192:195], v13, s[44:47], s73 offen offset:0 sc1
buffer_load_dword v188, v12, s[44:47], s72 offen offset:1024 sc1
buffer_load_dword v189, v12, s[44:47], s72 offen offset:1280 sc1
buffer_load_dword v190, v12, s[44:47], s72 offen offset:1536 sc1
buffer_load_dword v191, v12, s[44:47], s72 offen offset:1792 sc1
buffer_load_dwordx4 v[196:199], v13, s[44:47], s73 offen offset:128 sc1
s_branch k2_kc_b
k2_ko:
s_mul_i32 s74, s69, 65536
s_add_u32 s74, s74, s66
s_add_u32 s74, s74, 7340032
s_waitcnt vmcnt(0)
v_cvt_pk_bf16_f32 v200, v184, v185
v_cvt_pk_bf16_f32 v204, v192, v193
v_cvt_pk_bf16_f32 v201, v186, v187
v_cvt_pk_bf16_f32 v205, v194, v195
v_cvt_pk_bf16_f32 v202, v188, v189
v_cvt_pk_bf16_f32 v206, v196, v197
v_cvt_pk_bf16_f32 v203, v190, v191
v_cvt_pk_bf16_f32 v207, v198, v199
s_nop 1
v_mfma_f32_16x16x16_bf16 v[208:211], v[200:201], v[84:85], 0
v_mfma_f32_16x16x16_bf16 v[212:215], v[204:205], v[84:85], 0
v_mfma_f32_16x16x16_bf16 v[216:219], v[202:203], v[92:93], 0
v_mfma_f32_16x16x16_bf16 v[220:223], v[206:207], v[92:93], 0
v_mfma_f32_16x16x16_bf16 v[224:227], v[200:201], v[86:87], 0
v_mfma_f32_16x16x16_bf16 v[228:231], v[204:205], v[86:87], 0
v_mfma_f32_16x16x16_bf16 v[232:235], v[202:203], v[94:95], 0
v_mfma_f32_16x16x16_bf16 v[236:239], v[206:207], v[94:95], 0
s_nop 7
v_add_f32 v212, 0x358637bd, v212
v_add_f32 v220, 0x358637bd, v220
v_add_f32 v228, 0x358637bd, v228
v_add_f32 v236, 0x358637bd, v236
v_rcp_f32 v212, v212
v_rcp_f32 v220, v220
v_rcp_f32 v228, v228
v_rcp_f32 v236, v236
s_nop 0
v_pk_mul_f32 v[208:209], v[208:209], v[212:213] op_sel_hi:[1,0]
v_pk_mul_f32 v[210:211], v[210:211], v[212:213] op_sel_hi:[1,0]
v_pk_mul_f32 v[216:217], v[216:217], v[220:221] op_sel_hi:[1,0]
v_pk_mul_f32 v[218:219], v[218:219], v[220:221] op_sel_hi:[1,0]
v_pk_mul_f32 v[224:225], v[224:225], v[228:229] op_sel_hi:[1,0]
v_pk_mul_f32 v[226:227], v[226:227], v[228:229] op_sel_hi:[1,0]
v_pk_mul_f32 v[232:233], v[232:233], v[236:237] op_sel_hi:[1,0]
v_pk_mul_f32 v[234:235], v[234:235], v[236:237] op_sel_hi:[1,0]
v_cvt_pk_bf16_f32 v184, v208, v209
v_cvt_pk_bf16_f32 v185, v210, v211
v_cvt_pk_bf16_f32 v186, v216, v217
v_cvt_pk_bf16_f32 v187, v218, v219
v_cvt_pk_bf16_f32 v188, v224, v225
v_cvt_pk_bf16_f32 v189, v226, v227
v_cvt_pk_bf16_f32 v190, v232, v233
v_cvt_pk_bf16_f32 v191, v234, v235
buffer_store_dwordx4 v[184:187], v101, s[44:47], s74 offen offset:0 sc1
buffer_store_dwordx4 v[188:191], v101, s[44:47], s74 offen offset:1024 sc1
v_mfma_f32_16x16x16_bf16 v[208:211], v[200:201], v[88:89], 0
v_mfma_f32_16x16x16_bf16 v[212:215], v[204:205], v[88:89], 0
v_mfma_f32_16x16x16_bf16 v[216:219], v[202:203], v[96:97], 0
v_mfma_f32_16x16x16_bf16 v[220:223], v[206:207], v[96:97], 0
v_mfma_f32_16x16x16_bf16 v[224:227], v[200:201], v[90:91], 0
v_mfma_f32_16x16x16_bf16 v[228:231], v[204:205], v[90:91], 0
v_mfma_f32_16x16x16_bf16 v[232:235], v[202:203], v[98:99], 0
v_mfma_f32_16x16x16_bf16 v[236:239], v[206:207], v[98:99], 0
s_nop 7
v_add_f32 v212, 0x358637bd, v212
v_add_f32 v220, 0x358637bd, v220
v_add_f32 v228, 0x358637bd, v228
v_add_f32 v236, 0x358637bd, v236
v_rcp_f32 v212, v212
v_rcp_f32 v220, v220
v_rcp_f32 v228, v228
v_rcp_f32 v236, v236
s_nop 0
v_pk_mul_f32 v[208:209], v[208:209], v[212:213] op_sel_hi:[1,0]
v_pk_mul_f32 v[210:211], v[210:211], v[212:213] op_sel_hi:[1,0]
v_pk_mul_f32 v[216:217], v[216:217], v[220:221] op_sel_hi:[1,0]
v_pk_mul_f32 v[218:219], v[218:219], v[220:221] op_sel_hi:[1,0]
v_pk_mul_f32 v[224:225], v[224:225], v[228:229] op_sel_hi:[1,0]
v_pk_mul_f32 v[226:227], v[226:227], v[228:229] op_sel_hi:[1,0]
v_pk_mul_f32 v[232:233], v[232:233], v[236:237] op_sel_hi:[1,0]
v_pk_mul_f32 v[234:235], v[234:235], v[236:237] op_sel_hi:[1,0]
v_cvt_pk_bf16_f32 v192, v208, v209
v_cvt_pk_bf16_f32 v193, v210, v211
v_cvt_pk_bf16_f32 v194, v216, v217
v_cvt_pk_bf16_f32 v195, v218, v219
v_cvt_pk_bf16_f32 v196, v224, v225
v_cvt_pk_bf16_f32 v197, v226, v227
v_cvt_pk_bf16_f32 v198, v232, v233
v_cvt_pk_bf16_f32 v199, v234, v235
buffer_store_dwordx4 v[192:195], v101, s[44:47], s74 offen offset:2048 sc1
buffer_store_dwordx4 v[196:199], v101, s[44:47], s74 offen offset:3072 sc1
s_branch k2_ko_b
k2_of:
s_lshr_b32 s72, s69, 1
s_lshr_b32 s73, s72, 3
s_lshl_b32 s73, s73, 7
s_and_b32 s72, s72, 7
s_lshl_b32 s72, s72, 2
s_add_u32 s72, s72, s73
s_lshl_b32 s73, s60, 8
s_add_u32 s72, s72, s73
s_add_u32 s72, s72, 12394496
s_waitcnt vmcnt(0)
s_mov_b64 exec, 1
buffer_store_dword v14, v15, s[44:47], s72 offen sc1
s_mov_b64 exec, -1
s_branch k2_of_b
k_helper:
v_and_b32 v5, 127, v0
v_mov_b32 v9, 0
v_mov_b32 v8, 150528
ds_write2_b32 v8, v9, v9 offset0:1 offset1:2
ds_write2_b32 v8, v9, v9 offset0:4 offset1:5
s_mul_i32 s60, s28, 224
s_lshl_b32 s61, s29, 5
s_add_u32 s61, s61, s60
s_bitcmp1_b32 s27, 0
s_cselect_b32 s76, 128, 0
s_add_u32 s61, s61, s76
v_add_u32 v6, s61, v5
s_mul_i32 s61, s29, 192
s_add_u32 s60, s60, 128
s_sub_u32 s60, s60, s61
v_add_u32 v7, s60, v5
s_bitcmp1_b32 s27, 0
s_cselect_b32 s60, 63, 127
s_cselect_b32 s61, 95, s60
v_cmp_lt_u32 vcc, s60, v5
v_mov_b32 v10, 0x100000
s_nop 0
v_cndmask_b32 v6, v6, v7, vcc
v_cmp_lt_u32 vcc, s61, v5
s_nop 1
v_cndmask_b32 v6, v6, v10, vcc
v_lshlrev_b32 v6, 1, v6
s_lshl_b32 s60, s26, 7
s_lshl_b32 s61, s27, 2
s_add_u32 s61, s61, s60
s_lshl_b32 s76, s27, 7
s_add_u32 s76, s76, 2048
s_lshl_b32 s77, s26, 2
s_add_u32 s77, s77, s76
v_mov_b32 v12, s61
v_mov_b32 v14, s77
v_cmp_eq_u32 vcc, 1, v1
v_and_b32 v15, 15, v1
v_and_b32 v16, 16, v1
v_cndmask_b32 v12, v12, v14, vcc
v_add_u32 v12, 12386304, v12
v_mov_b32 v13, s60
v_mov_b32 v14, s76
v_cmp_ne_u32 vcc, 0, v16
s_nop 1
v_cndmask_b32 v13, v13, v14, vcc
v_lshl_add_u32 v13, v15, 2, v13
v_add_u32 v13, 12386304, v13
s_lshl_b32 s64, s28, 7
s_waitcnt lgkmcnt(0)
s_mov_b32 s44, s24
s_and_b32 s45, s25, 0xffff
s_mov_b32 s46, 16777216
s_mov_b32 s47, 0x00020000
s_mov_b32 s48, s22
s_and_b32 s49, s23, 0xffff
s_mov_b32 s50, 256
s_mov_b32 s51, 0x00020000
s_mov_b32 s52, s14
s_and_b32 s53, s15, 0xffff
s_mov_b32 s54, 3584
s_mov_b32 s55, 0x00020000
s_add_u32 s40, s6, s64
s_addc_u32 s41, s7, 0
s_and_b32 s41, s41, 0xffff
s_sub_u32 s42, 1572864, s64
s_mov_b32 s43, 0x00020000
s_bitcmp1_b32 s27, 0
s_cbranch_scc1 k_hpb
s_barrier
buffer_load_ushort v10, v6, s[52:55], 0 offen
buffer_load_dword v11, v9, s[48:51], 0 offen sc1
s_barrier
s_barrier
s_barrier
s_barrier
s_mov_b32 s60, 0
k_spinna:
s_waitcnt vmcnt(0)
v_readfirstlane_b32 s79, v11
s_cmp_lg_u32 s79, 0
s_cbranch_scc1 k_gotna
buffer_load_dword v11, v9, s[48:51], 0 offen sc1
s_add_u32 s60, s60, 1
s_cmp_lt_u32 s60, 131072
s_cbranch_scc1 k_spinna
k_gotna:
s_cmp_lg_u32 s31, 0
s_cbranch_scc1 k_nofa
s_mov_b64 exec, 3
buffer_store_dword v11, v12, s[44:47], 0 offen sc1
s_mov_b64 exec, -1
k_nofa:
s_and_b32 s60, s2, 7
s_lshl_b32 s60, s60, 2
s_lshr_b32 s61, s58, 3
s_add_u32 s66, s60, s61
s_and_b32 s58, s58, 7
s_lshl_b32 s65, s58, 7
s_add_u32 s48, s16, s65
s_addc_u32 s49, s17, 0
s_and_b32 s49, s49, 0xffff
s_sub_u32 s50, 1835008, s65
s_mov_b32 s51, 0x00020000
s_add_u32 s52, s8, s65
s_addc_u32 s53, s9, 0
s_and_b32 s53, s53, 0xffff
s_sub_u32 s54, 524288, s65
s_mov_b32 s55, 0x00020000
s_and_b32 s60, s66, 2
s_mul_i32 s60, s60, 7
s_mul_i32 s61, s58, 7
s_lshr_b32 s61, s61, 1
s_add_u32 s60, s60, s61
s_and_b32 s61, s2, 7
s_mul_i32 s61, s61, 7
s_lshr_b32 s61, s61, 2
s_add_u32 s60, s60, s61
s_cmp_ge_u32 s60, 28
s_cselect_b32 s61, 28, 0
s_sub_u32 s60, s60, s61
s_mul_i32 s64, s60, 262144
s_lshl_b32 s63, s60, 16
v_lshrrev_b32 v5, 3, v1
v_and_b32 v6, 7, v1
v_and_b32 v7, 6, v5
v_xor_b32 v7, v7, v6
v_lshlrev_b32 v41, 4, v7
v_lshl_add_u32 v41, v5, 10, v41
s_lshl_b32 s60, s31, 13
v_add_u32 v41, s60, v41
s_lshl_b32 s59, s31, 10
v_lshl_add_u32 v42, v1, 4, s59
v_add_u32 v44, 0x10000, v42
v_add_u32 v45, 0x20000, v42
s_lshl_b32 s60, s66, 1
s_add_u32 s60, s60, s31
s_lshl_b32 s60, s60, 13
v_lshlrev_b32 v16, 10, v1
s_mov_b64 exec, 0xff
buffer_load_dword v63, v16, s[52:55], s60 offen
s_mov_b64 exec, -1
s_barrier
s_barrier
buffer_load_dword v17, v13, s[44:47], 0 offen sc1
s_barrier
s_barrier
s_waitcnt vmcnt(0)
v_cmp_ne_u32 vcc, s79, v17
s_mov_b32 s60, 0
s_nop 3
s_cbranch_vccz k_stfa_ok
k_stfa_spin:
s_sleep 1
buffer_load_dword v17, v13, s[44:47], 0 offen sc1
s_add_u32 s60, s60, 1
s_cmp_gt_u32 s60, 131072
s_cbranch_scc1 k_stfa_ok
s_waitcnt vmcnt(0)
v_cmp_ne_u32 vcc, s79, v17
s_nop 4
s_cbranch_vccnz k_stfa_spin
k_stfa_ok:
s_lshl_b32 s60, s27, 14
s_lshl_b32 s61, s31, 9
s_add_u32 s60, s60, s61
s_add_u32 s60, s60, 12124160
s_add_u32 s61, s60, 4096
s_add_u32 s76, s60, 8192
s_add_u32 s78, s60, 12288
v_and_b32 v43, 15, v1
v_lshlrev_b32 v43, 4, v43
v_lshrrev_b32 v16, 4, v1
v_lshl_add_u32 v16, v16, 10, v43
buffer_load_dwordx4 v[64:67], v16, s[44:47], s60 offen offset:0 sc1
buffer_load_dwordx4 v[68:71], v16, s[44:47], s61 offen offset:0 sc1
buffer_load_dwordx4 v[72:75], v16, s[44:47], s76 offen offset:0 sc1
buffer_load_dwordx4 v[76:79], v16, s[44:47], s78 offen offset:0 sc1
buffer_load_dwordx4 v[80:83], v16, s[44:47], s60 offen offset:256 sc1
buffer_load_dwordx4 v[84:87], v16, s[44:47], s61 offen offset:256 sc1
buffer_load_dwordx4 v[88:91], v16, s[44:47], s76 offen offset:256 sc1
buffer_load_dwordx4 v[92:95], v16, s[44:47], s78 offen offset:256 sc1
s_lshl_b32 s60, s26, 10
s_add_u32 s60, s60, 12091392
v_and_b32 v5, 127, v0
v_lshlrev_b32 v7, 3, v5
buffer_load_dwordx2 v[18:19], v7, s[44:47], s60 offen sc1
s_add_u32 s60, s63, 0
buffer_load_dwordx4 v[96:99], v41, s[48:51], s60 offen
s_add_u32 s60, s63, 16384
buffer_load_dwordx4 v[100:103], v41, s[48:51], s60 offen
s_add_u32 s60, s63, 32768
buffer_load_dwordx4 v[104:107], v41, s[48:51], s60 offen
s_add_u32 s60, s63, 49152
buffer_load_dwordx4 v[108:111], v41, s[48:51], s60 offen
s_add_u32 s63, s63, 65536
s_cmp_eq_u32 s63, 1835008
s_cselect_b32 s63, 0, s63
s_add_u32 s60, s63, 0
buffer_load_dwordx4 v[112:115], v41, s[48:51], s60 offen
s_add_u32 s60, s63, 16384
buffer_load_dwordx4 v[116:119], v41, s[48:51], s60 offen
s_add_u32 s60, s63, 32768
buffer_load_dwordx4 v[120:123], v41, s[48:51], s60 offen
s_add_u32 s60, s63, 49152
buffer_load_dwordx4 v[124:127], v41, s[48:51], s60 offen
s_add_u32 s63, s63, 65536
s_cmp_eq_u32 s63, 1835008
s_cselect_b32 s63, 0, s63
s_barrier
s_add_u32 s60, s63, 0
buffer_load_dwordx4 v[128:131], v41, s[48:51], s60 offen
s_add_u32 s60, s63, 16384
buffer_load_dwordx4 v[132:135], v41, s[48:51], s60 offen
s_add_u32 s60, s63, 32768
buffer_load_dwordx4 v[136:139], v41, s[48:51], s60 offen
s_add_u32 s60, s63, 49152
buffer_load_dwordx4 v[140:143], v41, s[48:51], s60 offen
s_add_u32 s63, s63, 65536
s_cmp_eq_u32 s63, 1835008
s_cselect_b32 s63, 0, s63
s_add_u32 s60, s63, 0
buffer_load_dwordx4 v[144:147], v41, s[48:51], s60 offen
s_add_u32 s60, s63, 16384
buffer_load_dwordx4 v[148:151], v41, s[48:51], s60 offen
s_add_u32 s60, s63, 32768
buffer_load_dwordx4 v[152:155], v41, s[48:51], s60 offen
s_add_u32 s60, s63, 49152
buffer_load_dwordx4 v[156:159], v41, s[48:51], s60 offen
s_add_u32 s63, s63, 65536
s_cmp_eq_u32 s63, 1835008
s_cselect_b32 s63, 0, s63
s_barrier
s_add_u32 s60, s63, 0
buffer_load_dwordx4 v[160:163], v41, s[48:51], s60 offen
s_add_u32 s60, s63, 16384
buffer_load_dwordx4 v[164:167], v41, s[48:51], s60 offen
s_add_u32 s60, s63, 32768
buffer_load_dwordx4 v[168:171], v41, s[48:51], s60 offen
s_add_u32 s60, s63, 49152
buffer_load_dwordx4 v[172:175], v41, s[48:51], s60 offen
s_add_u32 s63, s63, 65536
s_cmp_eq_u32 s63, 1835008
s_cselect_b32 s63, 0, s63
s_add_u32 s60, s63, 0
buffer_load_dwordx4 v[176:179], v41, s[48:51], s60 offen
s_add_u32 s60, s63, 16384
buffer_load_dwordx4 v[180:183], v41, s[48:51], s60 offen
s_add_u32 s60, s63, 32768
buffer_load_dwordx4 v[184:187], v41, s[48:51], s60 offen
s_add_u32 s60, s63, 49152
buffer_load_dwordx4 v[188:191], v41, s[48:51], s60 offen
s_add_u32 s63, s63, 65536
s_cmp_eq_u32 s63, 1835008
s_cselect_b32 s63, 0, s63
s_barrier
s_waitcnt vmcnt(24)
v_pk_add_f32 v[64:65], v[64:65], v[68:69]
v_pk_add_f32 v[66:67], v[66:67], v[70:71]
v_pk_add_f32 v[72:73], v[72:73], v[76:77]
v_pk_add_f32 v[74:75], v[74:75], v[78:79]
v_pk_add_f32 v[80:81], v[80:81], v[84:85]
v_pk_add_f32 v[82:83], v[82:83], v[86:87]
v_pk_add_f32 v[88:89], v[88:89], v[92:93]
v_pk_add_f32 v[90:91], v[90:91], v[94:95]
v_pk_add_f32 v[64:65], v[64:65], v[72:73]
v_pk_add_f32 v[66:67], v[66:67], v[74:75]
v_pk_add_f32 v[80:81], v[80:81], v[88:89]
v_pk_add_f32 v[82:83], v[82:83], v[90:91]
s_nop 0
v_mov_b32 v68, v64
v_mov_b32 v69, v65
v_mov_b32 v70, v66
v_mov_b32 v71, v67
v_mov_b32 v84, v80
v_mov_b32 v85, v81
v_mov_b32 v86, v82
v_mov_b32 v87, v83
v_permlane32_swap_b32 v68, v64
v_permlane32_swap_b32 v69, v65
v_permlane32_swap_b32 v70, v66
v_permlane32_swap_b32 v71, v67
v_permlane32_swap_b32 v84, v80
v_permlane32_swap_b32 v85, v81
v_permlane32_swap_b32 v86, v82
v_permlane32_swap_b32 v87, v83
s_nop 1
v_pk_add_f32 v[64:65], v[64:65], v[68:69]
v_pk_add_f32 v[66:67], v[66:67], v[70:71]
v_pk_add_f32 v[80:81], v[80:81], v[84:85]
v_pk_add_f32 v[82:83], v[82:83], v[86:87]
s_nop 0
v_mov_b32 v68, v64
v_mov_b32 v69, v65
v_mov_b32 v70, v66
v_mov_b32 v71, v67
v_mov_b32 v84, v80
v_mov_b32 v85, v81
v_mov_b32 v86, v82
v_mov_b32 v87, v83
v_permlane16_swap_b32 v68, v64
v_permlane16_swap_b32 v69, v65
v_permlane16_swap_b32 v70, v66
v_permlane16_swap_b32 v71, v67
v_permlane16_swap_b32 v84, v80
v_permlane16_swap_b32 v85, v81
v_permlane16_swap_b32 v86, v82
v_permlane16_swap_b32 v87, v83
s_nop 1
v_pk_add_f32 v[64:65], v[64:65], v[68:69]
v_pk_add_f32 v[66:67], v[66:67], v[70:71]
v_pk_add_f32 v[80:81], v[80:81], v[84:85]
v_pk_add_f32 v[82:83], v[82:83], v[86:87]
s_lshl_b32 s60, s31, 9
s_add_u32 s60, s60, 148480
v_add_u32 v43, s60, v43
v_lshlrev_b32 v6, 2, v5
v_add_u32 v6, 147456, v6
v_lshlrev_b32 v10, 16, v10
ds_write_b32 v6, v10 offset:2048
ds_write2_b32 v6, v18, v19 offset0:0 offset1:128
ds_write_b32 v8, v11
s_mov_b64 exec, 0xffff
ds_write_b128 v43, v[64:67]
ds_write_b128 v43, v[80:83] offset:256
s_mov_b64 exec, -1
v_mov_b32 v16, 1
s_mov_b64 exec, 1
ds_add_u32 v8, v16 offset:20
s_mov_b64 exec, -1
s_waitcnt vmcnt(20)
ds_write_b128 v44, v[96:99] offset:49152
ds_write_b128 v44, v[100:103] offset:51200
ds_write_b128 v44, v[104:107] offset:53248
ds_write_b128 v44, v[108:111] offset:55296
s_waitcnt vmcnt(16)
ds_write_b128 v44, v[112:115] offset:57344
ds_write_b128 v44, v[116:119] offset:59392
ds_write_b128 v44, v[120:123] offset:61440
ds_write_b128 v44, v[124:127] offset:63488
s_barrier
s_waitcnt vmcnt(12)
ds_write_b128 v45, v[128:131] offset:0
ds_write_b128 v45, v[132:135] offset:2048
ds_write_b128 v45, v[136:139] offset:4096
ds_write_b128 v45, v[140:143] offset:6144
s_waitcnt vmcnt(8)
ds_write_b128 v45, v[144:147] offset:8192
ds_write_b128 v45, v[148:151] offset:10240
ds_write_b128 v45, v[152:155] offset:12288
ds_write_b128 v45, v[156:159] offset:14336
s_barrier
s_add_u32 s60, s63, 0
buffer_load_dwordx4 v[192:195], v41, s[48:51], s60 offen
s_add_u32 s60, s63, 16384
buffer_load_dwordx4 v[196:199], v41, s[48:51], s60 offen
s_add_u32 s60, s63, 32768
buffer_load_dwordx4 v[200:203], v41, s[48:51], s60 offen
s_add_u32 s60, s63, 49152
buffer_load_dwordx4 v[204:207], v41, s[48:51], s60 offen
s_add_u32 s63, s63, 65536
s_cmp_eq_u32 s63, 1835008
s_cselect_b32 s63, 0, s63
s_add_u32 s60, s63, 0
buffer_load_dwordx4 v[208:211], v41, s[48:51], s60 offen
s_add_u32 s60, s63, 16384
buffer_load_dwordx4 v[212:215], v41, s[48:51], s60 offen
s_add_u32 s60, s63, 32768
buffer_load_dwordx4 v[216:219], v41, s[48:51], s60 offen
s_add_u32 s60, s63, 49152
buffer_load_dwordx4 v[220:223], v41, s[48:51], s60 offen
s_add_u32 s63, s63, 65536
s_cmp_eq_u32 s63, 1835008
s_cselect_b32 s63, 0, s63
s_waitcnt vmcnt(12)
ds_write_b128 v42, v[160:163] offset:49152
ds_write_b128 v42, v[164:167] offset:51200
ds_write_b128 v42, v[168:171] offset:53248
ds_write_b128 v42, v[172:175] offset:55296
s_waitcnt vmcnt(8)
ds_write_b128 v42, v[176:179] offset:57344
ds_write_b128 v42, v[180:183] offset:59392
ds_write_b128 v42, v[184:187] offset:61440
ds_write_b128 v42, v[188:191] offset:63488
s_barrier
s_add_u32 s60, s63, 0
buffer_load_dwordx4 v[224:227], v41, s[48:51], s60 offen
s_add_u32 s60, s63, 16384
buffer_load_dwordx4 v[228:231], v41, s[48:51], s60 offen
s_add_u32 s60, s63, 32768
buffer_load_dwordx4 v[232:235], v41, s[48:51], s60 offen
s_add_u32 s60, s63, 49152
buffer_load_dwordx4 v[236:239], v41, s[48:51], s60 offen
s_add_u32 s63, s63, 65536
s_cmp_eq_u32 s63, 1835008
s_cselect_b32 s63, 0, s63
s_add_u32 s60, s63, 0
buffer_load_dwordx4 v[240:243], v41, s[48:51], s60 offen
s_add_u32 s60, s63, 16384
buffer_load_dwordx4 v[244:247], v41, s[48:51], s60 offen
s_add_u32 s60, s63, 32768
buffer_load_dwordx4 v[248:251], v41, s[48:51], s60 offen
s_add_u32 s60, s63, 49152
buffer_load_dwordx4 v[252:255], v41, s[48:51], s60 offen
s_add_u32 s63, s63, 65536
s_cmp_eq_u32 s63, 1835008
s_cselect_b32 s63, 0, s63
s_barrier
s_barrier
s_waitcnt vmcnt(12)
ds_write_b128 v44, v[192:195] offset:0
ds_write_b128 v44, v[196:199] offset:2048
ds_write_b128 v44, v[200:203] offset:4096
ds_write_b128 v44, v[204:207] offset:6144
s_waitcnt vmcnt(8)
ds_write_b128 v44, v[208:211] offset:8192
ds_write_b128 v44, v[212:215] offset:10240
ds_write_b128 v44, v[216:219] offset:12288
ds_write_b128 v44, v[220:223] offset:14336
s_waitcnt vmcnt(4)
ds_write_b128 v44, v[224:227] offset:16384
ds_write_b128 v44, v[228:231] offset:18432
ds_write_b128 v44, v[232:235] offset:20480
ds_write_b128 v44, v[236:239] offset:22528
s_waitcnt vmcnt(0)
ds_write_b128 v44, v[240:243] offset:24576
ds_write_b128 v44, v[244:247] offset:26624
ds_write_b128 v44, v[248:251] offset:28672
ds_write_b128 v44, v[252:255] offset:30720
s_waitcnt vmcnt(10)
s_add_u32 m0, s59, 98304
s_add_u32 s60, s63, 0
buffer_load_dwordx4 v41, s[48:51], s60 offen lds
s_add_u32 m0, s59, 100352
s_add_u32 s60, s63, 16384
buffer_load_dwordx4 v41, s[48:51], s60 offen lds
s_add_u32 m0, s59, 102400
s_add_u32 s60, s63, 32768
buffer_load_dwordx4 v41, s[48:51], s60 offen lds
s_add_u32 m0, s59, 104448
s_add_u32 s60, s63, 49152
buffer_load_dwordx4 v41, s[48:51], s60 offen lds
s_add_u32 s63, s63, 65536
s_cmp_eq_u32 s63, 1835008
s_cselect_b32 s63, 0, s63
s_waitcnt vmcnt(10)
s_add_u32 m0, s59, 106496
s_add_u32 s60, s63, 0
buffer_load_dwordx4 v41, s[48:51], s60 offen lds
s_add_u32 m0, s59, 108544
s_add_u32 s60, s63, 16384
buffer_load_dwordx4 v41, s[48:51], s60 offen lds
s_add_u32 m0, s59, 110592
s_add_u32 s60, s63, 32768
buffer_load_dwordx4 v41, s[48:51], s60 offen lds
s_add_u32 m0, s59, 112640
s_add_u32 s60, s63, 49152
buffer_load_dwordx4 v41, s[48:51], s60 offen lds
s_add_u32 s63, s63, 65536
s_cmp_eq_u32 s63, 1835008
s_cselect_b32 s63, 0, s63
s_waitcnt vmcnt(10)
s_add_u32 m0, s59, 32768
s_add_u32 s60, s63, 0
buffer_load_dwordx4 v41, s[48:51], s60 offen lds
s_add_u32 m0, s59, 34816
s_add_u32 s60, s63, 16384
buffer_load_dwordx4 v41, s[48:51], s60 offen lds
s_add_u32 m0, s59, 36864
s_add_u32 s60, s63, 32768
buffer_load_dwordx4 v41, s[48:51], s60 offen lds
s_add_u32 m0, s59, 38912
s_add_u32 s60, s63, 49152
buffer_load_dwordx4 v41, s[48:51], s60 offen lds
s_add_u32 s63, s63, 65536
s_cmp_eq_u32 s63, 1835008
s_cselect_b32 s63, 0, s63
s_waitcnt vmcnt(10)
s_add_u32 m0, s59, 40960
s_add_u32 s60, s63, 0
buffer_load_dwordx4 v41, s[48:51], s60 offen lds
s_add_u32 m0, s59, 43008
s_add_u32 s60, s63, 16384
buffer_load_dwordx4 v41, s[48:51], s60 offen lds
s_add_u32 m0, s59, 45056
s_add_u32 s60, s63, 32768
buffer_load_dwordx4 v41, s[48:51], s60 offen lds
s_add_u32 m0, s59, 47104
s_add_u32 s60, s63, 49152
buffer_load_dwordx4 v41, s[48:51], s60 offen lds
s_add_u32 s63, s63, 65536
s_cmp_eq_u32 s63, 1835008
s_cselect_b32 s63, 0, s63
s_waitcnt lgkmcnt(0)
v_and_b32 v12, 7, v1
v_lshlrev_b32 v12, 2, v12
v_bfe_u32 v13, v1, 3, 2
v_lshl_add_u32 v13, v13, 7, v12
v_bfe_u32 v14, v1, 3, 1
v_lshl_add_u32 v14, v14, 7, v12
s_lshl_b32 s77, s66, 8
s_add_u32 s77, s77, 12394496
s_lshl_b32 s76, s66, 9
s_add_u32 s76, s76, 12402688
s_cmp_lg_u32 s31, 0
s_cbranch_scc1 k_hf_xa
buffer_load_dword v17, v13, s[44:47], s76 offen sc1
s_waitcnt vmcnt(0)
v_cmp_ne_u32 vcc, s79, v17
s_mov_b32 s60, 0
s_nop 3
s_cbranch_vccz k_hfa_ok
k_hfa_spin:
s_sleep 2
buffer_load_dword v17, v13, s[44:47], s76 offen sc1
s_add_u32 s60, s60, 1
s_cmp_gt_u32 s60, 131072
s_cbranch_scc1 k_hfa_ok
s_waitcnt vmcnt(0)
v_cmp_ne_u32 vcc, s79, v17
s_nop 4
s_cbranch_vccnz k_hfa_spin
k_hfa_ok:
v_mov_b32 v16, 1
s_mov_b64 exec, 1
ds_add_u32 v8, v16 offset:16
s_mov_b64 exec, -1
k_hf_xa:
s_waitcnt vmcnt(0) lgkmcnt(0)
s_barrier
s_cmp_lg_u32 s31, 0
s_cbranch_scc1 k_end
s_barrier
s_barrier
s_barrier
s_barrier
s_barrier
s_barrier
s_barrier
s_barrier
s_lshl_b32 s76, s28, 9
s_add_u32 s76, s76, 12390400
v_and_b32 v12, 15, v1
v_lshrrev_b32 v13, 4, v1
v_lshlrev_b32 v13, 7, v13
v_lshl_add_u32 v13, v12, 2, v13
buffer_load_dword v17, v13, s[44:47], s76 offen sc1
s_barrier
s_barrier
s_waitcnt vmcnt(0)
v_cmp_ne_u32 vcc, s79, v17
s_mov_b32 s60, 0
s_nop 3
s_cbranch_vccz k_kvf_ok
k_kvf_spin:
s_sleep 1
buffer_load_dword v17, v13, s[44:47], s76 offen sc1
s_add_u32 s60, s60, 1
s_cmp_gt_u32 s60, 131072
s_cbranch_scc1 k_kvf_ok
s_waitcnt vmcnt(0)
v_cmp_ne_u32 vcc, s79, v17
s_nop 4
s_cbranch_vccnz k_kvf_spin
k_kvf_ok:
s_barrier
s_barrier
s_barrier
s_barrier
s_barrier
s_barrier
s_barrier
s_barrier
s_barrier
s_barrier
buffer_load_dword v17, v14, s[44:47], s77 offen sc1
s_barrier
s_barrier
s_waitcnt vmcnt(0)
v_cmp_ne_u32 vcc, s79, v17
s_mov_b32 s60, 0
s_nop 3
s_cbranch_vccz k_ofa_ok
k_ofa_spin:
s_sleep 1
buffer_load_dword v17, v14, s[44:47], s77 offen sc1
s_add_u32 s60, s60, 1
s_cmp_gt_u32 s60, 131072
s_cbranch_scc1 k_ofa_ok
s_waitcnt vmcnt(0)
v_cmp_ne_u32 vcc, s79, v17
s_nop 4
s_cbranch_vccnz k_ofa_spin
k_ofa_ok:
s_barrier
s_endpgm
k_hpb:
s_barrier
buffer_load_ushort v10, v6, s[52:55], 0 offen
buffer_load_dword v11, v9, s[48:51], 0 offen sc1
s_barrier
s_barrier
s_barrier
s_barrier
s_mov_b32 s60, 0
k_spinnb:
s_waitcnt vmcnt(0)
v_readfirstlane_b32 s79, v11
s_cmp_lg_u32 s79, 0
s_cbranch_scc1 k_gotnb
buffer_load_dword v11, v9, s[48:51], 0 offen sc1
s_add_u32 s60, s60, 1
s_cmp_lt_u32 s60, 131072
s_cbranch_scc1 k_spinnb
k_gotnb:
s_cmp_lg_u32 s31, 0
s_cbranch_scc1 k_nofb
s_mov_b64 exec, 3
buffer_store_dword v11, v12, s[44:47], 0 offen sc1
s_mov_b64 exec, -1
k_nofb:
s_and_b32 s60, s2, 7
s_lshl_b32 s60, s60, 2
s_lshr_b32 s61, s58, 3
s_add_u32 s66, s60, s61
s_and_b32 s58, s58, 7
s_lshl_b32 s65, s58, 7
s_add_u32 s48, s16, s65
s_addc_u32 s49, s17, 0
s_and_b32 s49, s49, 0xffff
s_sub_u32 s50, 1835008, s65
s_mov_b32 s51, 0x00020000
s_add_u32 s52, s8, s65
s_addc_u32 s53, s9, 0
s_and_b32 s53, s53, 0xffff
s_sub_u32 s54, 524288, s65
s_mov_b32 s55, 0x00020000
s_and_b32 s60, s66, 2
s_mul_i32 s60, s60, 7
s_mul_i32 s61, s58, 7
s_lshr_b32 s61, s61, 1
s_add_u32 s60, s60, s61
s_and_b32 s61, s2, 7
s_mul_i32 s61, s61, 7
s_lshr_b32 s61, s61, 2
s_add_u32 s60, s60, s61
s_cmp_ge_u32 s60, 28
s_cselect_b32 s61, 28, 0
s_sub_u32 s60, s60, s61
s_mul_i32 s64, s60, 262144
s_lshl_b32 s63, s60, 16
v_lshrrev_b32 v5, 3, v1
v_and_b32 v6, 7, v1
v_and_b32 v7, 6, v5
v_xor_b32 v7, v7, v6
v_lshlrev_b32 v41, 4, v7
v_lshl_add_u32 v41, v5, 10, v41
s_lshl_b32 s60, s31, 13
v_add_u32 v41, s60, v41
s_lshl_b32 s59, s31, 10
v_lshl_add_u32 v42, v1, 4, s59
v_add_u32 v44, 0x10000, v42
v_add_u32 v45, 0x20000, v42
s_lshl_b32 s60, s66, 1
s_add_u32 s60, s60, s31
s_lshl_b32 s60, s60, 13
v_lshlrev_b32 v16, 10, v1
s_mov_b64 exec, 0xff
buffer_load_dword v63, v16, s[52:55], s60 offen
s_mov_b64 exec, -1
s_barrier
s_barrier
buffer_load_dword v17, v13, s[44:47], 0 offen sc1
s_barrier
s_barrier
s_waitcnt vmcnt(0)
v_cmp_ne_u32 vcc, s79, v17
s_mov_b32 s60, 0
s_nop 3
s_cbranch_vccz k_stfb_ok
k_stfb_spin:
s_sleep 1
buffer_load_dword v17, v13, s[44:47], 0 offen sc1
s_add_u32 s60, s60, 1
s_cmp_gt_u32 s60, 131072
s_cbranch_scc1 k_stfb_ok
s_waitcnt vmcnt(0)
v_cmp_ne_u32 vcc, s79, v17
s_nop 4
s_cbranch_vccnz k_stfb_spin
k_stfb_ok:
s_lshl_b32 s60, s27, 14
s_lshl_b32 s61, s31, 9
s_add_u32 s60, s60, s61
s_add_u32 s60, s60, 12124160
s_add_u32 s61, s60, 4096
s_add_u32 s76, s60, 8192
s_add_u32 s78, s60, 12288
v_and_b32 v43, 15, v1
v_lshlrev_b32 v43, 4, v43
v_lshrrev_b32 v16, 4, v1
v_lshl_add_u32 v16, v16, 10, v43
buffer_load_dwordx4 v[64:67], v16, s[44:47], s60 offen offset:0 sc1
buffer_load_dwordx4 v[68:71], v16, s[44:47], s61 offen offset:0 sc1
buffer_load_dwordx4 v[72:75], v16, s[44:47], s76 offen offset:0 sc1
buffer_load_dwordx4 v[76:79], v16, s[44:47], s78 offen offset:0 sc1
buffer_load_dwordx4 v[80:83], v16, s[44:47], s60 offen offset:256 sc1
buffer_load_dwordx4 v[84:87], v16, s[44:47], s61 offen offset:256 sc1
buffer_load_dwordx4 v[88:91], v16, s[44:47], s76 offen offset:256 sc1
buffer_load_dwordx4 v[92:95], v16, s[44:47], s78 offen offset:256 sc1
s_lshl_b32 s60, s26, 10
s_add_u32 s60, s60, 12091392
v_and_b32 v5, 127, v0
v_lshlrev_b32 v7, 3, v5
buffer_load_dwordx2 v[18:19], v7, s[44:47], s60 offen sc1
s_barrier
s_barrier
s_waitcnt vmcnt(0)
v_pk_add_f32 v[64:65], v[64:65], v[68:69]
v_pk_add_f32 v[66:67], v[66:67], v[70:71]
v_pk_add_f32 v[72:73], v[72:73], v[76:77]
v_pk_add_f32 v[74:75], v[74:75], v[78:79]
v_pk_add_f32 v[80:81], v[80:81], v[84:85]
v_pk_add_f32 v[82:83], v[82:83], v[86:87]
v_pk_add_f32 v[88:89], v[88:89], v[92:93]
v_pk_add_f32 v[90:91], v[90:91], v[94:95]
v_pk_add_f32 v[64:65], v[64:65], v[72:73]
v_pk_add_f32 v[66:67], v[66:67], v[74:75]
v_pk_add_f32 v[80:81], v[80:81], v[88:89]
v_pk_add_f32 v[82:83], v[82:83], v[90:91]
s_nop 0
v_mov_b32 v68, v64
v_mov_b32 v69, v65
v_mov_b32 v70, v66
v_mov_b32 v71, v67
v_mov_b32 v84, v80
v_mov_b32 v85, v81
v_mov_b32 v86, v82
v_mov_b32 v87, v83
v_permlane32_swap_b32 v68, v64
v_permlane32_swap_b32 v69, v65
v_permlane32_swap_b32 v70, v66
v_permlane32_swap_b32 v71, v67
v_permlane32_swap_b32 v84, v80
v_permlane32_swap_b32 v85, v81
v_permlane32_swap_b32 v86, v82
v_permlane32_swap_b32 v87, v83
s_nop 1
v_pk_add_f32 v[64:65], v[64:65], v[68:69]
v_pk_add_f32 v[66:67], v[66:67], v[70:71]
v_pk_add_f32 v[80:81], v[80:81], v[84:85]
v_pk_add_f32 v[82:83], v[82:83], v[86:87]
s_nop 0
v_mov_b32 v68, v64
v_mov_b32 v69, v65
v_mov_b32 v70, v66
v_mov_b32 v71, v67
v_mov_b32 v84, v80
v_mov_b32 v85, v81
v_mov_b32 v86, v82
v_mov_b32 v87, v83
v_permlane16_swap_b32 v68, v64
v_permlane16_swap_b32 v69, v65
v_permlane16_swap_b32 v70, v66
v_permlane16_swap_b32 v71, v67
v_permlane16_swap_b32 v84, v80
v_permlane16_swap_b32 v85, v81
v_permlane16_swap_b32 v86, v82
v_permlane16_swap_b32 v87, v83
s_nop 1
v_pk_add_f32 v[64:65], v[64:65], v[68:69]
v_pk_add_f32 v[66:67], v[66:67], v[70:71]
v_pk_add_f32 v[80:81], v[80:81], v[84:85]
v_pk_add_f32 v[82:83], v[82:83], v[86:87]
s_lshl_b32 s60, s31, 9
s_add_u32 s60, s60, 148480
v_add_u32 v43, s60, v43
v_lshlrev_b32 v6, 2, v5
v_add_u32 v6, 147456, v6
v_lshlrev_b32 v10, 16, v10
ds_write_b32 v6, v10 offset:2048
ds_write2_b32 v6, v18, v19 offset0:0 offset1:128
ds_write_b32 v8, v11
s_mov_b64 exec, 0xffff
ds_write_b128 v43, v[64:67]
ds_write_b128 v43, v[80:83] offset:256
s_mov_b64 exec, -1
v_mov_b32 v16, 1
s_mov_b64 exec, 1
ds_add_u32 v8, v16 offset:20
s_mov_b64 exec, -1
s_add_u32 s60, s63, 0
buffer_load_dwordx4 v[96:99], v41, s[48:51], s60 offen
s_add_u32 s60, s63, 16384
buffer_load_dwordx4 v[100:103], v41, s[48:51], s60 offen
s_add_u32 s60, s63, 32768
buffer_load_dwordx4 v[104:107], v41, s[48:51], s60 offen
s_add_u32 s60, s63, 49152
buffer_load_dwordx4 v[108:111], v41, s[48:51], s60 offen
s_add_u32 s63, s63, 65536
s_cmp_eq_u32 s63, 1835008
s_cselect_b32 s63, 0, s63
s_barrier
s_add_u32 s60, s63, 0
buffer_load_dwordx4 v[112:115], v41, s[48:51], s60 offen
s_add_u32 s60, s63, 16384
buffer_load_dwordx4 v[116:119], v41, s[48:51], s60 offen
s_add_u32 s60, s63, 32768
buffer_load_dwordx4 v[120:123], v41, s[48:51], s60 offen
s_add_u32 s60, s63, 49152
buffer_load_dwordx4 v[124:127], v41, s[48:51], s60 offen
s_add_u32 s63, s63, 65536
s_cmp_eq_u32 s63, 1835008
s_cselect_b32 s63, 0, s63
s_barrier
s_add_u32 s60, s63, 0
buffer_load_dwordx4 v[128:131], v41, s[48:51], s60 offen
s_add_u32 s60, s63, 16384
buffer_load_dwordx4 v[132:135], v41, s[48:51], s60 offen
s_add_u32 s60, s63, 32768
buffer_load_dwordx4 v[136:139], v41, s[48:51], s60 offen
s_add_u32 s60, s63, 49152
buffer_load_dwordx4 v[140:143], v41, s[48:51], s60 offen
s_add_u32 s63, s63, 65536
s_cmp_eq_u32 s63, 1835008
s_cselect_b32 s63, 0, s63
s_add_u32 s60, s63, 0
buffer_load_dwordx4 v[144:147], v41, s[48:51], s60 offen
s_add_u32 s60, s63, 16384
buffer_load_dwordx4 v[148:151], v41, s[48:51], s60 offen
s_add_u32 s60, s63, 32768
buffer_load_dwordx4 v[152:155], v41, s[48:51], s60 offen
s_add_u32 s60, s63, 49152
buffer_load_dwordx4 v[156:159], v41, s[48:51], s60 offen
s_add_u32 s63, s63, 65536
s_cmp_eq_u32 s63, 1835008
s_cselect_b32 s63, 0, s63
s_barrier
s_add_u32 s60, s63, 0
buffer_load_dwordx4 v[160:163], v41, s[48:51], s60 offen
s_add_u32 s60, s63, 16384
buffer_load_dwordx4 v[164:167], v41, s[48:51], s60 offen
s_add_u32 s60, s63, 32768
buffer_load_dwordx4 v[168:171], v41, s[48:51], s60 offen
s_add_u32 s60, s63, 49152
buffer_load_dwordx4 v[172:175], v41, s[48:51], s60 offen
s_add_u32 s63, s63, 65536
s_cmp_eq_u32 s63, 1835008
s_cselect_b32 s63, 0, s63
s_add_u32 s60, s63, 0
buffer_load_dwordx4 v[176:179], v41, s[48:51], s60 offen
s_add_u32 s60, s63, 16384
buffer_load_dwordx4 v[180:183], v41, s[48:51], s60 offen
s_add_u32 s60, s63, 32768
buffer_load_dwordx4 v[184:187], v41, s[48:51], s60 offen
s_add_u32 s60, s63, 49152
buffer_load_dwordx4 v[188:191], v41, s[48:51], s60 offen
s_add_u32 s63, s63, 65536
s_cmp_eq_u32 s63, 1835008
s_cselect_b32 s63, 0, s63
s_waitcnt vmcnt(20)
ds_write_b128 v44, v[96:99] offset:49152
ds_write_b128 v44, v[100:103] offset:51200
ds_write_b128 v44, v[104:107] offset:53248
ds_write_b128 v44, v[108:111] offset:55296
s_barrier
s_add_u32 s60, s63, 0
buffer_load_dwordx4 v[192:195], v41, s[48:51], s60 offen
s_add_u32 s60, s63, 16384
buffer_load_dwordx4 v[196:199], v41, s[48:51], s60 offen
s_add_u32 s60, s63, 32768
buffer_load_dwordx4 v[200:203], v41, s[48:51], s60 offen
s_add_u32 s60, s63, 49152
buffer_load_dwordx4 v[204:207], v41, s[48:51], s60 offen
s_add_u32 s63, s63, 65536
s_cmp_eq_u32 s63, 1835008
s_cselect_b32 s63, 0, s63
s_add_u32 s60, s63, 0
buffer_load_dwordx4 v[208:211], v41, s[48:51], s60 offen
s_add_u32 s60, s63, 16384
buffer_load_dwordx4 v[212:215], v41, s[48:51], s60 offen
s_add_u32 s60, s63, 32768
buffer_load_dwordx4 v[216:219], v41, s[48:51], s60 offen
s_add_u32 s60, s63, 49152
buffer_load_dwordx4 v[220:223], v41, s[48:51], s60 offen
s_add_u32 s63, s63, 65536
s_cmp_eq_u32 s63, 1835008
s_cselect_b32 s63, 0, s63
s_waitcnt vmcnt(24)
ds_write_b128 v44, v[112:115] offset:57344
ds_write_b128 v44, v[116:119] offset:59392
ds_write_b128 v44, v[120:123] offset:61440
ds_write_b128 v44, v[124:127] offset:63488
s_barrier
s_add_u32 s60, s63, 0
buffer_load_dwordx4 v[224:227], v41, s[48:51], s60 offen
s_add_u32 s60, s63, 16384
buffer_load_dwordx4 v[228:231], v41, s[48:51], s60 offen
s_add_u32 s60, s63, 32768
buffer_load_dwordx4 v[232:235], v41, s[48:51], s60 offen
s_add_u32 s60, s63, 49152
buffer_load_dwordx4 v[236:239], v41, s[48:51], s60 offen
s_add_u32 s63, s63, 65536
s_cmp_eq_u32 s63, 1835008
s_cselect_b32 s63, 0, s63
s_add_u32 s60, s63, 0
buffer_load_dwordx4 v[240:243], v41, s[48:51], s60 offen
s_add_u32 s60, s63, 16384
buffer_load_dwordx4 v[244:247], v41, s[48:51], s60 offen
s_add_u32 s60, s63, 32768
buffer_load_dwordx4 v[248:251], v41, s[48:51], s60 offen
s_add_u32 s60, s63, 49152
buffer_load_dwordx4 v[252:255], v41, s[48:51], s60 offen
s_add_u32 s63, s63, 65536
s_cmp_eq_u32 s63, 1835008
s_cselect_b32 s63, 0, s63
s_waitcnt vmcnt(28)
ds_write_b128 v45, v[128:131] offset:0
ds_write_b128 v45, v[132:135] offset:2048
ds_write_b128 v45, v[136:139] offset:4096
ds_write_b128 v45, v[140:143] offset:6144
s_waitcnt vmcnt(24)
ds_write_b128 v45, v[144:147] offset:8192
ds_write_b128 v45, v[148:151] offset:10240
ds_write_b128 v45, v[152:155] offset:12288
ds_write_b128 v45, v[156:159] offset:14336
s_barrier
s_waitcnt vmcnt(20)
ds_write_b128 v42, v[160:163] offset:49152
ds_write_b128 v42, v[164:167] offset:51200
ds_write_b128 v42, v[168:171] offset:53248
ds_write_b128 v42, v[172:175] offset:55296
s_waitcnt vmcnt(16)
ds_write_b128 v42, v[176:179] offset:57344
ds_write_b128 v42, v[180:183] offset:59392
ds_write_b128 v42, v[184:187] offset:61440
ds_write_b128 v42, v[188:191] offset:63488
s_waitcnt vmcnt(12)
ds_write_b128 v44, v[192:195] offset:0
ds_write_b128 v44, v[196:199] offset:2048
ds_write_b128 v44, v[200:203] offset:4096
ds_write_b128 v44, v[204:207] offset:6144
s_waitcnt vmcnt(8)
ds_write_b128 v44, v[208:211] offset:8192
ds_write_b128 v44, v[212:215] offset:10240
ds_write_b128 v44, v[216:219] offset:12288
ds_write_b128 v44, v[220:223] offset:14336
s_waitcnt vmcnt(4)
ds_write_b128 v44, v[224:227] offset:16384
ds_write_b128 v44, v[228:231] offset:18432
ds_write_b128 v44, v[232:235] offset:20480
ds_write_b128 v44, v[236:239] offset:22528
s_waitcnt vmcnt(0)
ds_write_b128 v44, v[240:243] offset:24576
ds_write_b128 v44, v[244:247] offset:26624
ds_write_b128 v44, v[248:251] offset:28672
ds_write_b128 v44, v[252:255] offset:30720
s_waitcnt vmcnt(10)
s_add_u32 m0, s59, 98304
s_add_u32 s60, s63, 0
buffer_load_dwordx4 v41, s[48:51], s60 offen lds
s_add_u32 m0, s59, 100352
s_add_u32 s60, s63, 16384
buffer_load_dwordx4 v41, s[48:51], s60 offen lds
s_add_u32 m0, s59, 102400
s_add_u32 s60, s63, 32768
buffer_load_dwordx4 v41, s[48:51], s60 offen lds
s_add_u32 m0, s59, 104448
s_add_u32 s60, s63, 49152
buffer_load_dwordx4 v41, s[48:51], s60 offen lds
s_add_u32 s63, s63, 65536
s_cmp_eq_u32 s63, 1835008
s_cselect_b32 s63, 0, s63
s_waitcnt vmcnt(10)
s_add_u32 m0, s59, 106496
s_add_u32 s60, s63, 0
buffer_load_dwordx4 v41, s[48:51], s60 offen lds
s_add_u32 m0, s59, 108544
s_add_u32 s60, s63, 16384
buffer_load_dwordx4 v41, s[48:51], s60 offen lds
s_add_u32 m0, s59, 110592
s_add_u32 s60, s63, 32768
buffer_load_dwordx4 v41, s[48:51], s60 offen lds
s_add_u32 m0, s59, 112640
s_add_u32 s60, s63, 49152
buffer_load_dwordx4 v41, s[48:51], s60 offen lds
s_add_u32 s63, s63, 65536
s_cmp_eq_u32 s63, 1835008
s_cselect_b32 s63, 0, s63
s_waitcnt vmcnt(10)
s_add_u32 m0, s59, 32768
s_add_u32 s60, s63, 0
buffer_load_dwordx4 v41, s[48:51], s60 offen lds
s_add_u32 m0, s59, 34816
s_add_u32 s60, s63, 16384
buffer_load_dwordx4 v41, s[48:51], s60 offen lds
s_add_u32 m0, s59, 36864
s_add_u32 s60, s63, 32768
buffer_load_dwordx4 v41, s[48:51], s60 offen lds
s_add_u32 m0, s59, 38912
s_add_u32 s60, s63, 49152
buffer_load_dwordx4 v41, s[48:51], s60 offen lds
s_add_u32 s63, s63, 65536
s_cmp_eq_u32 s63, 1835008
s_cselect_b32 s63, 0, s63
s_waitcnt vmcnt(10)
s_add_u32 m0, s59, 40960
s_add_u32 s60, s63, 0
buffer_load_dwordx4 v41, s[48:51], s60 offen lds
s_add_u32 m0, s59, 43008
s_add_u32 s60, s63, 16384
buffer_load_dwordx4 v41, s[48:51], s60 offen lds
s_add_u32 m0, s59, 45056
s_add_u32 s60, s63, 32768
buffer_load_dwordx4 v41, s[48:51], s60 offen lds
s_add_u32 m0, s59, 47104
s_add_u32 s60, s63, 49152
buffer_load_dwordx4 v41, s[48:51], s60 offen lds
s_add_u32 s63, s63, 65536
s_cmp_eq_u32 s63, 1835008
s_cselect_b32 s63, 0, s63
s_waitcnt lgkmcnt(0)
v_and_b32 v12, 7, v1
v_lshlrev_b32 v12, 2, v12
v_bfe_u32 v13, v1, 3, 2
v_lshl_add_u32 v13, v13, 7, v12
v_bfe_u32 v14, v1, 3, 1
v_lshl_add_u32 v14, v14, 7, v12
s_lshl_b32 s77, s66, 8
s_add_u32 s77, s77, 12394496
s_lshl_b32 s76, s66, 9
s_add_u32 s76, s76, 12402688
s_cmp_lg_u32 s31, 0
s_cbranch_scc1 k_hf_xb
buffer_load_dword v17, v13, s[44:47], s76 offen sc1
s_waitcnt vmcnt(0)
v_cmp_ne_u32 vcc, s79, v17
s_mov_b32 s60, 0
s_nop 3
s_cbranch_vccz k_hfb_ok
k_hfb_spin:
s_sleep 2
buffer_load_dword v17, v13, s[44:47], s76 offen sc1
s_add_u32 s60, s60, 1
s_cmp_gt_u32 s60, 131072
s_cbranch_scc1 k_hfb_ok
s_waitcnt vmcnt(0)
v_cmp_ne_u32 vcc, s79, v17
s_nop 4
s_cbranch_vccnz k_hfb_spin
k_hfb_ok:
v_mov_b32 v16, 1
s_mov_b64 exec, 1
ds_add_u32 v8, v16 offset:16
s_mov_b64 exec, -1
k_hf_xb:
s_waitcnt vmcnt(0) lgkmcnt(0)
s_barrier
s_cmp_lg_u32 s31, 0
s_cbranch_scc1 k_end
s_barrier
s_barrier
s_barrier
s_barrier
s_barrier
s_barrier
s_barrier
s_barrier
s_barrier
s_barrier
s_barrier
s_barrier
s_barrier
s_barrier
s_barrier
s_barrier
s_barrier
s_barrier
s_barrier
s_barrier
buffer_load_dword v17, v14, s[44:47], s77 offen sc1
s_barrier
s_barrier
s_waitcnt vmcnt(0)
v_cmp_ne_u32 vcc, s79, v17
s_mov_b32 s60, 0
s_nop 3
s_cbranch_vccz k_ofb_ok
k_ofb_spin:
s_sleep 1
buffer_load_dword v17, v14, s[44:47], s77 offen sc1
s_add_u32 s60, s60, 1
s_cmp_gt_u32 s60, 131072
s_cbranch_scc1 k_ofb_ok
s_waitcnt vmcnt(0)
v_cmp_ne_u32 vcc, s79, v17
s_nop 4
s_cbranch_vccnz k_ofb_spin
k_ofb_ok:
s_barrier
s_endpgm
k_lda:
s_add_u32 m0, s71, 2048
s_add_u32 s77, s74, 128
buffer_load_dwordx4 v3, s[36:39], s77 offen lds
s_add_u32 m0, s71, 10240
s_add_u32 s77, s74, 114816
buffer_load_dwordx4 v3, s[36:39], s77 offen lds
s_add_u32 m0, s71, 3072
s_add_u32 s77, s74, 14464
buffer_load_dwordx4 v3, s[36:39], s77 offen lds
s_add_u32 m0, s71, 11264
s_add_u32 s77, s74, 129152
buffer_load_dwordx4 v3, s[36:39], s77 offen lds
s_add_u32 s73, s73, 128
s_add_u32 s74, s74, 229376
s_and_b32 s73, s73, 1023
s_cselect_b32 s74, s74, s72
s_add_u32 s40, s6, s64
s_addc_u32 s41, s7, 0
s_and_b32 s41, s41, 0xffff
s_sub_u32 s42, 1572864, s64
s_mov_b32 s43, 0x00020000
s_lshl_b32 s76, s26, 5
s_lshl_b32 s78, s31, 2
s_add_u32 s78, s78, s76
s_mul_i32 s68, s78, 3584
s_mul_i32 s69, s78, 3072
s_mul_i32 s70, s76, 3584
s_lshl_b32 s66, s31, 10
s_add_u32 m0, s71, 65536
s_add_u32 s77, s73, 0
buffer_load_dwordx4 v2, s[32:35], s77 offen lds
s_add_u32 m0, s71, 73728
s_add_u32 s77, s73, 65536
buffer_load_dwordx4 v2, s[32:35], s77 offen lds
s_add_u32 m0, s71, 66560
s_add_u32 s77, s73, 8192
buffer_load_dwordx4 v2, s[32:35], s77 offen lds
s_add_u32 m0, s71, 74752
s_add_u32 s77, s73, 73728
buffer_load_dwordx4 v2, s[32:35], s77 offen lds
s_add_u32 m0, s71, 67584
s_add_u32 s77, s73, 16384
buffer_load_dwordx4 v2, s[32:35], s77 offen lds
s_add_u32 m0, s71, 75776
s_add_u32 s77, s73, 81920
buffer_load_dwordx4 v2, s[32:35], s77 offen lds
s_add_u32 m0, s71, 68608
s_add_u32 s77, s73, 24576
buffer_load_dwordx4 v2, s[32:35], s77 offen lds
s_add_u32 m0, s71, 76800
s_add_u32 s77, s73, 90112
buffer_load_dwordx4 v2, s[32:35], s77 offen lds
s_add_u32 m0, s71, 16384
s_add_u32 s77, s74, 0
buffer_load_dwordx4 v3, s[36:39], s77 offen lds
s_add_u32 m0, s71, 24576
s_add_u32 s77, s74, 114688
buffer_load_dwordx4 v3, s[36:39], s77 offen lds
s_add_u32 m0, s71, 17408
s_add_u32 s77, s74, 14336
buffer_load_dwordx4 v3, s[36:39], s77 offen lds
s_add_u32 m0, s71, 25600
s_add_u32 s77, s74, 129024
buffer_load_dwordx4 v3, s[36:39], s77 offen lds
s_add_u32 m0, s71, 18432
s_add_u32 s77, s74, 128
buffer_load_dwordx4 v3, s[36:39], s77 offen lds
s_add_u32 m0, s71, 26624
s_add_u32 s77, s74, 114816
buffer_load_dwordx4 v3, s[36:39], s77 offen lds
s_add_u32 m0, s71, 19456
s_add_u32 s77, s74, 14464
buffer_load_dwordx4 v3, s[36:39], s77 offen lds
s_add_u32 m0, s71, 27648
s_add_u32 s77, s74, 129152
buffer_load_dwordx4 v3, s[36:39], s77 offen lds
s_add_u32 s73, s73, 128
s_add_u32 s74, s74, 229376
s_and_b32 s73, s73, 1023
s_cselect_b32 s74, s74, s72
s_add_u32 m0, s66, 131072
s_add_u32 s77, s68, 0
buffer_load_dwordx4 v3, s[36:39], s77 offen lds
s_add_u32 m0, s66, 139264
s_add_u32 s77, s68, 57344
buffer_load_dwordx4 v3, s[36:39], s77 offen lds
s_add_u32 m0, s66, 133120
s_add_u32 s77, s68, 128
buffer_load_dwordx4 v3, s[36:39], s77 offen lds
s_add_u32 m0, s66, 141312
s_add_u32 s77, s68, 57472
buffer_load_dwordx4 v3, s[36:39], s77 offen lds
s_add_u32 m0, s66, 135168
s_add_u32 s77, s69, 0
buffer_load_dwordx4 v39, s[40:43], s77 offen lds
s_add_u32 m0, s66, 143360
s_add_u32 s77, s69, 49152
buffer_load_dwordx4 v39, s[40:43], s77 offen lds
s_waitcnt vmcnt(22)
s_barrier
s_add_u32 m0, s71, 81920
s_add_u32 s77, s73, 0
buffer_load_dwordx4 v2, s[32:35], s77 offen lds
s_add_u32 m0, s71, 90112
s_add_u32 s77, s73, 65536
buffer_load_dwordx4 v2, s[32:35], s77 offen lds
s_add_u32 m0, s71, 82944
s_add_u32 s77, s73, 8192
buffer_load_dwordx4 v2, s[32:35], s77 offen lds
s_add_u32 m0, s71, 91136
s_add_u32 s77, s73, 73728
buffer_load_dwordx4 v2, s[32:35], s77 offen lds
s_add_u32 m0, s71, 83968
s_add_u32 s77, s73, 16384
buffer_load_dwordx4 v2, s[32:35], s77 offen lds
s_add_u32 m0, s71, 92160
s_add_u32 s77, s73, 81920
buffer_load_dwordx4 v2, s[32:35], s77 offen lds
s_add_u32 m0, s71, 84992
s_add_u32 s77, s73, 24576
buffer_load_dwordx4 v2, s[32:35], s77 offen lds
s_add_u32 m0, s71, 93184
s_add_u32 s77, s73, 90112
buffer_load_dwordx4 v2, s[32:35], s77 offen lds
s_add_u32 m0, s71, 32768
s_add_u32 s77, s74, 0
buffer_load_dwordx4 v3, s[36:39], s77 offen lds
s_add_u32 m0, s71, 40960
s_add_u32 s77, s74, 114688
buffer_load_dwordx4 v3, s[36:39], s77 offen lds
s_add_u32 m0, s71, 33792
s_add_u32 s77, s74, 14336
buffer_load_dwordx4 v3, s[36:39], s77 offen lds
s_add_u32 m0, s71, 41984
s_add_u32 s77, s74, 129024
buffer_load_dwordx4 v3, s[36:39], s77 offen lds
s_add_u32 m0, s71, 34816
s_add_u32 s77, s74, 128
buffer_load_dwordx4 v3, s[36:39], s77 offen lds
s_add_u32 m0, s71, 43008
s_add_u32 s77, s74, 114816
buffer_load_dwordx4 v3, s[36:39], s77 offen lds
s_add_u32 m0, s71, 35840
s_add_u32 s77, s74, 14464
buffer_load_dwordx4 v3, s[36:39], s77 offen lds
s_add_u32 m0, s71, 44032
s_add_u32 s77, s74, 129152
buffer_load_dwordx4 v3, s[36:39], s77 offen lds
s_add_u32 s73, s73, 128
s_add_u32 s74, s74, 229376
s_and_b32 s73, s73, 1023
s_cselect_b32 s74, s74, s72
s_waitcnt vmcnt(16)
s_barrier
s_add_u32 m0, s71, 98304
s_add_u32 s77, s73, 0
buffer_load_dwordx4 v2, s[32:35], s77 offen lds
s_add_u32 m0, s71, 106496
s_add_u32 s77, s73, 65536
buffer_load_dwordx4 v2, s[32:35], s77 offen lds
s_add_u32 m0, s71, 99328
s_add_u32 s77, s73, 8192
buffer_load_dwordx4 v2, s[32:35], s77 offen lds
s_add_u32 m0, s71, 107520
s_add_u32 s77, s73, 73728
buffer_load_dwordx4 v2, s[32:35], s77 offen lds
s_add_u32 m0, s71, 100352
s_add_u32 s77, s73, 16384
buffer_load_dwordx4 v2, s[32:35], s77 offen lds
s_add_u32 m0, s71, 108544
s_add_u32 s77, s73, 81920
buffer_load_dwordx4 v2, s[32:35], s77 offen lds
s_add_u32 m0, s71, 101376
s_add_u32 s77, s73, 24576
buffer_load_dwordx4 v2, s[32:35], s77 offen lds
s_add_u32 m0, s71, 109568
s_add_u32 s77, s73, 90112
buffer_load_dwordx4 v2, s[32:35], s77 offen lds
s_add_u32 m0, s71, 0
s_add_u32 s77, s74, 0
buffer_load_dwordx4 v3, s[36:39], s77 offen lds
s_add_u32 m0, s71, 8192
s_add_u32 s77, s74, 114688
buffer_load_dwordx4 v3, s[36:39], s77 offen lds
s_add_u32 m0, s71, 1024
s_add_u32 s77, s74, 14336
buffer_load_dwordx4 v3, s[36:39], s77 offen lds
s_add_u32 m0, s71, 9216
s_add_u32 s77, s74, 129024
buffer_load_dwordx4 v3, s[36:39], s77 offen lds
s_add_u32 m0, s71, 2048
s_add_u32 s77, s74, 128
buffer_load_dwordx4 v3, s[36:39], s77 offen lds
s_add_u32 m0, s71, 10240
s_add_u32 s77, s74, 114816
buffer_load_dwordx4 v3, s[36:39], s77 offen lds
s_add_u32 m0, s71, 3072
s_add_u32 s77, s74, 14464
buffer_load_dwordx4 v3, s[36:39], s77 offen lds
s_add_u32 m0, s71, 11264
s_add_u32 s77, s74, 129152
buffer_load_dwordx4 v3, s[36:39], s77 offen lds
s_add_u32 s73, s73, 128
s_add_u32 s74, s74, 229376
s_and_b32 s73, s73, 1023
s_cselect_b32 s74, s74, s72
s_waitcnt vmcnt(16)
s_barrier
s_add_u32 m0, s71, 114688
s_add_u32 s77, s73, 0
buffer_load_dwordx4 v2, s[32:35], s77 offen lds
s_add_u32 m0, s71, 122880
s_add_u32 s77, s73, 65536
buffer_load_dwordx4 v2, s[32:35], s77 offen lds
s_add_u32 m0, s71, 115712
s_add_u32 s77, s73, 8192
buffer_load_dwordx4 v2, s[32:35], s77 offen lds
s_add_u32 m0, s71, 123904
s_add_u32 s77, s73, 73728
buffer_load_dwordx4 v2, s[32:35], s77 offen lds
s_add_u32 m0, s71, 116736
s_add_u32 s77, s73, 16384
buffer_load_dwordx4 v2, s[32:35], s77 offen lds
s_add_u32 m0, s71, 124928
s_add_u32 s77, s73, 81920
buffer_load_dwordx4 v2, s[32:35], s77 offen lds
s_add_u32 m0, s71, 117760
s_add_u32 s77, s73, 24576
buffer_load_dwordx4 v2, s[32:35], s77 offen lds
s_add_u32 m0, s71, 125952
s_add_u32 s77, s73, 90112
buffer_load_dwordx4 v2, s[32:35], s77 offen lds
s_add_u32 m0, s71, 16384
s_add_u32 s77, s74, 0
buffer_load_dwordx4 v3, s[36:39], s77 offen lds
s_add_u32 m0, s71, 24576
s_add_u32 s77, s74, 114688
buffer_load_dwordx4 v3, s[36:39], s77 offen lds
s_add_u32 m0, s71, 17408
s_add_u32 s77, s74, 14336
buffer_load_dwordx4 v3, s[36:39], s77 offen lds
s_add_u32 m0, s71, 25600
s_add_u32 s77, s74, 129024
buffer_load_dwordx4 v3, s[36:39], s77 offen lds
s_add_u32 m0, s71, 18432
s_add_u32 s77, s74, 128
buffer_load_dwordx4 v3, s[36:39], s77 offen lds
s_add_u32 m0, s71, 26624
s_add_u32 s77, s74, 114816
buffer_load_dwordx4 v3, s[36:39], s77 offen lds
s_add_u32 m0, s71, 19456
s_add_u32 s77, s74, 14464
buffer_load_dwordx4 v3, s[36:39], s77 offen lds
s_add_u32 m0, s71, 27648
s_add_u32 s77, s74, 129152
buffer_load_dwordx4 v3, s[36:39], s77 offen lds
s_add_u32 s73, s73, 128
s_add_u32 s74, s74, 229376
s_and_b32 s73, s73, 1023
s_cselect_b32 s74, s74, s72
s_waitcnt vmcnt(16)
s_barrier
s_add_u32 m0, s71, 131072
s_add_u32 s77, s73, 0
buffer_load_dwordx4 v2, s[32:35], s77 offen lds
s_add_u32 m0, s71, 139264
s_add_u32 s77, s73, 65536
buffer_load_dwordx4 v2, s[32:35], s77 offen lds
s_add_u32 m0, s71, 132096
s_add_u32 s77, s73, 8192
buffer_load_dwordx4 v2, s[32:35], s77 offen lds
s_add_u32 m0, s71, 140288
s_add_u32 s77, s73, 73728
buffer_load_dwordx4 v2, s[32:35], s77 offen lds
s_add_u32 m0, s71, 133120
s_add_u32 s77, s73, 16384
buffer_load_dwordx4 v2, s[32:35], s77 offen lds
s_add_u32 m0, s71, 141312
s_add_u32 s77, s73, 81920
buffer_load_dwordx4 v2, s[32:35], s77 offen lds
s_add_u32 m0, s71, 134144
s_add_u32 s77, s73, 24576
buffer_load_dwordx4 v2, s[32:35], s77 offen lds
s_add_u32 m0, s71, 142336
s_add_u32 s77, s73, 90112
buffer_load_dwordx4 v2, s[32:35], s77 offen lds
s_add_u32 m0, s71, 32768
s_add_u32 s77, s74, 0
buffer_load_dwordx4 v3, s[36:39], s77 offen lds
s_add_u32 m0, s71, 40960
s_add_u32 s77, s74, 114688
buffer_load_dwordx4 v3, s[36:39], s77 offen lds
s_add_u32 m0, s71, 33792
s_add_u32 s77, s74, 14336
buffer_load_dwordx4 v3, s[36:39], s77 offen lds
s_add_u32 m0, s71, 41984
s_add_u32 s77, s74, 129024
buffer_load_dwordx4 v3, s[36:39], s77 offen lds
s_add_u32 m0, s71, 34816
s_add_u32 s77, s74, 128
buffer_load_dwordx4 v3, s[36:39], s77 offen lds
s_add_u32 m0, s71, 43008
s_add_u32 s77, s74, 114816
buffer_load_dwordx4 v3, s[36:39], s77 offen lds
s_add_u32 m0, s71, 35840
s_add_u32 s77, s74, 14464
buffer_load_dwordx4 v3, s[36:39], s77 offen lds
s_add_u32 m0, s71, 44032
s_add_u32 s77, s74, 129152
buffer_load_dwordx4 v3, s[36:39], s77 offen lds
s_add_u32 s73, s73, 128
s_add_u32 s74, s74, 229376
s_and_b32 s73, s73, 1023
s_cselect_b32 s74, s74, s72
s_waitcnt vmcnt(16)
s_barrier
s_add_u32 m0, s71, 49152
s_add_u32 s77, s73, 0
buffer_load_dwordx4 v2, s[32:35], s77 offen lds
s_add_u32 m0, s71, 57344
s_add_u32 s77, s73, 65536
buffer_load_dwordx4 v2, s[32:35], s77 offen lds
s_add_u32 m0, s71, 50176
s_add_u32 s77, s73, 8192
buffer_load_dwordx4 v2, s[32:35], s77 offen lds
s_add_u32 m0, s71, 58368
s_add_u32 s77, s73, 73728
buffer_load_dwordx4 v2, s[32:35], s77 offen lds
s_add_u32 m0, s71, 51200
s_add_u32 s77, s73, 16384
buffer_load_dwordx4 v2, s[32:35], s77 offen lds
s_add_u32 m0, s71, 59392
s_add_u32 s77, s73, 81920
buffer_load_dwordx4 v2, s[32:35], s77 offen lds
s_add_u32 m0, s71, 52224
s_add_u32 s77, s73, 24576
buffer_load_dwordx4 v2, s[32:35], s77 offen lds
s_add_u32 m0, s71, 60416
s_add_u32 s77, s73, 90112
buffer_load_dwordx4 v2, s[32:35], s77 offen lds
s_add_u32 m0, s71, 0
s_add_u32 s77, s74, 0
buffer_load_dwordx4 v3, s[36:39], s77 offen lds
s_add_u32 m0, s71, 8192
s_add_u32 s77, s74, 114688
buffer_load_dwordx4 v3, s[36:39], s77 offen lds
s_add_u32 m0, s71, 1024
s_add_u32 s77, s74, 14336
buffer_load_dwordx4 v3, s[36:39], s77 offen lds
s_add_u32 m0, s71, 9216
s_add_u32 s77, s74, 129024
buffer_load_dwordx4 v3, s[36:39], s77 offen lds
s_add_u32 m0, s71, 2048
s_add_u32 s77, s74, 128
buffer_load_dwordx4 v3, s[36:39], s77 offen lds
s_add_u32 m0, s71, 10240
s_add_u32 s77, s74, 114816
buffer_load_dwordx4 v3, s[36:39], s77 offen lds
s_add_u32 m0, s71, 3072
s_add_u32 s77, s74, 14464
buffer_load_dwordx4 v3, s[36:39], s77 offen lds
s_add_u32 m0, s71, 11264
s_add_u32 s77, s74, 129152
buffer_load_dwordx4 v3, s[36:39], s77 offen lds
s_add_u32 s73, s73, 128
s_add_u32 s74, s74, 229376
s_and_b32 s73, s73, 1023
s_cselect_b32 s74, s74, s72
s_waitcnt vmcnt(16)
s_barrier
s_add_u32 m0, s71, 65536
s_add_u32 s77, s73, 0
buffer_load_dwordx4 v2, s[32:35], s77 offen lds
s_add_u32 m0, s71, 73728
s_add_u32 s77, s73, 65536
buffer_load_dwordx4 v2, s[32:35], s77 offen lds
s_add_u32 m0, s71, 66560
s_add_u32 s77, s73, 8192
buffer_load_dwordx4 v2, s[32:35], s77 offen lds
s_add_u32 m0, s71, 74752
s_add_u32 s77, s73, 73728
buffer_load_dwordx4 v2, s[32:35], s77 offen lds
s_add_u32 m0, s71, 67584
s_add_u32 s77, s73, 16384
buffer_load_dwordx4 v2, s[32:35], s77 offen lds
s_add_u32 m0, s71, 75776
s_add_u32 s77, s73, 81920
buffer_load_dwordx4 v2, s[32:35], s77 offen lds
s_add_u32 m0, s71, 68608
s_add_u32 s77, s73, 24576
buffer_load_dwordx4 v2, s[32:35], s77 offen lds
s_add_u32 m0, s71, 76800
s_add_u32 s77, s73, 90112
buffer_load_dwordx4 v2, s[32:35], s77 offen lds
s_add_u32 m0, s71, 16384
s_add_u32 s77, s74, 0
buffer_load_dwordx4 v3, s[36:39], s77 offen lds
s_add_u32 m0, s71, 24576
s_add_u32 s77, s74, 114688
buffer_load_dwordx4 v3, s[36:39], s77 offen lds
s_add_u32 m0, s71, 17408
s_add_u32 s77, s74, 14336
buffer_load_dwordx4 v3, s[36:39], s77 offen lds
s_add_u32 m0, s71, 25600
s_add_u32 s77, s74, 129024
buffer_load_dwordx4 v3, s[36:39], s77 offen lds
s_add_u32 m0, s71, 18432
s_add_u32 s77, s74, 128
buffer_load_dwordx4 v3, s[36:39], s77 offen lds
s_add_u32 m0, s71, 26624
s_add_u32 s77, s74, 114816
buffer_load_dwordx4 v3, s[36:39], s77 offen lds
s_add_u32 m0, s71, 19456
s_add_u32 s77, s74, 14464
buffer_load_dwordx4 v3, s[36:39], s77 offen lds
s_add_u32 m0, s71, 27648
s_add_u32 s77, s74, 129152
buffer_load_dwordx4 v3, s[36:39], s77 offen lds
s_add_u32 s73, s73, 128
s_add_u32 s74, s74, 229376
s_and_b32 s73, s73, 1023
s_cselect_b32 s74, s74, s72
s_waitcnt vmcnt(16)
s_barrier
s_add_u32 s75, s57, 2
s_and_b32 s75, s75, 7
s_mul_i32 s72, s31, 49152
s_mul_i32 s74, s75, 196608
s_add_u32 s74, s74, s72
s_add_u32 s75, s72, 8*196608
s_lshr_b32 s30, s71, 1
s_add_u32 m0, s30, 32768
s_add_u32 s77, s74, 0
buffer_load_dwordx4 v39, s[40:43], s77 offen lds
s_add_u32 m0, s30, 36864
s_add_u32 s77, s74, 98304
buffer_load_dwordx4 v39, s[40:43], s77 offen lds
s_add_u32 m0, s30, 33792
s_add_u32 s77, s74, 12288
buffer_load_dwordx4 v39, s[40:43], s77 offen lds
s_add_u32 m0, s30, 37888
s_add_u32 s77, s74, 110592
buffer_load_dwordx4 v39, s[40:43], s77 offen lds
s_add_u32 s74, s74, 196608
s_cmp_eq_u32 s74, s75
s_cselect_b32 s74, s72, s74
s_add_u32 m0, s30, 40960
s_add_u32 s77, s74, 0
buffer_load_dwordx4 v39, s[40:43], s77 offen lds
s_add_u32 m0, s30, 45056
s_add_u32 s77, s74, 98304
buffer_load_dwordx4 v39, s[40:43], s77 offen lds
s_add_u32 m0, s30, 41984
s_add_u32 s77, s74, 12288
buffer_load_dwordx4 v39, s[40:43], s77 offen lds
s_add_u32 m0, s30, 46080
s_add_u32 s77, s74, 110592
buffer_load_dwordx4 v39, s[40:43], s77 offen lds
s_add_u32 s74, s74, 196608
s_cmp_eq_u32 s74, s75
s_cselect_b32 s74, s72, s74
s_waitcnt vmcnt(8)
s_barrier
s_add_u32 m0, s30, 0
s_add_u32 s77, s74, 0
buffer_load_dwordx4 v39, s[40:43], s77 offen lds
s_add_u32 m0, s30, 4096
s_add_u32 s77, s74, 98304
buffer_load_dwordx4 v39, s[40:43], s77 offen lds
s_add_u32 m0, s30, 1024
s_add_u32 s77, s74, 12288
buffer_load_dwordx4 v39, s[40:43], s77 offen lds
s_add_u32 m0, s30, 5120
s_add_u32 s77, s74, 110592
buffer_load_dwordx4 v39, s[40:43], s77 offen lds
s_add_u32 s74, s74, 196608
s_cmp_eq_u32 s74, s75
s_cselect_b32 s74, s72, s74
s_add_u32 m0, s30, 8192
s_add_u32 s77, s74, 0
buffer_load_dwordx4 v39, s[40:43], s77 offen lds
s_add_u32 m0, s30, 12288
s_add_u32 s77, s74, 98304
buffer_load_dwordx4 v39, s[40:43], s77 offen lds
s_add_u32 m0, s30, 9216
s_add_u32 s77, s74, 12288
buffer_load_dwordx4 v39, s[40:43], s77 offen lds
s_add_u32 m0, s30, 13312
s_add_u32 s77, s74, 110592
buffer_load_dwordx4 v39, s[40:43], s77 offen lds
s_add_u32 s74, s74, 196608
s_cmp_eq_u32 s74, s75
s_cselect_b32 s74, s72, s74
s_waitcnt vmcnt(12)
s_barrier
s_add_u32 m0, s30, 16384
s_add_u32 s77, s74, 0
buffer_load_dwordx4 v39, s[40:43], s77 offen lds
s_add_u32 m0, s30, 20480
s_add_u32 s77, s74, 98304
buffer_load_dwordx4 v39, s[40:43], s77 offen lds
s_add_u32 m0, s30, 17408
s_add_u32 s77, s74, 12288
buffer_load_dwordx4 v39, s[40:43], s77 offen lds
s_add_u32 m0, s30, 21504
s_add_u32 s77, s74, 110592
buffer_load_dwordx4 v39, s[40:43], s77 offen lds
s_add_u32 s74, s74, 196608
s_cmp_eq_u32 s74, s75
s_cselect_b32 s74, s72, s74
s_add_u32 m0, s30, 24576
s_add_u32 s77, s74, 0
buffer_load_dwordx4 v39, s[40:43], s77 offen lds
s_add_u32 m0, s30, 28672
s_add_u32 s77, s74, 98304
buffer_load_dwordx4 v39, s[40:43], s77 offen lds
s_add_u32 m0, s30, 25600
s_add_u32 s77, s74, 12288
buffer_load_dwordx4 v39, s[40:43], s77 offen lds
s_add_u32 m0, s30, 29696
s_add_u32 s77, s74, 110592
buffer_load_dwordx4 v39, s[40:43], s77 offen lds
s_add_u32 s74, s74, 196608
s_cmp_eq_u32 s74, s75
s_cselect_b32 s74, s72, s74
s_waitcnt vmcnt(16)
s_barrier
s_add_u32 m0, s30, 32768
s_add_u32 s77, s74, 0
buffer_load_dwordx4 v39, s[40:43], s77 offen lds
s_add_u32 m0, s30, 36864
s_add_u32 s77, s74, 98304
buffer_load_dwordx4 v39, s[40:43], s77 offen lds
s_add_u32 m0, s30, 33792
s_add_u32 s77, s74, 12288
buffer_load_dwordx4 v39, s[40:43], s77 offen lds
s_add_u32 m0, s30, 37888
s_add_u32 s77, s74, 110592
buffer_load_dwordx4 v39, s[40:43], s77 offen lds
s_add_u32 s74, s74, 196608
s_cmp_eq_u32 s74, s75
s_cselect_b32 s74, s72, s74
s_add_u32 m0, s71, 81920
s_add_u32 s77, s73, 0
buffer_load_dwordx4 v2, s[32:35], s77 offen lds
s_add_u32 m0, s71, 90112
s_add_u32 s77, s73, 65536
buffer_load_dwordx4 v2, s[32:35], s77 offen lds
s_add_u32 m0, s71, 82944
s_add_u32 s77, s73, 8192
buffer_load_dwordx4 v2, s[32:35], s77 offen lds
s_add_u32 m0, s71, 91136
s_add_u32 s77, s73, 73728
buffer_load_dwordx4 v2, s[32:35], s77 offen lds
s_add_u32 m0, s71, 83968
s_add_u32 s77, s73, 16384
buffer_load_dwordx4 v2, s[32:35], s77 offen lds
s_add_u32 m0, s71, 92160
s_add_u32 s77, s73, 81920
buffer_load_dwordx4 v2, s[32:35], s77 offen lds
s_add_u32 m0, s71, 84992
s_add_u32 s77, s73, 24576
buffer_load_dwordx4 v2, s[32:35], s77 offen lds
s_add_u32 m0, s71, 93184
s_add_u32 s77, s73, 90112
buffer_load_dwordx4 v2, s[32:35], s77 offen lds
s_add_u32 s73, s73, 128
s_and_b32 s73, s73, 1023
s_waitcnt vmcnt(24)
s_barrier
s_add_u32 m0, s30, 40960
s_add_u32 s77, s74, 0
buffer_load_dwordx4 v39, s[40:43], s77 offen lds
s_add_u32 m0, s30, 45056
s_add_u32 s77, s74, 98304
buffer_load_dwordx4 v39, s[40:43], s77 offen lds
s_add_u32 m0, s30, 41984
s_add_u32 s77, s74, 12288
buffer_load_dwordx4 v39, s[40:43], s77 offen lds
s_add_u32 m0, s30, 46080
s_add_u32 s77, s74, 110592
buffer_load_dwordx4 v39, s[40:43], s77 offen lds
s_add_u32 s74, s74, 196608
s_cmp_eq_u32 s74, s75
s_cselect_b32 s74, s72, s74
s_add_u32 m0, s71, 98304
s_add_u32 s77, s73, 0
buffer_load_dwordx4 v2, s[32:35], s77 offen lds
s_add_u32 m0, s71, 106496
s_add_u32 s77, s73, 65536
buffer_load_dwordx4 v2, s[32:35], s77 offen lds
s_add_u32 m0, s71, 99328
s_add_u32 s77, s73, 8192
buffer_load_dwordx4 v2, s[32:35], s77 offen lds
s_add_u32 m0, s71, 107520
s_add_u32 s77, s73, 73728
buffer_load_dwordx4 v2, s[32:35], s77 offen lds
s_add_u32 m0, s71, 100352
s_add_u32 s77, s73, 16384
buffer_load_dwordx4 v2, s[32:35], s77 offen lds
s_add_u32 m0, s71, 108544
s_add_u32 s77, s73, 81920
buffer_load_dwordx4 v2, s[32:35], s77 offen lds
s_add_u32 m0, s71, 101376
s_add_u32 s77, s73, 24576
buffer_load_dwordx4 v2, s[32:35], s77 offen lds
s_add_u32 m0, s71, 109568
s_add_u32 s77, s73, 90112
buffer_load_dwordx4 v2, s[32:35], s77 offen lds
s_add_u32 s73, s73, 128
s_and_b32 s73, s73, 1023
s_waitcnt vmcnt(32)
s_barrier
s_waitcnt vmcnt(28)
s_barrier
s_mov_b32 s44, s24
s_and_b32 s45, s25, 0xffff
s_mov_b32 s46, 16777216
s_mov_b32 s47, 0x00020000
s_and_b32 s60, s2, 7
s_lshl_b32 s60, s60, 2
s_lshr_b32 s61, s58, 3
s_add_u32 s66, s60, s61
s_and_b32 s58, s58, 7
s_lshl_b32 s65, s58, 7
s_add_u32 s48, s16, s65
s_addc_u32 s49, s17, 0
s_and_b32 s49, s49, 0xffff
s_sub_u32 s50, 1835008, s65
s_mov_b32 s51, 0x00020000
s_add_u32 s52, s8, s65
s_addc_u32 s53, s9, 0
s_and_b32 s53, s53, 0xffff
s_sub_u32 s54, 524288, s65
s_mov_b32 s55, 0x00020000
s_and_b32 s60, s66, 2
s_mul_i32 s60, s60, 7
s_mul_i32 s61, s58, 7
s_lshr_b32 s61, s61, 1
s_add_u32 s60, s60, s61
s_and_b32 s61, s2, 7
s_mul_i32 s61, s61, 7
s_lshr_b32 s61, s61, 2
s_add_u32 s60, s60, s61
s_cmp_ge_u32 s60, 28
s_cselect_b32 s61, 28, 0
s_sub_u32 s60, s60, s61
s_mul_i32 s64, s60, 262144
s_lshl_b32 s63, s60, 16
v_lshrrev_b32 v5, 3, v1
v_and_b32 v6, 7, v1
v_and_b32 v7, 6, v5
v_xor_b32 v7, v7, v6
v_lshlrev_b32 v41, 4, v7
v_lshl_add_u32 v41, v5, 10, v41
s_lshl_b32 s60, s31, 13
v_add_u32 v41, s60, v41
s_lshl_b32 s59, s31, 10
v_lshl_add_u32 v42, v1, 4, s59
s_add_u32 s63, s63, 917504
s_cmp_ge_u32 s63, 1835008
s_cselect_b32 s60, 1835008, 0
s_sub_u32 s63, s63, s60
s_mul_i32 s67, s66, 4096
s_add_u32 s68, s67, 7340032
s_add_u32 s69, s67, s64
v_mov_b32 v8, 150528
s_waitcnt vmcnt(24)
s_barrier
s_waitcnt vmcnt(12)
s_barrier
s_waitcnt vmcnt(0)
s_barrier
s_barrier
k_hf_wa:
s_sleep 1
ds_read_b32 v16, v8 offset:16
s_waitcnt lgkmcnt(0)
v_readfirstlane_b32 s61, v16
s_cmp_lt_u32 s61, 1
s_cbranch_scc1 k_hf_wa
s_add_u32 m0, s59, 0
s_add_u32 s60, s69, 0
buffer_load_dwordx4 v42, s[44:47], s60 offen sc1 lds
s_add_u32 m0, s59, 2048
s_add_u32 s60, s69, 2048
buffer_load_dwordx4 v42, s[44:47], s60 offen sc1 lds
s_add_u32 m0, s59, 4096
s_add_u32 s60, s69, 131072
buffer_load_dwordx4 v42, s[44:47], s60 offen sc1 lds
s_add_u32 m0, s59, 6144
s_add_u32 s60, s69, 133120
buffer_load_dwordx4 v42, s[44:47], s60 offen sc1 lds
s_add_u32 s69, s69, 262144
s_cmp_eq_u32 s69, s68
s_cselect_b32 s69, s67, s69
s_add_u32 m0, s59, 8192
s_add_u32 s60, s69, 0
buffer_load_dwordx4 v42, s[44:47], s60 offen sc1 lds
s_add_u32 m0, s59, 10240
s_add_u32 s60, s69, 2048
buffer_load_dwordx4 v42, s[44:47], s60 offen sc1 lds
s_add_u32 m0, s59, 12288
s_add_u32 s60, s69, 131072
buffer_load_dwordx4 v42, s[44:47], s60 offen sc1 lds
s_add_u32 m0, s59, 14336
s_add_u32 s60, s69, 133120
buffer_load_dwordx4 v42, s[44:47], s60 offen sc1 lds
s_add_u32 s69, s69, 262144
s_cmp_eq_u32 s69, s68
s_cselect_b32 s69, s67, s69
s_add_u32 m0, s59, 16384
s_add_u32 s60, s69, 0
buffer_load_dwordx4 v42, s[44:47], s60 offen sc1 lds
s_add_u32 m0, s59, 18432
s_add_u32 s60, s69, 2048
buffer_load_dwordx4 v42, s[44:47], s60 offen sc1 lds
s_add_u32 m0, s59, 20480
s_add_u32 s60, s69, 131072
buffer_load_dwordx4 v42, s[44:47], s60 offen sc1 lds
s_add_u32 m0, s59, 22528
s_add_u32 s60, s69, 133120
buffer_load_dwordx4 v42, s[44:47], s60 offen sc1 lds
s_add_u32 s69, s69, 262144
s_cmp_eq_u32 s69, s68
s_cselect_b32 s69, s67, s69
s_waitcnt vmcnt(8)
s_barrier
s_add_u32 m0, s59, 24576
s_add_u32 s60, s69, 0
buffer_load_dwordx4 v42, s[44:47], s60 offen sc1 lds
s_add_u32 m0, s59, 26624
s_add_u32 s60, s69, 2048
buffer_load_dwordx4 v42, s[44:47], s60 offen sc1 lds
s_add_u32 m0, s59, 28672
s_add_u32 s60, s69, 131072
buffer_load_dwordx4 v42, s[44:47], s60 offen sc1 lds
s_add_u32 m0, s59, 30720
s_add_u32 s60, s69, 133120
buffer_load_dwordx4 v42, s[44:47], s60 offen sc1 lds
s_add_u32 s69, s69, 262144
s_cmp_eq_u32 s69, s68
s_cselect_b32 s69, s67, s69
s_add_u32 m0, s59, 147456
s_add_u32 s60, s63, 0
buffer_load_dwordx4 v41, s[48:51], s60 offen lds
s_add_u32 m0, s59, 149504
s_add_u32 s60, s63, 16384
buffer_load_dwordx4 v41, s[48:51], s60 offen lds
s_add_u32 m0, s59, 151552
s_add_u32 s60, s63, 32768
buffer_load_dwordx4 v41, s[48:51], s60 offen lds
s_add_u32 m0, s59, 153600
s_add_u32 s60, s63, 49152
buffer_load_dwordx4 v41, s[48:51], s60 offen lds
s_add_u32 s63, s63, 65536
s_cmp_eq_u32 s63, 1835008
s_cselect_b32 s63, 0, s63
s_waitcnt vmcnt(12)
s_barrier
s_add_u32 m0, s59, 155648
s_add_u32 s60, s63, 0
buffer_load_dwordx4 v41, s[48:51], s60 offen lds
s_add_u32 m0, s59, 157696
s_add_u32 s60, s63, 16384
buffer_load_dwordx4 v41, s[48:51], s60 offen lds
s_add_u32 m0, s59, 159744
s_add_u32 s60, s63, 32768
buffer_load_dwordx4 v41, s[48:51], s60 offen lds
s_add_u32 m0, s59, 161792
s_add_u32 s60, s63, 49152
buffer_load_dwordx4 v41, s[48:51], s60 offen lds
s_add_u32 s63, s63, 65536
s_cmp_eq_u32 s63, 1835008
s_cselect_b32 s63, 0, s63
s_waitcnt vmcnt(12)
s_barrier
s_add_u32 m0, s59, 0
s_add_u32 s60, s69, 0
buffer_load_dwordx4 v42, s[44:47], s60 offen sc1 lds
s_add_u32 m0, s59, 2048
s_add_u32 s60, s69, 2048
buffer_load_dwordx4 v42, s[44:47], s60 offen sc1 lds
s_add_u32 m0, s59, 4096
s_add_u32 s60, s69, 131072
buffer_load_dwordx4 v42, s[44:47], s60 offen sc1 lds
s_add_u32 m0, s59, 6144
s_add_u32 s60, s69, 133120
buffer_load_dwordx4 v42, s[44:47], s60 offen sc1 lds
s_add_u32 s69, s69, 262144
s_cmp_eq_u32 s69, s68
s_cselect_b32 s69, s67, s69
s_add_u32 m0, s59, 114688
s_add_u32 s60, s69, 0
buffer_load_dwordx4 v42, s[44:47], s60 offen sc1 lds
s_add_u32 m0, s59, 116736
s_add_u32 s60, s69, 2048
buffer_load_dwordx4 v42, s[44:47], s60 offen sc1 lds
s_add_u32 m0, s59, 118784
s_add_u32 s60, s69, 131072
buffer_load_dwordx4 v42, s[44:47], s60 offen sc1 lds
s_add_u32 m0, s59, 120832
s_add_u32 s60, s69, 133120
buffer_load_dwordx4 v42, s[44:47], s60 offen sc1 lds
s_add_u32 s69, s69, 262144
s_cmp_eq_u32 s69, s68
s_cselect_b32 s69, s67, s69
s_waitcnt vmcnt(16)
s_barrier
s_add_u32 m0, s59, 8192
s_add_u32 s60, s69, 0
buffer_load_dwordx4 v42, s[44:47], s60 offen sc1 lds
s_add_u32 m0, s59, 10240
s_add_u32 s60, s69, 2048
buffer_load_dwordx4 v42, s[44:47], s60 offen sc1 lds
s_add_u32 m0, s59, 12288
s_add_u32 s60, s69, 131072
buffer_load_dwordx4 v42, s[44:47], s60 offen sc1 lds
s_add_u32 m0, s59, 14336
s_add_u32 s60, s69, 133120
buffer_load_dwordx4 v42, s[44:47], s60 offen sc1 lds
s_add_u32 s69, s69, 262144
s_cmp_eq_u32 s69, s68
s_cselect_b32 s69, s67, s69
s_add_u32 m0, s59, 122880
s_add_u32 s60, s69, 0
buffer_load_dwordx4 v42, s[44:47], s60 offen sc1 lds
s_add_u32 m0, s59, 124928
s_add_u32 s60, s69, 2048
buffer_load_dwordx4 v42, s[44:47], s60 offen sc1 lds
s_add_u32 m0, s59, 126976
s_add_u32 s60, s69, 131072
buffer_load_dwordx4 v42, s[44:47], s60 offen sc1 lds
s_add_u32 m0, s59, 129024
s_add_u32 s60, s69, 133120
buffer_load_dwordx4 v42, s[44:47], s60 offen sc1 lds
s_add_u32 s69, s69, 262144
s_cmp_eq_u32 s69, s68
s_cselect_b32 s69, s67, s69
s_waitcnt vmcnt(12)
s_barrier
s_add_u32 m0, s59, 16384
s_add_u32 s60, s69, 0
buffer_load_dwordx4 v42, s[44:47], s60 offen sc1 lds
s_add_u32 m0, s59, 18432
s_add_u32 s60, s69, 2048
buffer_load_dwordx4 v42, s[44:47], s60 offen sc1 lds
s_add_u32 m0, s59, 20480
s_add_u32 s60, s69, 131072
buffer_load_dwordx4 v42, s[44:47], s60 offen sc1 lds
s_add_u32 m0, s59, 22528
s_add_u32 s60, s69, 133120
buffer_load_dwordx4 v42, s[44:47], s60 offen sc1 lds
s_add_u32 s69, s69, 262144
s_cmp_eq_u32 s69, s68
s_cselect_b32 s69, s67, s69
s_add_u32 m0, s59, 131072
s_add_u32 s60, s69, 0
buffer_load_dwordx4 v42, s[44:47], s60 offen sc1 lds
s_add_u32 m0, s59, 133120
s_add_u32 s60, s69, 2048
buffer_load_dwordx4 v42, s[44:47], s60 offen sc1 lds
s_add_u32 m0, s59, 135168
s_add_u32 s60, s69, 131072
buffer_load_dwordx4 v42, s[44:47], s60 offen sc1 lds
s_add_u32 m0, s59, 137216
s_add_u32 s60, s69, 133120
buffer_load_dwordx4 v42, s[44:47], s60 offen sc1 lds
s_add_u32 s69, s69, 262144
s_cmp_eq_u32 s69, s68
s_cselect_b32 s69, s67, s69
s_waitcnt vmcnt(16)
s_barrier
s_add_u32 m0, s59, 24576
s_add_u32 s60, s69, 0
buffer_load_dwordx4 v42, s[44:47], s60 offen sc1 lds
s_add_u32 m0, s59, 26624
s_add_u32 s60, s69, 2048
buffer_load_dwordx4 v42, s[44:47], s60 offen sc1 lds
s_add_u32 m0, s59, 28672
s_add_u32 s60, s69, 131072
buffer_load_dwordx4 v42, s[44:47], s60 offen sc1 lds
s_add_u32 m0, s59, 30720
s_add_u32 s60, s69, 133120
buffer_load_dwordx4 v42, s[44:47], s60 offen sc1 lds
s_add_u32 s69, s69, 262144
s_cmp_eq_u32 s69, s68
s_cselect_b32 s69, s67, s69
s_waitcnt vmcnt(16)
s_barrier
s_add_u32 m0, s59, 139264
s_add_u32 s60, s69, 0
buffer_load_dwordx4 v42, s[44:47], s60 offen sc1 lds
s_add_u32 m0, s59, 141312
s_add_u32 s60, s69, 2048
buffer_load_dwordx4 v42, s[44:47], s60 offen sc1 lds
s_add_u32 m0, s59, 143360
s_add_u32 s60, s69, 131072
buffer_load_dwordx4 v42, s[44:47], s60 offen sc1 lds
s_add_u32 m0, s59, 145408
s_add_u32 s60, s69, 133120
buffer_load_dwordx4 v42, s[44:47], s60 offen sc1 lds
s_add_u32 s69, s69, 262144
s_cmp_eq_u32 s69, s68
s_cselect_b32 s69, s67, s69
s_waitcnt vmcnt(16)
s_barrier
s_add_u32 m0, s59, 0
s_add_u32 s60, s69, 0
buffer_load_dwordx4 v42, s[44:47], s60 offen sc1 lds
s_add_u32 m0, s59, 2048
s_add_u32 s60, s69, 2048
buffer_load_dwordx4 v42, s[44:47], s60 offen sc1 lds
s_add_u32 m0, s59, 4096
s_add_u32 s60, s69, 131072
buffer_load_dwordx4 v42, s[44:47], s60 offen sc1 lds
s_add_u32 m0, s59, 6144
s_add_u32 s60, s69, 133120
buffer_load_dwordx4 v42, s[44:47], s60 offen sc1 lds
s_add_u32 s69, s69, 262144
s_cmp_eq_u32 s69, s68
s_cselect_b32 s69, s67, s69
s_waitcnt vmcnt(16)
s_barrier
s_add_u32 m0, s59, 49152
s_add_u32 s60, s69, 0
buffer_load_dwordx4 v42, s[44:47], s60 offen sc1 lds
s_add_u32 m0, s59, 51200
s_add_u32 s60, s69, 2048
buffer_load_dwordx4 v42, s[44:47], s60 offen sc1 lds
s_add_u32 m0, s59, 53248
s_add_u32 s60, s69, 131072
buffer_load_dwordx4 v42, s[44:47], s60 offen sc1 lds
s_add_u32 m0, s59, 55296
s_add_u32 s60, s69, 133120
buffer_load_dwordx4 v42, s[44:47], s60 offen sc1 lds
s_add_u32 s69, s69, 262144
s_cmp_eq_u32 s69, s68
s_cselect_b32 s69, s67, s69
s_add_u32 m0, s59, 114688
s_add_u32 s60, s63, 0
buffer_load_dwordx4 v41, s[48:51], s60 offen lds
s_add_u32 m0, s59, 116736
s_add_u32 s60, s63, 16384
buffer_load_dwordx4 v41, s[48:51], s60 offen lds
s_add_u32 m0, s59, 118784
s_add_u32 s60, s63, 32768
buffer_load_dwordx4 v41, s[48:51], s60 offen lds
s_add_u32 m0, s59, 120832
s_add_u32 s60, s63, 49152
buffer_load_dwordx4 v41, s[48:51], s60 offen lds
s_add_u32 s63, s63, 65536
s_cmp_eq_u32 s63, 1835008
s_cselect_b32 s63, 0, s63
s_waitcnt vmcnt(20)
s_barrier
s_add_u32 m0, s59, 57344
s_add_u32 s60, s69, 0
buffer_load_dwordx4 v42, s[44:47], s60 offen sc1 lds
s_add_u32 m0, s59, 59392
s_add_u32 s60, s69, 2048
buffer_load_dwordx4 v42, s[44:47], s60 offen sc1 lds
s_add_u32 m0, s59, 61440
s_add_u32 s60, s69, 131072
buffer_load_dwordx4 v42, s[44:47], s60 offen sc1 lds
s_add_u32 m0, s59, 63488
s_add_u32 s60, s69, 133120
buffer_load_dwordx4 v42, s[44:47], s60 offen sc1 lds
s_add_u32 s69, s69, 262144
s_cmp_eq_u32 s69, s68
s_cselect_b32 s69, s67, s69
s_add_u32 m0, s59, 8192
s_add_u32 s60, s63, 0
buffer_load_dwordx4 v41, s[48:51], s60 offen lds
s_add_u32 m0, s59, 10240
s_add_u32 s60, s63, 16384
buffer_load_dwordx4 v41, s[48:51], s60 offen lds
s_add_u32 m0, s59, 12288
s_add_u32 s60, s63, 32768
buffer_load_dwordx4 v41, s[48:51], s60 offen lds
s_add_u32 m0, s59, 14336
s_add_u32 s60, s63, 49152
buffer_load_dwordx4 v41, s[48:51], s60 offen lds
s_add_u32 s63, s63, 65536
s_cmp_eq_u32 s63, 1835008
s_cselect_b32 s63, 0, s63
s_waitcnt vmcnt(24)
s_barrier
s_add_u32 m0, s59, 65536
s_add_u32 s60, s69, 0
buffer_load_dwordx4 v42, s[44:47], s60 offen sc1 lds
s_add_u32 m0, s59, 67584
s_add_u32 s60, s69, 2048
buffer_load_dwordx4 v42, s[44:47], s60 offen sc1 lds
s_add_u32 m0, s59, 69632
s_add_u32 s60, s69, 131072
buffer_load_dwordx4 v42, s[44:47], s60 offen sc1 lds
s_add_u32 m0, s59, 71680
s_add_u32 s60, s69, 133120
buffer_load_dwordx4 v42, s[44:47], s60 offen sc1 lds
s_add_u32 s69, s69, 262144
s_cmp_eq_u32 s69, s68
s_cselect_b32 s69, s67, s69
s_add_u32 m0, s59, 122880
s_add_u32 s60, s63, 0
buffer_load_dwordx4 v41, s[48:51], s60 offen lds
s_add_u32 m0, s59, 124928
s_add_u32 s60, s63, 16384
buffer_load_dwordx4 v41, s[48:51], s60 offen lds
s_add_u32 m0, s59, 126976
s_add_u32 s60, s63, 32768
buffer_load_dwordx4 v41, s[48:51], s60 offen lds
s_add_u32 m0, s59, 129024
s_add_u32 s60, s63, 49152
buffer_load_dwordx4 v41, s[48:51], s60 offen lds
s_add_u32 s63, s63, 65536
s_cmp_eq_u32 s63, 1835008
s_cselect_b32 s63, 0, s63
s_waitcnt vmcnt(28)
s_barrier
s_add_u32 m0, s59, 73728
s_add_u32 s60, s69, 0
buffer_load_dwordx4 v42, s[44:47], s60 offen sc1 lds
s_add_u32 m0, s59, 75776
s_add_u32 s60, s69, 2048
buffer_load_dwordx4 v42, s[44:47], s60 offen sc1 lds
s_add_u32 m0, s59, 77824
s_add_u32 s60, s69, 131072
buffer_load_dwordx4 v42, s[44:47], s60 offen sc1 lds
s_add_u32 m0, s59, 79872
s_add_u32 s60, s69, 133120
buffer_load_dwordx4 v42, s[44:47], s60 offen sc1 lds
s_add_u32 s69, s69, 262144
s_cmp_eq_u32 s69, s68
s_cselect_b32 s69, s67, s69
s_add_u32 m0, s59, 16384
s_add_u32 s60, s63, 0
buffer_load_dwordx4 v41, s[48:51], s60 offen lds
s_add_u32 m0, s59, 18432
s_add_u32 s60, s63, 16384
buffer_load_dwordx4 v41, s[48:51], s60 offen lds
s_add_u32 m0, s59, 20480
s_add_u32 s60, s63, 32768
buffer_load_dwordx4 v41, s[48:51], s60 offen lds
s_add_u32 m0, s59, 22528
s_add_u32 s60, s63, 49152
buffer_load_dwordx4 v41, s[48:51], s60 offen lds
s_add_u32 s63, s63, 65536
s_cmp_eq_u32 s63, 1835008
s_cselect_b32 s63, 0, s63
s_waitcnt vmcnt(32)
s_barrier
s_add_u32 m0, s59, 81920
s_add_u32 s60, s69, 0
buffer_load_dwordx4 v42, s[44:47], s60 offen sc1 lds
s_add_u32 m0, s59, 83968
s_add_u32 s60, s69, 2048
buffer_load_dwordx4 v42, s[44:47], s60 offen sc1 lds
s_add_u32 m0, s59, 86016
s_add_u32 s60, s69, 131072
buffer_load_dwordx4 v42, s[44:47], s60 offen sc1 lds
s_add_u32 m0, s59, 88064
s_add_u32 s60, s69, 133120
buffer_load_dwordx4 v42, s[44:47], s60 offen sc1 lds
s_add_u32 s69, s69, 262144
s_cmp_eq_u32 s69, s68
s_cselect_b32 s69, s67, s69
s_add_u32 m0, s59, 131072
s_add_u32 s60, s63, 0
buffer_load_dwordx4 v41, s[48:51], s60 offen lds
s_add_u32 m0, s59, 133120
s_add_u32 s60, s63, 16384
buffer_load_dwordx4 v41, s[48:51], s60 offen lds
s_add_u32 m0, s59, 135168
s_add_u32 s60, s63, 32768
buffer_load_dwordx4 v41, s[48:51], s60 offen lds
s_add_u32 m0, s59, 137216
s_add_u32 s60, s63, 49152
buffer_load_dwordx4 v41, s[48:51], s60 offen lds
s_add_u32 s63, s63, 65536
s_cmp_eq_u32 s63, 1835008
s_cselect_b32 s63, 0, s63
s_waitcnt vmcnt(36)
s_barrier
s_add_u32 m0, s59, 90112
s_add_u32 s60, s69, 0
buffer_load_dwordx4 v42, s[44:47], s60 offen sc1 lds
s_add_u32 m0, s59, 92160
s_add_u32 s60, s69, 2048
buffer_load_dwordx4 v42, s[44:47], s60 offen sc1 lds
s_add_u32 m0, s59, 94208
s_add_u32 s60, s69, 131072
buffer_load_dwordx4 v42, s[44:47], s60 offen sc1 lds
s_add_u32 m0, s59, 96256
s_add_u32 s60, s69, 133120
buffer_load_dwordx4 v42, s[44:47], s60 offen sc1 lds
s_add_u32 s69, s69, 262144
s_cmp_eq_u32 s69, s68
s_cselect_b32 s69, s67, s69
s_add_u32 m0, s59, 24576
s_add_u32 s60, s63, 0
buffer_load_dwordx4 v41, s[48:51], s60 offen lds
s_add_u32 m0, s59, 26624
s_add_u32 s60, s63, 16384
buffer_load_dwordx4 v41, s[48:51], s60 offen lds
s_add_u32 m0, s59, 28672
s_add_u32 s60, s63, 32768
buffer_load_dwordx4 v41, s[48:51], s60 offen lds
s_add_u32 m0, s59, 30720
s_add_u32 s60, s63, 49152
buffer_load_dwordx4 v41, s[48:51], s60 offen lds
s_add_u32 s63, s63, 65536
s_cmp_eq_u32 s63, 1835008
s_cselect_b32 s63, 0, s63
s_waitcnt vmcnt(36)
s_barrier
s_add_u32 m0, s59, 98304
s_add_u32 s60, s69, 0
buffer_load_dwordx4 v42, s[44:47], s60 offen sc1 lds
s_add_u32 m0, s59, 100352
s_add_u32 s60, s69, 2048
buffer_load_dwordx4 v42, s[44:47], s60 offen sc1 lds
s_add_u32 m0, s59, 102400
s_add_u32 s60, s69, 131072
buffer_load_dwordx4 v42, s[44:47], s60 offen sc1 lds
s_add_u32 m0, s59, 104448
s_add_u32 s60, s69, 133120
buffer_load_dwordx4 v42, s[44:47], s60 offen sc1 lds
s_add_u32 s69, s69, 262144
s_cmp_eq_u32 s69, s68
s_cselect_b32 s69, s67, s69
s_add_u32 m0, s59, 139264
s_add_u32 s60, s63, 0
buffer_load_dwordx4 v41, s[48:51], s60 offen lds
s_add_u32 m0, s59, 141312
s_add_u32 s60, s63, 16384
buffer_load_dwordx4 v41, s[48:51], s60 offen lds
s_add_u32 m0, s59, 143360
s_add_u32 s60, s63, 32768
buffer_load_dwordx4 v41, s[48:51], s60 offen lds
s_add_u32 m0, s59, 145408
s_add_u32 s60, s63, 49152
buffer_load_dwordx4 v41, s[48:51], s60 offen lds
s_add_u32 s63, s63, 65536
s_cmp_eq_u32 s63, 1835008
s_cselect_b32 s63, 0, s63
s_waitcnt vmcnt(36)
s_barrier
s_add_u32 m0, s59, 106496
s_add_u32 s60, s69, 0
buffer_load_dwordx4 v42, s[44:47], s60 offen sc1 lds
s_add_u32 m0, s59, 108544
s_add_u32 s60, s69, 2048
buffer_load_dwordx4 v42, s[44:47], s60 offen sc1 lds
s_add_u32 m0, s59, 110592
s_add_u32 s60, s69, 131072
buffer_load_dwordx4 v42, s[44:47], s60 offen sc1 lds
s_add_u32 m0, s59, 112640
s_add_u32 s60, s69, 133120
buffer_load_dwordx4 v42, s[44:47], s60 offen sc1 lds
s_add_u32 s69, s69, 262144
s_cmp_eq_u32 s69, s68
s_cselect_b32 s69, s67, s69
s_add_u32 m0, s59, 0
s_add_u32 s60, s63, 0
buffer_load_dwordx4 v41, s[48:51], s60 offen lds
s_add_u32 m0, s59, 2048
s_add_u32 s60, s63, 16384
buffer_load_dwordx4 v41, s[48:51], s60 offen lds
s_add_u32 m0, s59, 4096
s_add_u32 s60, s63, 32768
buffer_load_dwordx4 v41, s[48:51], s60 offen lds
s_add_u32 m0, s59, 6144
s_add_u32 s60, s63, 49152
buffer_load_dwordx4 v41, s[48:51], s60 offen lds
s_add_u32 s63, s63, 65536
s_cmp_eq_u32 s63, 1835008
s_cselect_b32 s63, 0, s63
s_waitcnt vmcnt(36)
s_barrier
s_add_u32 m0, s59, 32768
s_add_u32 s60, s69, 0
buffer_load_dwordx4 v42, s[44:47], s60 offen sc1 lds
s_add_u32 m0, s59, 34816
s_add_u32 s60, s69, 2048
buffer_load_dwordx4 v42, s[44:47], s60 offen sc1 lds
s_add_u32 m0, s59, 36864
s_add_u32 s60, s69, 131072
buffer_load_dwordx4 v42, s[44:47], s60 offen sc1 lds
s_add_u32 m0, s59, 38912
s_add_u32 s60, s69, 133120
buffer_load_dwordx4 v42, s[44:47], s60 offen sc1 lds
s_add_u32 s69, s69, 262144
s_cmp_eq_u32 s69, s68
s_cselect_b32 s69, s67, s69
s_add_u32 m0, s59, 49152
s_add_u32 s60, s63, 0
buffer_load_dwordx4 v41, s[48:51], s60 offen lds
s_add_u32 m0, s59, 51200
s_add_u32 s60, s63, 16384
buffer_load_dwordx4 v41, s[48:51], s60 offen lds
s_add_u32 m0, s59, 53248
s_add_u32 s60, s63, 32768
buffer_load_dwordx4 v41, s[48:51], s60 offen lds
s_add_u32 m0, s59, 55296
s_add_u32 s60, s63, 49152
buffer_load_dwordx4 v41, s[48:51], s60 offen lds
s_add_u32 s63, s63, 65536
s_cmp_eq_u32 s63, 1835008
s_cselect_b32 s63, 0, s63
s_waitcnt vmcnt(36)
s_barrier
s_add_u32 m0, s59, 40960
s_add_u32 s60, s69, 0
buffer_load_dwordx4 v42, s[44:47], s60 offen sc1 lds
s_add_u32 m0, s59, 43008
s_add_u32 s60, s69, 2048
buffer_load_dwordx4 v42, s[44:47], s60 offen sc1 lds
s_add_u32 m0, s59, 45056
s_add_u32 s60, s69, 131072
buffer_load_dwordx4 v42, s[44:47], s60 offen sc1 lds
s_add_u32 m0, s59, 47104
s_add_u32 s60, s69, 133120
buffer_load_dwordx4 v42, s[44:47], s60 offen sc1 lds
s_add_u32 s69, s69, 262144
s_cmp_eq_u32 s69, s68
s_cselect_b32 s69, s67, s69
s_add_u32 m0, s59, 57344
s_add_u32 s60, s63, 0
buffer_load_dwordx4 v41, s[48:51], s60 offen lds
s_add_u32 m0, s59, 59392
s_add_u32 s60, s63, 16384
buffer_load_dwordx4 v41, s[48:51], s60 offen lds
s_add_u32 m0, s59, 61440
s_add_u32 s60, s63, 32768
buffer_load_dwordx4 v41, s[48:51], s60 offen lds
s_add_u32 m0, s59, 63488
s_add_u32 s60, s63, 49152
buffer_load_dwordx4 v41, s[48:51], s60 offen lds
s_add_u32 s63, s63, 65536
s_cmp_eq_u32 s63, 1835008
s_cselect_b32 s63, 0, s63
s_waitcnt vmcnt(36)
s_barrier
s_add_u32 m0, s59, 147456
s_add_u32 s60, s69, 0
buffer_load_dwordx4 v42, s[44:47], s60 offen sc1 lds
s_add_u32 m0, s59, 149504
s_add_u32 s60, s69, 2048
buffer_load_dwordx4 v42, s[44:47], s60 offen sc1 lds
s_add_u32 m0, s59, 151552
s_add_u32 s60, s69, 131072
buffer_load_dwordx4 v42, s[44:47], s60 offen sc1 lds
s_add_u32 m0, s59, 153600
s_add_u32 s60, s69, 133120
buffer_load_dwordx4 v42, s[44:47], s60 offen sc1 lds
s_add_u32 s69, s69, 262144
s_cmp_eq_u32 s69, s68
s_cselect_b32 s69, s67, s69
s_add_u32 m0, s59, 65536
s_add_u32 s60, s63, 0
buffer_load_dwordx4 v41, s[48:51], s60 offen lds
s_add_u32 m0, s59, 67584
s_add_u32 s60, s63, 16384
buffer_load_dwordx4 v41, s[48:51], s60 offen lds
s_add_u32 m0, s59, 69632
s_add_u32 s60, s63, 32768
buffer_load_dwordx4 v41, s[48:51], s60 offen lds
s_add_u32 m0, s59, 71680
s_add_u32 s60, s63, 49152
buffer_load_dwordx4 v41, s[48:51], s60 offen lds
s_add_u32 s63, s63, 65536
s_cmp_eq_u32 s63, 1835008
s_cselect_b32 s63, 0, s63
s_waitcnt vmcnt(36)
s_barrier
s_add_u32 m0, s59, 155648
s_add_u32 s60, s69, 0
buffer_load_dwordx4 v42, s[44:47], s60 offen sc1 lds
s_add_u32 m0, s59, 157696
s_add_u32 s60, s69, 2048
buffer_load_dwordx4 v42, s[44:47], s60 offen sc1 lds
s_add_u32 m0, s59, 159744
s_add_u32 s60, s69, 131072
buffer_load_dwordx4 v42, s[44:47], s60 offen sc1 lds
s_add_u32 m0, s59, 161792
s_add_u32 s60, s69, 133120
buffer_load_dwordx4 v42, s[44:47], s60 offen sc1 lds
s_add_u32 s69, s69, 262144
s_cmp_eq_u32 s69, s68
s_cselect_b32 s69, s67, s69
s_add_u32 m0, s59, 73728
s_add_u32 s60, s63, 0
buffer_load_dwordx4 v41, s[48:51], s60 offen lds
s_add_u32 m0, s59, 75776
s_add_u32 s60, s63, 16384
buffer_load_dwordx4 v41, s[48:51], s60 offen lds
s_add_u32 m0, s59, 77824
s_add_u32 s60, s63, 32768
buffer_load_dwordx4 v41, s[48:51], s60 offen lds
s_add_u32 m0, s59, 79872
s_add_u32 s60, s63, 49152
buffer_load_dwordx4 v41, s[48:51], s60 offen lds
s_add_u32 s63, s63, 65536
s_cmp_eq_u32 s63, 1835008
s_cselect_b32 s63, 0, s63
s_waitcnt vmcnt(36)
s_barrier
s_add_u32 m0, s59, 114688
s_add_u32 s60, s69, 0
buffer_load_dwordx4 v42, s[44:47], s60 offen sc1 lds
s_add_u32 m0, s59, 116736
s_add_u32 s60, s69, 2048
buffer_load_dwordx4 v42, s[44:47], s60 offen sc1 lds
s_add_u32 m0, s59, 118784
s_add_u32 s60, s69, 131072
buffer_load_dwordx4 v42, s[44:47], s60 offen sc1 lds
s_add_u32 m0, s59, 120832
s_add_u32 s60, s69, 133120
buffer_load_dwordx4 v42, s[44:47], s60 offen sc1 lds
s_add_u32 s69, s69, 262144
s_cmp_eq_u32 s69, s68
s_cselect_b32 s69, s67, s69
s_lshl_b32 s63, s58, 16
s_add_u32 m0, s59, 81920
s_add_u32 s60, s63, 0
buffer_load_dwordx4 v41, s[52:55], s60 offen lds
s_add_u32 m0, s59, 83968
s_add_u32 s60, s63, 16384
buffer_load_dwordx4 v41, s[52:55], s60 offen lds
s_add_u32 m0, s59, 86016
s_add_u32 s60, s63, 32768
buffer_load_dwordx4 v41, s[52:55], s60 offen lds
s_add_u32 m0, s59, 88064
s_add_u32 s60, s63, 49152
buffer_load_dwordx4 v41, s[52:55], s60 offen lds
s_add_u32 s63, s63, 65536
s_and_b32 s63, s63, 524287
s_waitcnt vmcnt(36)
s_barrier
s_add_u32 m0, s59, 8192
s_add_u32 s60, s69, 0
buffer_load_dwordx4 v42, s[44:47], s60 offen sc1 lds
s_add_u32 m0, s59, 10240
s_add_u32 s60, s69, 2048
buffer_load_dwordx4 v42, s[44:47], s60 offen sc1 lds
s_add_u32 m0, s59, 12288
s_add_u32 s60, s69, 131072
buffer_load_dwordx4 v42, s[44:47], s60 offen sc1 lds
s_add_u32 m0, s59, 14336
s_add_u32 s60, s69, 133120
buffer_load_dwordx4 v42, s[44:47], s60 offen sc1 lds
s_add_u32 s69, s69, 262144
s_cmp_eq_u32 s69, s68
s_cselect_b32 s69, s67, s69
s_add_u32 m0, s59, 90112
s_add_u32 s60, s63, 0
buffer_load_dwordx4 v41, s[52:55], s60 offen lds
s_add_u32 m0, s59, 92160
s_add_u32 s60, s63, 16384
buffer_load_dwordx4 v41, s[52:55], s60 offen lds
s_add_u32 m0, s59, 94208
s_add_u32 s60, s63, 32768
buffer_load_dwordx4 v41, s[52:55], s60 offen lds
s_add_u32 m0, s59, 96256
s_add_u32 s60, s63, 49152
buffer_load_dwordx4 v41, s[52:55], s60 offen lds
s_add_u32 s63, s63, 65536
s_and_b32 s63, s63, 524287
s_waitcnt vmcnt(36)
s_barrier
s_add_u32 m0, s59, 122880
s_add_u32 s60, s69, 0
buffer_load_dwordx4 v42, s[44:47], s60 offen sc1 lds
s_add_u32 m0, s59, 124928
s_add_u32 s60, s69, 2048
buffer_load_dwordx4 v42, s[44:47], s60 offen sc1 lds
s_add_u32 m0, s59, 126976
s_add_u32 s60, s69, 131072
buffer_load_dwordx4 v42, s[44:47], s60 offen sc1 lds
s_add_u32 m0, s59, 129024
s_add_u32 s60, s69, 133120
buffer_load_dwordx4 v42, s[44:47], s60 offen sc1 lds
s_add_u32 s69, s69, 262144
s_cmp_eq_u32 s69, s68
s_cselect_b32 s69, s67, s69
s_add_u32 m0, s59, 98304
s_add_u32 s60, s63, 0
buffer_load_dwordx4 v41, s[52:55], s60 offen lds
s_add_u32 m0, s59, 100352
s_add_u32 s60, s63, 16384
buffer_load_dwordx4 v41, s[52:55], s60 offen lds
s_add_u32 m0, s59, 102400
s_add_u32 s60, s63, 32768
buffer_load_dwordx4 v41, s[52:55], s60 offen lds
s_add_u32 m0, s59, 104448
s_add_u32 s60, s63, 49152
buffer_load_dwordx4 v41, s[52:55], s60 offen lds
s_add_u32 s63, s63, 65536
s_and_b32 s63, s63, 524287
s_waitcnt vmcnt(36)
s_barrier
s_mov_b32 s67, s68
s_mul_i32 s60, s58, 262144
s_add_u32 s69, s68, s60
s_add_u32 s68, s68, 2097152
s_add_u32 m0, s59, 16384
s_add_u32 s60, s69, 0
buffer_load_dwordx4 v42, s[44:47], s60 offen sc1 lds
s_add_u32 m0, s59, 18432
s_add_u32 s60, s69, 2048
buffer_load_dwordx4 v42, s[44:47], s60 offen sc1 lds
s_add_u32 m0, s59, 20480
s_add_u32 s60, s69, 131072
buffer_load_dwordx4 v42, s[44:47], s60 offen sc1 lds
s_add_u32 m0, s59, 22528
s_add_u32 s60, s69, 133120
buffer_load_dwordx4 v42, s[44:47], s60 offen sc1 lds
s_add_u32 s69, s69, 262144
s_cmp_eq_u32 s69, s68
s_cselect_b32 s69, s67, s69
s_add_u32 m0, s59, 106496
s_add_u32 s60, s63, 0
buffer_load_dwordx4 v41, s[52:55], s60 offen lds
s_add_u32 m0, s59, 108544
s_add_u32 s60, s63, 16384
buffer_load_dwordx4 v41, s[52:55], s60 offen lds
s_add_u32 m0, s59, 110592
s_add_u32 s60, s63, 32768
buffer_load_dwordx4 v41, s[52:55], s60 offen lds
s_add_u32 m0, s59, 112640
s_add_u32 s60, s63, 49152
buffer_load_dwordx4 v41, s[52:55], s60 offen lds
s_add_u32 s63, s63, 65536
s_and_b32 s63, s63, 524287
s_waitcnt vmcnt(36)
s_barrier
s_add_u32 m0, s59, 131072
s_add_u32 s60, s69, 0
buffer_load_dwordx4 v42, s[44:47], s60 offen sc1 lds
s_add_u32 m0, s59, 133120
s_add_u32 s60, s69, 2048
buffer_load_dwordx4 v42, s[44:47], s60 offen sc1 lds
s_add_u32 m0, s59, 135168
s_add_u32 s60, s69, 131072
buffer_load_dwordx4 v42, s[44:47], s60 offen sc1 lds
s_add_u32 m0, s59, 137216
s_add_u32 s60, s69, 133120
buffer_load_dwordx4 v42, s[44:47], s60 offen sc1 lds
s_add_u32 s69, s69, 262144
s_cmp_eq_u32 s69, s68
s_cselect_b32 s69, s67, s69
s_add_u32 m0, s59, 32768
s_add_u32 s60, s63, 0
buffer_load_dwordx4 v41, s[52:55], s60 offen lds
s_add_u32 m0, s59, 34816
s_add_u32 s60, s63, 16384
buffer_load_dwordx4 v41, s[52:55], s60 offen lds
s_add_u32 m0, s59, 36864
s_add_u32 s60, s63, 32768
buffer_load_dwordx4 v41, s[52:55], s60 offen lds
s_add_u32 m0, s59, 38912
s_add_u32 s60, s63, 49152
buffer_load_dwordx4 v41, s[52:55], s60 offen lds
s_add_u32 s63, s63, 65536
s_and_b32 s63, s63, 524287
s_waitcnt vmcnt(36)
s_barrier
s_add_u32 m0, s59, 24576
s_add_u32 s60, s69, 0
buffer_load_dwordx4 v42, s[44:47], s60 offen sc1 lds
s_add_u32 m0, s59, 26624
s_add_u32 s60, s69, 2048
buffer_load_dwordx4 v42, s[44:47], s60 offen sc1 lds
s_add_u32 m0, s59, 28672
s_add_u32 s60, s69, 131072
buffer_load_dwordx4 v42, s[44:47], s60 offen sc1 lds
s_add_u32 m0, s59, 30720
s_add_u32 s60, s69, 133120
buffer_load_dwordx4 v42, s[44:47], s60 offen sc1 lds
s_add_u32 s69, s69, 262144
s_cmp_eq_u32 s69, s68
s_cselect_b32 s69, s67, s69
s_add_u32 m0, s59, 40960
s_add_u32 s60, s63, 0
buffer_load_dwordx4 v41, s[52:55], s60 offen lds
s_add_u32 m0, s59, 43008
s_add_u32 s60, s63, 16384
buffer_load_dwordx4 v41, s[52:55], s60 offen lds
s_add_u32 m0, s59, 45056
s_add_u32 s60, s63, 32768
buffer_load_dwordx4 v41, s[52:55], s60 offen lds
s_add_u32 m0, s59, 47104
s_add_u32 s60, s63, 49152
buffer_load_dwordx4 v41, s[52:55], s60 offen lds
s_add_u32 s63, s63, 65536
s_and_b32 s63, s63, 524287
s_waitcnt vmcnt(36)
s_barrier
s_add_u32 m0, s59, 139264
s_add_u32 s60, s69, 0
buffer_load_dwordx4 v42, s[44:47], s60 offen sc1 lds
s_add_u32 m0, s59, 141312
s_add_u32 s60, s69, 2048
buffer_load_dwordx4 v42, s[44:47], s60 offen sc1 lds
s_add_u32 m0, s59, 143360
s_add_u32 s60, s69, 131072
buffer_load_dwordx4 v42, s[44:47], s60 offen sc1 lds
s_add_u32 m0, s59, 145408
s_add_u32 s60, s69, 133120
buffer_load_dwordx4 v42, s[44:47], s60 offen sc1 lds
s_add_u32 s69, s69, 262144
s_cmp_eq_u32 s69, s68
s_cselect_b32 s69, s67, s69
s_add_u32 m0, s59, 147456
s_add_u32 s60, s63, 0
buffer_load_dwordx4 v41, s[52:55], s60 offen lds
s_add_u32 m0, s59, 149504
s_add_u32 s60, s63, 16384
buffer_load_dwordx4 v41, s[52:55], s60 offen lds
s_add_u32 m0, s59, 151552
s_add_u32 s60, s63, 32768
buffer_load_dwordx4 v41, s[52:55], s60 offen lds
s_add_u32 m0, s59, 153600
s_add_u32 s60, s63, 49152
buffer_load_dwordx4 v41, s[52:55], s60 offen lds
s_add_u32 s63, s63, 65536
s_and_b32 s63, s63, 524287
s_waitcnt vmcnt(36)
s_barrier
s_add_u32 m0, s59, 0
s_add_u32 s60, s69, 0
buffer_load_dwordx4 v42, s[44:47], s60 offen sc1 lds
s_add_u32 m0, s59, 2048
s_add_u32 s60, s69, 2048
buffer_load_dwordx4 v42, s[44:47], s60 offen sc1 lds
s_add_u32 m0, s59, 4096
s_add_u32 s60, s69, 131072
buffer_load_dwordx4 v42, s[44:47], s60 offen sc1 lds
s_add_u32 m0, s59, 6144
s_add_u32 s60, s69, 133120
buffer_load_dwordx4 v42, s[44:47], s60 offen sc1 lds
s_add_u32 s69, s69, 262144
s_cmp_eq_u32 s69, s68
s_cselect_b32 s69, s67, s69
s_add_u32 m0, s59, 155648
s_add_u32 s60, s63, 0
buffer_load_dwordx4 v41, s[52:55], s60 offen lds
s_add_u32 m0, s59, 157696
s_add_u32 s60, s63, 16384
buffer_load_dwordx4 v41, s[52:55], s60 offen lds
s_add_u32 m0, s59, 159744
s_add_u32 s60, s63, 32768
buffer_load_dwordx4 v41, s[52:55], s60 offen lds
s_add_u32 m0, s59, 161792
s_add_u32 s60, s63, 49152
buffer_load_dwordx4 v41, s[52:55], s60 offen lds
s_add_u32 s63, s63, 65536
s_and_b32 s63, s63, 524287
s_waitcnt vmcnt(36)
s_barrier
s_add_u32 m0, s59, 49152
s_add_u32 s60, s69, 0
buffer_load_dwordx4 v42, s[44:47], s60 offen sc1 lds
s_add_u32 m0, s59, 51200
s_add_u32 s60, s69, 2048
buffer_load_dwordx4 v42, s[44:47], s60 offen sc1 lds
s_add_u32 m0, s59, 53248
s_add_u32 s60, s69, 131072
buffer_load_dwordx4 v42, s[44:47], s60 offen sc1 lds
s_add_u32 m0, s59, 55296
s_add_u32 s60, s69, 133120
buffer_load_dwordx4 v42, s[44:47], s60 offen sc1 lds
s_add_u32 s69, s69, 262144
s_cmp_eq_u32 s69, s68
s_cselect_b32 s69, s67, s69
s_waitcnt vmcnt(32)
s_barrier
s_add_u32 m0, s59, 114688
s_add_u32 s60, s69, 0
buffer_load_dwordx4 v42, s[44:47], s60 offen sc1 lds
s_add_u32 m0, s59, 116736
s_add_u32 s60, s69, 2048
buffer_load_dwordx4 v42, s[44:47], s60 offen sc1 lds
s_add_u32 m0, s59, 118784
s_add_u32 s60, s69, 131072
buffer_load_dwordx4 v42, s[44:47], s60 offen sc1 lds
s_add_u32 m0, s59, 120832
s_add_u32 s60, s69, 133120
buffer_load_dwordx4 v42, s[44:47], s60 offen sc1 lds
s_add_u32 s69, s69, 262144
s_cmp_eq_u32 s69, s68
s_cselect_b32 s69, s67, s69
s_waitcnt vmcnt(28)
s_barrier
s_add_u32 m0, s59, 57344
s_add_u32 s60, s69, 0
buffer_load_dwordx4 v42, s[44:47], s60 offen sc1 lds
s_add_u32 m0, s59, 59392
s_add_u32 s60, s69, 2048
buffer_load_dwordx4 v42, s[44:47], s60 offen sc1 lds
s_add_u32 m0, s59, 61440
s_add_u32 s60, s69, 131072
buffer_load_dwordx4 v42, s[44:47], s60 offen sc1 lds
s_add_u32 m0, s59, 63488
s_add_u32 s60, s69, 133120
buffer_load_dwordx4 v42, s[44:47], s60 offen sc1 lds
s_add_u32 s69, s69, 262144
s_cmp_eq_u32 s69, s68
s_cselect_b32 s69, s67, s69
s_waitcnt vmcnt(24)
s_barrier
s_waitcnt vmcnt(16)
s_barrier
s_waitcnt vmcnt(8)
s_barrier
s_waitcnt vmcnt(4)
s_barrier
s_waitcnt vmcnt(0)
s_barrier
s_branch k2_fin
k_ldb:
s_add_u32 m0, s71, 2048
s_add_u32 s77, s74, 0
buffer_load_dwordx4 v4, s[36:39], s77 offen lds
s_add_u32 m0, s71, 10240
s_add_u32 s77, s74, 114688
buffer_load_dwordx4 v4, s[36:39], s77 offen lds
s_add_u32 s73, s73, 128
s_add_u32 s74, s74, 229376
s_and_b32 s73, s73, 1023
s_cselect_b32 s74, s74, s72
s_add_u32 s40, s6, s64
s_addc_u32 s41, s7, 0
s_and_b32 s41, s41, 0xffff
s_sub_u32 s42, 1572864, s64
s_mov_b32 s43, 0x00020000
s_lshl_b32 s76, s26, 5
s_lshl_b32 s78, s31, 2
s_add_u32 s78, s78, s76
s_mul_i32 s68, s78, 3584
s_mul_i32 s69, s78, 3072
s_mul_i32 s70, s76, 3584
s_lshl_b32 s66, s31, 10
s_add_u32 m0, s71, 65536
s_add_u32 s77, s73, 0
buffer_load_dwordx4 v2, s[32:35], s77 offen lds
s_add_u32 m0, s71, 73728
s_add_u32 s77, s73, 65536
buffer_load_dwordx4 v2, s[32:35], s77 offen lds
s_add_u32 m0, s71, 66560
s_add_u32 s77, s73, 8192
buffer_load_dwordx4 v2, s[32:35], s77 offen lds
s_add_u32 m0, s71, 74752
s_add_u32 s77, s73, 73728
buffer_load_dwordx4 v2, s[32:35], s77 offen lds
s_add_u32 m0, s71, 67584
s_add_u32 s77, s73, 16384
buffer_load_dwordx4 v2, s[32:35], s77 offen lds
s_add_u32 m0, s71, 75776
s_add_u32 s77, s73, 81920
buffer_load_dwordx4 v2, s[32:35], s77 offen lds
s_add_u32 m0, s71, 68608
s_add_u32 s77, s73, 24576
buffer_load_dwordx4 v2, s[32:35], s77 offen lds
s_add_u32 m0, s71, 76800
s_add_u32 s77, s73, 90112
buffer_load_dwordx4 v2, s[32:35], s77 offen lds
s_add_u32 m0, s71, 16384
s_add_u32 s77, s74, 0
buffer_load_dwordx4 v3, s[36:39], s77 offen lds
s_add_u32 m0, s71, 24576
s_add_u32 s77, s74, 114688
buffer_load_dwordx4 v3, s[36:39], s77 offen lds
s_add_u32 m0, s71, 17408
s_add_u32 s77, s74, 14336
buffer_load_dwordx4 v3, s[36:39], s77 offen lds
s_add_u32 m0, s71, 25600
s_add_u32 s77, s74, 129024
buffer_load_dwordx4 v3, s[36:39], s77 offen lds
s_add_u32 m0, s71, 18432
s_add_u32 s77, s74, 0
buffer_load_dwordx4 v4, s[36:39], s77 offen lds
s_add_u32 m0, s71, 26624
s_add_u32 s77, s74, 114688
buffer_load_dwordx4 v4, s[36:39], s77 offen lds
s_add_u32 s73, s73, 128
s_add_u32 s74, s74, 229376
s_and_b32 s73, s73, 1023
s_cselect_b32 s74, s74, s72
s_add_u32 m0, s66, 131072
s_add_u32 s77, s68, 0
buffer_load_dwordx4 v3, s[36:39], s77 offen lds
s_add_u32 m0, s66, 139264
s_add_u32 s77, s68, 57344
buffer_load_dwordx4 v3, s[36:39], s77 offen lds
s_add_u32 m0, s66, 133120
s_add_u32 s77, s70, 0
buffer_load_dwordx4 v4, s[36:39], s77 offen lds
s_add_u32 m0, s66, 141312
s_add_u32 s77, s70, 57344
buffer_load_dwordx4 v4, s[36:39], s77 offen lds
s_add_u32 m0, s66, 135168
s_add_u32 s77, s69, 1024
buffer_load_dwordx4 v39, s[40:43], s77 offen lds
s_add_u32 m0, s66, 143360
s_add_u32 s77, s69, 50176
buffer_load_dwordx4 v39, s[40:43], s77 offen lds
s_add_u32 m0, s66, 137216
s_add_u32 s77, s69, 2048
buffer_load_dwordx4 v39, s[40:43], s77 offen lds
s_add_u32 m0, s66, 145408
s_add_u32 s77, s69, 51200
buffer_load_dwordx4 v39, s[40:43], s77 offen lds
s_waitcnt vmcnt(22)
s_barrier
s_add_u32 m0, s71, 81920
s_add_u32 s77, s73, 0
buffer_load_dwordx4 v2, s[32:35], s77 offen lds
s_add_u32 m0, s71, 90112
s_add_u32 s77, s73, 65536
buffer_load_dwordx4 v2, s[32:35], s77 offen lds
s_add_u32 m0, s71, 82944
s_add_u32 s77, s73, 8192
buffer_load_dwordx4 v2, s[32:35], s77 offen lds
s_add_u32 m0, s71, 91136
s_add_u32 s77, s73, 73728
buffer_load_dwordx4 v2, s[32:35], s77 offen lds
s_add_u32 m0, s71, 83968
s_add_u32 s77, s73, 16384
buffer_load_dwordx4 v2, s[32:35], s77 offen lds
s_add_u32 m0, s71, 92160
s_add_u32 s77, s73, 81920
buffer_load_dwordx4 v2, s[32:35], s77 offen lds
s_add_u32 m0, s71, 84992
s_add_u32 s77, s73, 24576
buffer_load_dwordx4 v2, s[32:35], s77 offen lds
s_add_u32 m0, s71, 93184
s_add_u32 s77, s73, 90112
buffer_load_dwordx4 v2, s[32:35], s77 offen lds
s_add_u32 m0, s71, 32768
s_add_u32 s77, s74, 0
buffer_load_dwordx4 v3, s[36:39], s77 offen lds
s_add_u32 m0, s71, 40960
s_add_u32 s77, s74, 114688
buffer_load_dwordx4 v3, s[36:39], s77 offen lds
s_add_u32 m0, s71, 33792
s_add_u32 s77, s74, 14336
buffer_load_dwordx4 v3, s[36:39], s77 offen lds
s_add_u32 m0, s71, 41984
s_add_u32 s77, s74, 129024
buffer_load_dwordx4 v3, s[36:39], s77 offen lds
s_add_u32 m0, s71, 34816
s_add_u32 s77, s74, 0
buffer_load_dwordx4 v4, s[36:39], s77 offen lds
s_add_u32 m0, s71, 43008
s_add_u32 s77, s74, 114688
buffer_load_dwordx4 v4, s[36:39], s77 offen lds
s_add_u32 s73, s73, 128
s_add_u32 s74, s74, 229376
s_and_b32 s73, s73, 1023
s_cselect_b32 s74, s74, s72
s_waitcnt vmcnt(14)
s_barrier
s_add_u32 m0, s71, 98304
s_add_u32 s77, s73, 0
buffer_load_dwordx4 v2, s[32:35], s77 offen lds
s_add_u32 m0, s71, 106496
s_add_u32 s77, s73, 65536
buffer_load_dwordx4 v2, s[32:35], s77 offen lds
s_add_u32 m0, s71, 99328
s_add_u32 s77, s73, 8192
buffer_load_dwordx4 v2, s[32:35], s77 offen lds
s_add_u32 m0, s71, 107520
s_add_u32 s77, s73, 73728
buffer_load_dwordx4 v2, s[32:35], s77 offen lds
s_add_u32 m0, s71, 100352
s_add_u32 s77, s73, 16384
buffer_load_dwordx4 v2, s[32:35], s77 offen lds
s_add_u32 m0, s71, 108544
s_add_u32 s77, s73, 81920
buffer_load_dwordx4 v2, s[32:35], s77 offen lds
s_add_u32 m0, s71, 101376
s_add_u32 s77, s73, 24576
buffer_load_dwordx4 v2, s[32:35], s77 offen lds
s_add_u32 m0, s71, 109568
s_add_u32 s77, s73, 90112
buffer_load_dwordx4 v2, s[32:35], s77 offen lds
s_add_u32 m0, s71, 0
s_add_u32 s77, s74, 0
buffer_load_dwordx4 v3, s[36:39], s77 offen lds
s_add_u32 m0, s71, 8192
s_add_u32 s77, s74, 114688
buffer_load_dwordx4 v3, s[36:39], s77 offen lds
s_add_u32 m0, s71, 1024
s_add_u32 s77, s74, 14336
buffer_load_dwordx4 v3, s[36:39], s77 offen lds
s_add_u32 m0, s71, 9216
s_add_u32 s77, s74, 129024
buffer_load_dwordx4 v3, s[36:39], s77 offen lds
s_add_u32 m0, s71, 2048
s_add_u32 s77, s74, 0
buffer_load_dwordx4 v4, s[36:39], s77 offen lds
s_add_u32 m0, s71, 10240
s_add_u32 s77, s74, 114688
buffer_load_dwordx4 v4, s[36:39], s77 offen lds
s_add_u32 s73, s73, 128
s_add_u32 s74, s74, 229376
s_and_b32 s73, s73, 1023
s_cselect_b32 s74, s74, s72
s_waitcnt vmcnt(14)
s_barrier
s_add_u32 m0, s71, 114688
s_add_u32 s77, s73, 0
buffer_load_dwordx4 v2, s[32:35], s77 offen lds
s_add_u32 m0, s71, 122880
s_add_u32 s77, s73, 65536
buffer_load_dwordx4 v2, s[32:35], s77 offen lds
s_add_u32 m0, s71, 115712
s_add_u32 s77, s73, 8192
buffer_load_dwordx4 v2, s[32:35], s77 offen lds
s_add_u32 m0, s71, 123904
s_add_u32 s77, s73, 73728
buffer_load_dwordx4 v2, s[32:35], s77 offen lds
s_add_u32 m0, s71, 116736
s_add_u32 s77, s73, 16384
buffer_load_dwordx4 v2, s[32:35], s77 offen lds
s_add_u32 m0, s71, 124928
s_add_u32 s77, s73, 81920
buffer_load_dwordx4 v2, s[32:35], s77 offen lds
s_add_u32 m0, s71, 117760
s_add_u32 s77, s73, 24576
buffer_load_dwordx4 v2, s[32:35], s77 offen lds
s_add_u32 m0, s71, 125952
s_add_u32 s77, s73, 90112
buffer_load_dwordx4 v2, s[32:35], s77 offen lds
s_add_u32 m0, s71, 16384
s_add_u32 s77, s74, 0
buffer_load_dwordx4 v3, s[36:39], s77 offen lds
s_add_u32 m0, s71, 24576
s_add_u32 s77, s74, 114688
buffer_load_dwordx4 v3, s[36:39], s77 offen lds
s_add_u32 m0, s71, 17408
s_add_u32 s77, s74, 14336
buffer_load_dwordx4 v3, s[36:39], s77 offen lds
s_add_u32 m0, s71, 25600
s_add_u32 s77, s74, 129024
buffer_load_dwordx4 v3, s[36:39], s77 offen lds
s_add_u32 m0, s71, 18432
s_add_u32 s77, s74, 0
buffer_load_dwordx4 v4, s[36:39], s77 offen lds
s_add_u32 m0, s71, 26624
s_add_u32 s77, s74, 114688
buffer_load_dwordx4 v4, s[36:39], s77 offen lds
s_add_u32 s73, s73, 128
s_add_u32 s74, s74, 229376
s_and_b32 s73, s73, 1023
s_cselect_b32 s74, s74, s72
s_waitcnt vmcnt(14)
s_barrier
s_add_u32 m0, s71, 131072
s_add_u32 s77, s73, 0
buffer_load_dwordx4 v2, s[32:35], s77 offen lds
s_add_u32 m0, s71, 139264
s_add_u32 s77, s73, 65536
buffer_load_dwordx4 v2, s[32:35], s77 offen lds
s_add_u32 m0, s71, 132096
s_add_u32 s77, s73, 8192
buffer_load_dwordx4 v2, s[32:35], s77 offen lds
s_add_u32 m0, s71, 140288
s_add_u32 s77, s73, 73728
buffer_load_dwordx4 v2, s[32:35], s77 offen lds
s_add_u32 m0, s71, 133120
s_add_u32 s77, s73, 16384
buffer_load_dwordx4 v2, s[32:35], s77 offen lds
s_add_u32 m0, s71, 141312
s_add_u32 s77, s73, 81920
buffer_load_dwordx4 v2, s[32:35], s77 offen lds
s_add_u32 m0, s71, 134144
s_add_u32 s77, s73, 24576
buffer_load_dwordx4 v2, s[32:35], s77 offen lds
s_add_u32 m0, s71, 142336
s_add_u32 s77, s73, 90112
buffer_load_dwordx4 v2, s[32:35], s77 offen lds
s_add_u32 m0, s71, 32768
s_add_u32 s77, s74, 0
buffer_load_dwordx4 v3, s[36:39], s77 offen lds
s_add_u32 m0, s71, 40960
s_add_u32 s77, s74, 114688
buffer_load_dwordx4 v3, s[36:39], s77 offen lds
s_add_u32 m0, s71, 33792
s_add_u32 s77, s74, 14336
buffer_load_dwordx4 v3, s[36:39], s77 offen lds
s_add_u32 m0, s71, 41984
s_add_u32 s77, s74, 129024
buffer_load_dwordx4 v3, s[36:39], s77 offen lds
s_add_u32 m0, s71, 34816
s_add_u32 s77, s74, 0
buffer_load_dwordx4 v4, s[36:39], s77 offen lds
s_add_u32 m0, s71, 43008
s_add_u32 s77, s74, 114688
buffer_load_dwordx4 v4, s[36:39], s77 offen lds
s_add_u32 s73, s73, 128
s_add_u32 s74, s74, 229376
s_and_b32 s73, s73, 1023
s_cselect_b32 s74, s74, s72
s_waitcnt vmcnt(14)
s_barrier
s_add_u32 m0, s71, 49152
s_add_u32 s77, s73, 0
buffer_load_dwordx4 v2, s[32:35], s77 offen lds
s_add_u32 m0, s71, 57344
s_add_u32 s77, s73, 65536
buffer_load_dwordx4 v2, s[32:35], s77 offen lds
s_add_u32 m0, s71, 50176
s_add_u32 s77, s73, 8192
buffer_load_dwordx4 v2, s[32:35], s77 offen lds
s_add_u32 m0, s71, 58368
s_add_u32 s77, s73, 73728
buffer_load_dwordx4 v2, s[32:35], s77 offen lds
s_add_u32 m0, s71, 51200
s_add_u32 s77, s73, 16384
buffer_load_dwordx4 v2, s[32:35], s77 offen lds
s_add_u32 m0, s71, 59392
s_add_u32 s77, s73, 81920
buffer_load_dwordx4 v2, s[32:35], s77 offen lds
s_add_u32 m0, s71, 52224
s_add_u32 s77, s73, 24576
buffer_load_dwordx4 v2, s[32:35], s77 offen lds
s_add_u32 m0, s71, 60416
s_add_u32 s77, s73, 90112
buffer_load_dwordx4 v2, s[32:35], s77 offen lds
s_add_u32 m0, s71, 0
s_add_u32 s77, s74, 0
buffer_load_dwordx4 v3, s[36:39], s77 offen lds
s_add_u32 m0, s71, 8192
s_add_u32 s77, s74, 114688
buffer_load_dwordx4 v3, s[36:39], s77 offen lds
s_add_u32 m0, s71, 1024
s_add_u32 s77, s74, 14336
buffer_load_dwordx4 v3, s[36:39], s77 offen lds
s_add_u32 m0, s71, 9216
s_add_u32 s77, s74, 129024
buffer_load_dwordx4 v3, s[36:39], s77 offen lds
s_add_u32 m0, s71, 2048
s_add_u32 s77, s74, 0
buffer_load_dwordx4 v4, s[36:39], s77 offen lds
s_add_u32 m0, s71, 10240
s_add_u32 s77, s74, 114688
buffer_load_dwordx4 v4, s[36:39], s77 offen lds
s_add_u32 s73, s73, 128
s_add_u32 s74, s74, 229376
s_and_b32 s73, s73, 1023
s_cselect_b32 s74, s74, s72
s_waitcnt vmcnt(14)
s_barrier
s_add_u32 m0, s71, 65536
s_add_u32 s77, s73, 0
buffer_load_dwordx4 v2, s[32:35], s77 offen lds
s_add_u32 m0, s71, 73728
s_add_u32 s77, s73, 65536
buffer_load_dwordx4 v2, s[32:35], s77 offen lds
s_add_u32 m0, s71, 66560
s_add_u32 s77, s73, 8192
buffer_load_dwordx4 v2, s[32:35], s77 offen lds
s_add_u32 m0, s71, 74752
s_add_u32 s77, s73, 73728
buffer_load_dwordx4 v2, s[32:35], s77 offen lds
s_add_u32 m0, s71, 67584
s_add_u32 s77, s73, 16384
buffer_load_dwordx4 v2, s[32:35], s77 offen lds
s_add_u32 m0, s71, 75776
s_add_u32 s77, s73, 81920
buffer_load_dwordx4 v2, s[32:35], s77 offen lds
s_add_u32 m0, s71, 68608
s_add_u32 s77, s73, 24576
buffer_load_dwordx4 v2, s[32:35], s77 offen lds
s_add_u32 m0, s71, 76800
s_add_u32 s77, s73, 90112
buffer_load_dwordx4 v2, s[32:35], s77 offen lds
s_add_u32 m0, s71, 16384
s_add_u32 s77, s74, 0
buffer_load_dwordx4 v3, s[36:39], s77 offen lds
s_add_u32 m0, s71, 24576
s_add_u32 s77, s74, 114688
buffer_load_dwordx4 v3, s[36:39], s77 offen lds
s_add_u32 m0, s71, 17408
s_add_u32 s77, s74, 14336
buffer_load_dwordx4 v3, s[36:39], s77 offen lds
s_add_u32 m0, s71, 25600
s_add_u32 s77, s74, 129024
buffer_load_dwordx4 v3, s[36:39], s77 offen lds
s_add_u32 m0, s71, 18432
s_add_u32 s77, s74, 0
buffer_load_dwordx4 v4, s[36:39], s77 offen lds
s_add_u32 m0, s71, 26624
s_add_u32 s77, s74, 114688
buffer_load_dwordx4 v4, s[36:39], s77 offen lds
s_add_u32 s73, s73, 128
s_add_u32 s74, s74, 229376
s_and_b32 s73, s73, 1023
s_cselect_b32 s74, s74, s72
s_waitcnt vmcnt(14)
s_barrier
s_add_u32 s75, s57, 2
s_and_b32 s75, s75, 7
s_mul_i32 s72, s31, 49152
s_mul_i32 s74, s75, 196608
s_add_u32 s74, s74, s72
s_add_u32 s75, s72, 8*196608
s_lshr_b32 s30, s71, 1
s_add_u32 m0, s71, 32768
s_add_u32 s77, s74, 1024
buffer_load_dwordx4 v39, s[40:43], s77 offen lds
s_add_u32 m0, s71, 40960
s_add_u32 s77, s74, 99328
buffer_load_dwordx4 v39, s[40:43], s77 offen lds
s_add_u32 m0, s71, 33792
s_add_u32 s77, s74, 13312
buffer_load_dwordx4 v39, s[40:43], s77 offen lds
s_add_u32 m0, s71, 41984
s_add_u32 s77, s74, 111616
buffer_load_dwordx4 v39, s[40:43], s77 offen lds
s_add_u32 m0, s71, 34816
s_add_u32 s77, s74, 2048
buffer_load_dwordx4 v39, s[40:43], s77 offen lds
s_add_u32 m0, s71, 43008
s_add_u32 s77, s74, 100352
buffer_load_dwordx4 v39, s[40:43], s77 offen lds
s_add_u32 m0, s71, 35840
s_add_u32 s77, s74, 14336
buffer_load_dwordx4 v39, s[40:43], s77 offen lds
s_add_u32 m0, s71, 44032
s_add_u32 s77, s74, 112640
buffer_load_dwordx4 v39, s[40:43], s77 offen lds
s_add_u32 s74, s74, 196608
s_cmp_eq_u32 s74, s75
s_cselect_b32 s74, s72, s74
s_waitcnt vmcnt(8)
s_barrier
s_add_u32 m0, s71, 0
s_add_u32 s77, s74, 1024
buffer_load_dwordx4 v39, s[40:43], s77 offen lds
s_add_u32 m0, s71, 8192
s_add_u32 s77, s74, 99328
buffer_load_dwordx4 v39, s[40:43], s77 offen lds
s_add_u32 m0, s71, 1024
s_add_u32 s77, s74, 13312
buffer_load_dwordx4 v39, s[40:43], s77 offen lds
s_add_u32 m0, s71, 9216
s_add_u32 s77, s74, 111616
buffer_load_dwordx4 v39, s[40:43], s77 offen lds
s_add_u32 m0, s71, 2048
s_add_u32 s77, s74, 2048
buffer_load_dwordx4 v39, s[40:43], s77 offen lds
s_add_u32 m0, s71, 10240
s_add_u32 s77, s74, 100352
buffer_load_dwordx4 v39, s[40:43], s77 offen lds
s_add_u32 m0, s71, 3072
s_add_u32 s77, s74, 14336
buffer_load_dwordx4 v39, s[40:43], s77 offen lds
s_add_u32 m0, s71, 11264
s_add_u32 s77, s74, 112640
buffer_load_dwordx4 v39, s[40:43], s77 offen lds
s_add_u32 s74, s74, 196608
s_cmp_eq_u32 s74, s75
s_cselect_b32 s74, s72, s74
s_waitcnt vmcnt(8)
s_barrier
s_add_u32 m0, s71, 16384
s_add_u32 s77, s74, 1024
buffer_load_dwordx4 v39, s[40:43], s77 offen lds
s_add_u32 m0, s71, 24576
s_add_u32 s77, s74, 99328
buffer_load_dwordx4 v39, s[40:43], s77 offen lds
s_add_u32 m0, s71, 17408
s_add_u32 s77, s74, 13312
buffer_load_dwordx4 v39, s[40:43], s77 offen lds
s_add_u32 m0, s71, 25600
s_add_u32 s77, s74, 111616
buffer_load_dwordx4 v39, s[40:43], s77 offen lds
s_add_u32 m0, s71, 18432
s_add_u32 s77, s74, 2048
buffer_load_dwordx4 v39, s[40:43], s77 offen lds
s_add_u32 m0, s71, 26624
s_add_u32 s77, s74, 100352
buffer_load_dwordx4 v39, s[40:43], s77 offen lds
s_add_u32 m0, s71, 19456
s_add_u32 s77, s74, 14336
buffer_load_dwordx4 v39, s[40:43], s77 offen lds
s_add_u32 m0, s71, 27648
s_add_u32 s77, s74, 112640
buffer_load_dwordx4 v39, s[40:43], s77 offen lds
s_add_u32 s74, s74, 196608
s_cmp_eq_u32 s74, s75
s_cselect_b32 s74, s72, s74
s_waitcnt vmcnt(8)
s_barrier
s_add_u32 m0, s71, 32768
s_add_u32 s77, s74, 1024
buffer_load_dwordx4 v39, s[40:43], s77 offen lds
s_add_u32 m0, s71, 40960
s_add_u32 s77, s74, 99328
buffer_load_dwordx4 v39, s[40:43], s77 offen lds
s_add_u32 m0, s71, 33792
s_add_u32 s77, s74, 13312
buffer_load_dwordx4 v39, s[40:43], s77 offen lds
s_add_u32 m0, s71, 41984
s_add_u32 s77, s74, 111616
buffer_load_dwordx4 v39, s[40:43], s77 offen lds
s_add_u32 m0, s71, 34816
s_add_u32 s77, s74, 2048
buffer_load_dwordx4 v39, s[40:43], s77 offen lds
s_add_u32 m0, s71, 43008
s_add_u32 s77, s74, 100352
buffer_load_dwordx4 v39, s[40:43], s77 offen lds
s_add_u32 m0, s71, 35840
s_add_u32 s77, s74, 14336
buffer_load_dwordx4 v39, s[40:43], s77 offen lds
s_add_u32 m0, s71, 44032
s_add_u32 s77, s74, 112640
buffer_load_dwordx4 v39, s[40:43], s77 offen lds
s_add_u32 s74, s74, 196608
s_cmp_eq_u32 s74, s75
s_cselect_b32 s74, s72, s74
s_add_u32 m0, s71, 81920
s_add_u32 s77, s73, 0
buffer_load_dwordx4 v2, s[32:35], s77 offen lds
s_add_u32 m0, s71, 90112
s_add_u32 s77, s73, 65536
buffer_load_dwordx4 v2, s[32:35], s77 offen lds
s_add_u32 m0, s71, 82944
s_add_u32 s77, s73, 8192
buffer_load_dwordx4 v2, s[32:35], s77 offen lds
s_add_u32 m0, s71, 91136
s_add_u32 s77, s73, 73728
buffer_load_dwordx4 v2, s[32:35], s77 offen lds
s_add_u32 m0, s71, 83968
s_add_u32 s77, s73, 16384
buffer_load_dwordx4 v2, s[32:35], s77 offen lds
s_add_u32 m0, s71, 92160
s_add_u32 s77, s73, 81920
buffer_load_dwordx4 v2, s[32:35], s77 offen lds
s_add_u32 m0, s71, 84992
s_add_u32 s77, s73, 24576
buffer_load_dwordx4 v2, s[32:35], s77 offen lds
s_add_u32 m0, s71, 93184
s_add_u32 s77, s73, 90112
buffer_load_dwordx4 v2, s[32:35], s77 offen lds
s_add_u32 s73, s73, 128
s_and_b32 s73, s73, 1023
s_waitcnt vmcnt(16)
s_barrier
s_add_u32 m0, s71, 0
s_add_u32 s77, s74, 1024
buffer_load_dwordx4 v39, s[40:43], s77 offen lds
s_add_u32 m0, s71, 8192
s_add_u32 s77, s74, 99328
buffer_load_dwordx4 v39, s[40:43], s77 offen lds
s_add_u32 m0, s71, 1024
s_add_u32 s77, s74, 13312
buffer_load_dwordx4 v39, s[40:43], s77 offen lds
s_add_u32 m0, s71, 9216
s_add_u32 s77, s74, 111616
buffer_load_dwordx4 v39, s[40:43], s77 offen lds
s_add_u32 m0, s71, 2048
s_add_u32 s77, s74, 2048
buffer_load_dwordx4 v39, s[40:43], s77 offen lds
s_add_u32 m0, s71, 10240
s_add_u32 s77, s74, 100352
buffer_load_dwordx4 v39, s[40:43], s77 offen lds
s_add_u32 m0, s71, 3072
s_add_u32 s77, s74, 14336
buffer_load_dwordx4 v39, s[40:43], s77 offen lds
s_add_u32 m0, s71, 11264
s_add_u32 s77, s74, 112640
buffer_load_dwordx4 v39, s[40:43], s77 offen lds
s_add_u32 s74, s74, 196608
s_cmp_eq_u32 s74, s75
s_cselect_b32 s74, s72, s74
s_add_u32 m0, s71, 98304
s_add_u32 s77, s73, 0
buffer_load_dwordx4 v2, s[32:35], s77 offen lds
s_add_u32 m0, s71, 106496
s_add_u32 s77, s73, 65536
buffer_load_dwordx4 v2, s[32:35], s77 offen lds
s_add_u32 m0, s71, 99328
s_add_u32 s77, s73, 8192
buffer_load_dwordx4 v2, s[32:35], s77 offen lds
s_add_u32 m0, s71, 107520
s_add_u32 s77, s73, 73728
buffer_load_dwordx4 v2, s[32:35], s77 offen lds
s_add_u32 m0, s71, 100352
s_add_u32 s77, s73, 16384
buffer_load_dwordx4 v2, s[32:35], s77 offen lds
s_add_u32 m0, s71, 108544
s_add_u32 s77, s73, 81920
buffer_load_dwordx4 v2, s[32:35], s77 offen lds
s_add_u32 m0, s71, 101376
s_add_u32 s77, s73, 24576
buffer_load_dwordx4 v2, s[32:35], s77 offen lds
s_add_u32 m0, s71, 109568
s_add_u32 s77, s73, 90112
buffer_load_dwordx4 v2, s[32:35], s77 offen lds
s_add_u32 s73, s73, 128
s_and_b32 s73, s73, 1023
s_waitcnt vmcnt(24)
s_barrier
s_add_u32 m0, s71, 16384
s_add_u32 s77, s74, 1024
buffer_load_dwordx4 v39, s[40:43], s77 offen lds
s_add_u32 m0, s71, 24576
s_add_u32 s77, s74, 99328
buffer_load_dwordx4 v39, s[40:43], s77 offen lds
s_add_u32 m0, s71, 17408
s_add_u32 s77, s74, 13312
buffer_load_dwordx4 v39, s[40:43], s77 offen lds
s_add_u32 m0, s71, 25600
s_add_u32 s77, s74, 111616
buffer_load_dwordx4 v39, s[40:43], s77 offen lds
s_add_u32 m0, s71, 18432
s_add_u32 s77, s74, 2048
buffer_load_dwordx4 v39, s[40:43], s77 offen lds
s_add_u32 m0, s71, 26624
s_add_u32 s77, s74, 100352
buffer_load_dwordx4 v39, s[40:43], s77 offen lds
s_add_u32 m0, s71, 19456
s_add_u32 s77, s74, 14336
buffer_load_dwordx4 v39, s[40:43], s77 offen lds
s_add_u32 m0, s71, 27648
s_add_u32 s77, s74, 112640
buffer_load_dwordx4 v39, s[40:43], s77 offen lds
s_add_u32 s74, s74, 196608
s_cmp_eq_u32 s74, s75
s_cselect_b32 s74, s72, s74
s_waitcnt vmcnt(16)
s_barrier
s_add_u32 m0, s71, 32768
s_add_u32 s77, s74, 1024
buffer_load_dwordx4 v39, s[40:43], s77 offen lds
s_add_u32 m0, s71, 40960
s_add_u32 s77, s74, 99328
buffer_load_dwordx4 v39, s[40:43], s77 offen lds
s_add_u32 m0, s71, 33792
s_add_u32 s77, s74, 13312
buffer_load_dwordx4 v39, s[40:43], s77 offen lds
s_add_u32 m0, s71, 41984
s_add_u32 s77, s74, 111616
buffer_load_dwordx4 v39, s[40:43], s77 offen lds
s_add_u32 m0, s71, 34816
s_add_u32 s77, s74, 2048
buffer_load_dwordx4 v39, s[40:43], s77 offen lds
s_add_u32 m0, s71, 43008
s_add_u32 s77, s74, 100352
buffer_load_dwordx4 v39, s[40:43], s77 offen lds
s_add_u32 m0, s71, 35840
s_add_u32 s77, s74, 14336
buffer_load_dwordx4 v39, s[40:43], s77 offen lds
s_add_u32 m0, s71, 44032
s_add_u32 s77, s74, 112640
buffer_load_dwordx4 v39, s[40:43], s77 offen lds
s_add_u32 s74, s74, 196608
s_cmp_eq_u32 s74, s75
s_cselect_b32 s74, s72, s74
s_mov_b32 s44, s24
s_and_b32 s45, s25, 0xffff
s_mov_b32 s46, 16777216
s_mov_b32 s47, 0x00020000
s_and_b32 s60, s2, 7
s_lshl_b32 s60, s60, 2
s_lshr_b32 s61, s58, 3
s_add_u32 s66, s60, s61
s_and_b32 s58, s58, 7
s_lshl_b32 s65, s58, 7
s_add_u32 s48, s16, s65
s_addc_u32 s49, s17, 0
s_and_b32 s49, s49, 0xffff
s_sub_u32 s50, 1835008, s65
s_mov_b32 s51, 0x00020000
s_add_u32 s52, s8, s65
s_addc_u32 s53, s9, 0
s_and_b32 s53, s53, 0xffff
s_sub_u32 s54, 524288, s65
s_mov_b32 s55, 0x00020000
s_and_b32 s60, s66, 2
s_mul_i32 s60, s60, 7
s_mul_i32 s61, s58, 7
s_lshr_b32 s61, s61, 1
s_add_u32 s60, s60, s61
s_and_b32 s61, s2, 7
s_mul_i32 s61, s61, 7
s_lshr_b32 s61, s61, 2
s_add_u32 s60, s60, s61
s_cmp_ge_u32 s60, 28
s_cselect_b32 s61, 28, 0
s_sub_u32 s60, s60, s61
s_mul_i32 s64, s60, 262144
s_lshl_b32 s63, s60, 16
v_lshrrev_b32 v5, 3, v1
v_and_b32 v6, 7, v1
v_and_b32 v7, 6, v5
v_xor_b32 v7, v7, v6
v_lshlrev_b32 v41, 4, v7
v_lshl_add_u32 v41, v5, 10, v41
s_lshl_b32 s60, s31, 13
v_add_u32 v41, s60, v41
s_lshl_b32 s59, s31, 10
v_lshl_add_u32 v42, v1, 4, s59
s_add_u32 s63, s63, 917504
s_cmp_ge_u32 s63, 1835008
s_cselect_b32 s60, 1835008, 0
s_sub_u32 s63, s63, s60
s_mul_i32 s67, s66, 4096
s_add_u32 s68, s67, 7340032
s_add_u32 s69, s67, s64
v_mov_b32 v8, 150528
s_waitcnt vmcnt(8)
s_barrier
s_add_u32 m0, s71, 0
s_add_u32 s77, s74, 1024
buffer_load_dwordx4 v39, s[40:43], s77 offen lds
s_add_u32 m0, s71, 8192
s_add_u32 s77, s74, 99328
buffer_load_dwordx4 v39, s[40:43], s77 offen lds
s_add_u32 m0, s71, 1024
s_add_u32 s77, s74, 13312
buffer_load_dwordx4 v39, s[40:43], s77 offen lds
s_add_u32 m0, s71, 9216
s_add_u32 s77, s74, 111616
buffer_load_dwordx4 v39, s[40:43], s77 offen lds
s_add_u32 m0, s71, 2048
s_add_u32 s77, s74, 2048
buffer_load_dwordx4 v39, s[40:43], s77 offen lds
s_add_u32 m0, s71, 10240
s_add_u32 s77, s74, 100352
buffer_load_dwordx4 v39, s[40:43], s77 offen lds
s_add_u32 m0, s71, 3072
s_add_u32 s77, s74, 14336
buffer_load_dwordx4 v39, s[40:43], s77 offen lds
s_add_u32 m0, s71, 11264
s_add_u32 s77, s74, 112640
buffer_load_dwordx4 v39, s[40:43], s77 offen lds
s_add_u32 s74, s74, 196608
s_cmp_eq_u32 s74, s75
s_cselect_b32 s74, s72, s74
s_waitcnt vmcnt(8)
s_barrier
s_waitcnt vmcnt(0)
s_barrier
s_barrier
k_hf_wb:
s_sleep 1
ds_read_b32 v16, v8 offset:16
s_waitcnt lgkmcnt(0)
v_readfirstlane_b32 s61, v16
s_cmp_lt_u32 s61, 1
s_cbranch_scc1 k_hf_wb
s_add_u32 m0, s59, 0
s_add_u32 s60, s69, 0
buffer_load_dwordx4 v42, s[44:47], s60 offen sc1 lds
s_add_u32 m0, s59, 2048
s_add_u32 s60, s69, 2048
buffer_load_dwordx4 v42, s[44:47], s60 offen sc1 lds
s_add_u32 m0, s59, 4096
s_add_u32 s60, s69, 131072
buffer_load_dwordx4 v42, s[44:47], s60 offen sc1 lds
s_add_u32 m0, s59, 6144
s_add_u32 s60, s69, 133120
buffer_load_dwordx4 v42, s[44:47], s60 offen sc1 lds
s_add_u32 s69, s69, 262144
s_cmp_eq_u32 s69, s68
s_cselect_b32 s69, s67, s69
s_add_u32 m0, s59, 8192
s_add_u32 s60, s69, 0
buffer_load_dwordx4 v42, s[44:47], s60 offen sc1 lds
s_add_u32 m0, s59, 10240
s_add_u32 s60, s69, 2048
buffer_load_dwordx4 v42, s[44:47], s60 offen sc1 lds
s_add_u32 m0, s59, 12288
s_add_u32 s60, s69, 131072
buffer_load_dwordx4 v42, s[44:47], s60 offen sc1 lds
s_add_u32 m0, s59, 14336
s_add_u32 s60, s69, 133120
buffer_load_dwordx4 v42, s[44:47], s60 offen sc1 lds
s_add_u32 s69, s69, 262144
s_cmp_eq_u32 s69, s68
s_cselect_b32 s69, s67, s69
s_add_u32 m0, s59, 16384
s_add_u32 s60, s69, 0
buffer_load_dwordx4 v42, s[44:47], s60 offen sc1 lds
s_add_u32 m0, s59, 18432
s_add_u32 s60, s69, 2048
buffer_load_dwordx4 v42, s[44:47], s60 offen sc1 lds
s_add_u32 m0, s59, 20480
s_add_u32 s60, s69, 131072
buffer_load_dwordx4 v42, s[44:47], s60 offen sc1 lds
s_add_u32 m0, s59, 22528
s_add_u32 s60, s69, 133120
buffer_load_dwordx4 v42, s[44:47], s60 offen sc1 lds
s_add_u32 s69, s69, 262144
s_cmp_eq_u32 s69, s68
s_cselect_b32 s69, s67, s69
s_waitcnt vmcnt(8)
s_barrier
s_add_u32 m0, s59, 24576
s_add_u32 s60, s69, 0
buffer_load_dwordx4 v42, s[44:47], s60 offen sc1 lds
s_add_u32 m0, s59, 26624
s_add_u32 s60, s69, 2048
buffer_load_dwordx4 v42, s[44:47], s60 offen sc1 lds
s_add_u32 m0, s59, 28672
s_add_u32 s60, s69, 131072
buffer_load_dwordx4 v42, s[44:47], s60 offen sc1 lds
s_add_u32 m0, s59, 30720
s_add_u32 s60, s69, 133120
buffer_load_dwordx4 v42, s[44:47], s60 offen sc1 lds
s_add_u32 s69, s69, 262144
s_cmp_eq_u32 s69, s68
s_cselect_b32 s69, s67, s69
s_add_u32 m0, s59, 147456
s_add_u32 s60, s63, 0
buffer_load_dwordx4 v41, s[48:51], s60 offen lds
s_add_u32 m0, s59, 149504
s_add_u32 s60, s63, 16384
buffer_load_dwordx4 v41, s[48:51], s60 offen lds
s_add_u32 m0, s59, 151552
s_add_u32 s60, s63, 32768
buffer_load_dwordx4 v41, s[48:51], s60 offen lds
s_add_u32 m0, s59, 153600
s_add_u32 s60, s63, 49152
buffer_load_dwordx4 v41, s[48:51], s60 offen lds
s_add_u32 s63, s63, 65536
s_cmp_eq_u32 s63, 1835008
s_cselect_b32 s63, 0, s63
s_waitcnt vmcnt(12)
s_barrier
s_add_u32 m0, s59, 155648
s_add_u32 s60, s63, 0
buffer_load_dwordx4 v41, s[48:51], s60 offen lds
s_add_u32 m0, s59, 157696
s_add_u32 s60, s63, 16384
buffer_load_dwordx4 v41, s[48:51], s60 offen lds
s_add_u32 m0, s59, 159744
s_add_u32 s60, s63, 32768
buffer_load_dwordx4 v41, s[48:51], s60 offen lds
s_add_u32 m0, s59, 161792
s_add_u32 s60, s63, 49152
buffer_load_dwordx4 v41, s[48:51], s60 offen lds
s_add_u32 s63, s63, 65536
s_cmp_eq_u32 s63, 1835008
s_cselect_b32 s63, 0, s63
s_waitcnt vmcnt(12)
s_barrier
s_add_u32 m0, s59, 0
s_add_u32 s60, s69, 0
buffer_load_dwordx4 v42, s[44:47], s60 offen sc1 lds
s_add_u32 m0, s59, 2048
s_add_u32 s60, s69, 2048
buffer_load_dwordx4 v42, s[44:47], s60 offen sc1 lds
s_add_u32 m0, s59, 4096
s_add_u32 s60, s69, 131072
buffer_load_dwordx4 v42, s[44:47], s60 offen sc1 lds
s_add_u32 m0, s59, 6144
s_add_u32 s60, s69, 133120
buffer_load_dwordx4 v42, s[44:47], s60 offen sc1 lds
s_add_u32 s69, s69, 262144
s_cmp_eq_u32 s69, s68
s_cselect_b32 s69, s67, s69
s_add_u32 m0, s59, 114688
s_add_u32 s60, s69, 0
buffer_load_dwordx4 v42, s[44:47], s60 offen sc1 lds
s_add_u32 m0, s59, 116736
s_add_u32 s60, s69, 2048
buffer_load_dwordx4 v42, s[44:47], s60 offen sc1 lds
s_add_u32 m0, s59, 118784
s_add_u32 s60, s69, 131072
buffer_load_dwordx4 v42, s[44:47], s60 offen sc1 lds
s_add_u32 m0, s59, 120832
s_add_u32 s60, s69, 133120
buffer_load_dwordx4 v42, s[44:47], s60 offen sc1 lds
s_add_u32 s69, s69, 262144
s_cmp_eq_u32 s69, s68
s_cselect_b32 s69, s67, s69
s_waitcnt vmcnt(16)
s_barrier
s_add_u32 m0, s59, 8192
s_add_u32 s60, s69, 0
buffer_load_dwordx4 v42, s[44:47], s60 offen sc1 lds
s_add_u32 m0, s59, 10240
s_add_u32 s60, s69, 2048
buffer_load_dwordx4 v42, s[44:47], s60 offen sc1 lds
s_add_u32 m0, s59, 12288
s_add_u32 s60, s69, 131072
buffer_load_dwordx4 v42, s[44:47], s60 offen sc1 lds
s_add_u32 m0, s59, 14336
s_add_u32 s60, s69, 133120
buffer_load_dwordx4 v42, s[44:47], s60 offen sc1 lds
s_add_u32 s69, s69, 262144
s_cmp_eq_u32 s69, s68
s_cselect_b32 s69, s67, s69
s_add_u32 m0, s59, 122880
s_add_u32 s60, s69, 0
buffer_load_dwordx4 v42, s[44:47], s60 offen sc1 lds
s_add_u32 m0, s59, 124928
s_add_u32 s60, s69, 2048
buffer_load_dwordx4 v42, s[44:47], s60 offen sc1 lds
s_add_u32 m0, s59, 126976
s_add_u32 s60, s69, 131072
buffer_load_dwordx4 v42, s[44:47], s60 offen sc1 lds
s_add_u32 m0, s59, 129024
s_add_u32 s60, s69, 133120
buffer_load_dwordx4 v42, s[44:47], s60 offen sc1 lds
s_add_u32 s69, s69, 262144
s_cmp_eq_u32 s69, s68
s_cselect_b32 s69, s67, s69
s_waitcnt vmcnt(12)
s_barrier
s_add_u32 m0, s59, 16384
s_add_u32 s60, s69, 0
buffer_load_dwordx4 v42, s[44:47], s60 offen sc1 lds
s_add_u32 m0, s59, 18432
s_add_u32 s60, s69, 2048
buffer_load_dwordx4 v42, s[44:47], s60 offen sc1 lds
s_add_u32 m0, s59, 20480
s_add_u32 s60, s69, 131072
buffer_load_dwordx4 v42, s[44:47], s60 offen sc1 lds
s_add_u32 m0, s59, 22528
s_add_u32 s60, s69, 133120
buffer_load_dwordx4 v42, s[44:47], s60 offen sc1 lds
s_add_u32 s69, s69, 262144
s_cmp_eq_u32 s69, s68
s_cselect_b32 s69, s67, s69
s_add_u32 m0, s59, 131072
s_add_u32 s60, s69, 0
buffer_load_dwordx4 v42, s[44:47], s60 offen sc1 lds
s_add_u32 m0, s59, 133120
s_add_u32 s60, s69, 2048
buffer_load_dwordx4 v42, s[44:47], s60 offen sc1 lds
s_add_u32 m0, s59, 135168
s_add_u32 s60, s69, 131072
buffer_load_dwordx4 v42, s[44:47], s60 offen sc1 lds
s_add_u32 m0, s59, 137216
s_add_u32 s60, s69, 133120
buffer_load_dwordx4 v42, s[44:47], s60 offen sc1 lds
s_add_u32 s69, s69, 262144
s_cmp_eq_u32 s69, s68
s_cselect_b32 s69, s67, s69
s_waitcnt vmcnt(16)
s_barrier
s_add_u32 m0, s59, 24576
s_add_u32 s60, s69, 0
buffer_load_dwordx4 v42, s[44:47], s60 offen sc1 lds
s_add_u32 m0, s59, 26624
s_add_u32 s60, s69, 2048
buffer_load_dwordx4 v42, s[44:47], s60 offen sc1 lds
s_add_u32 m0, s59, 28672
s_add_u32 s60, s69, 131072
buffer_load_dwordx4 v42, s[44:47], s60 offen sc1 lds
s_add_u32 m0, s59, 30720
s_add_u32 s60, s69, 133120
buffer_load_dwordx4 v42, s[44:47], s60 offen sc1 lds
s_add_u32 s69, s69, 262144
s_cmp_eq_u32 s69, s68
s_cselect_b32 s69, s67, s69
s_waitcnt vmcnt(16)
s_barrier
s_add_u32 m0, s59, 139264
s_add_u32 s60, s69, 0
buffer_load_dwordx4 v42, s[44:47], s60 offen sc1 lds
s_add_u32 m0, s59, 141312
s_add_u32 s60, s69, 2048
buffer_load_dwordx4 v42, s[44:47], s60 offen sc1 lds
s_add_u32 m0, s59, 143360
s_add_u32 s60, s69, 131072
buffer_load_dwordx4 v42, s[44:47], s60 offen sc1 lds
s_add_u32 m0, s59, 145408
s_add_u32 s60, s69, 133120
buffer_load_dwordx4 v42, s[44:47], s60 offen sc1 lds
s_add_u32 s69, s69, 262144
s_cmp_eq_u32 s69, s68
s_cselect_b32 s69, s67, s69
s_waitcnt vmcnt(16)
s_barrier
s_add_u32 m0, s59, 0
s_add_u32 s60, s69, 0
buffer_load_dwordx4 v42, s[44:47], s60 offen sc1 lds
s_add_u32 m0, s59, 2048
s_add_u32 s60, s69, 2048
buffer_load_dwordx4 v42, s[44:47], s60 offen sc1 lds
s_add_u32 m0, s59, 4096
s_add_u32 s60, s69, 131072
buffer_load_dwordx4 v42, s[44:47], s60 offen sc1 lds
s_add_u32 m0, s59, 6144
s_add_u32 s60, s69, 133120
buffer_load_dwordx4 v42, s[44:47], s60 offen sc1 lds
s_add_u32 s69, s69, 262144
s_cmp_eq_u32 s69, s68
s_cselect_b32 s69, s67, s69
s_waitcnt vmcnt(16)
s_barrier
s_add_u32 m0, s59, 49152
s_add_u32 s60, s69, 0
buffer_load_dwordx4 v42, s[44:47], s60 offen sc1 lds
s_add_u32 m0, s59, 51200
s_add_u32 s60, s69, 2048
buffer_load_dwordx4 v42, s[44:47], s60 offen sc1 lds
s_add_u32 m0, s59, 53248
s_add_u32 s60, s69, 131072
buffer_load_dwordx4 v42, s[44:47], s60 offen sc1 lds
s_add_u32 m0, s59, 55296
s_add_u32 s60, s69, 133120
buffer_load_dwordx4 v42, s[44:47], s60 offen sc1 lds
s_add_u32 s69, s69, 262144
s_cmp_eq_u32 s69, s68
s_cselect_b32 s69, s67, s69
s_add_u32 m0, s59, 114688
s_add_u32 s60, s63, 0
buffer_load_dwordx4 v41, s[48:51], s60 offen lds
s_add_u32 m0, s59, 116736
s_add_u32 s60, s63, 16384
buffer_load_dwordx4 v41, s[48:51], s60 offen lds
s_add_u32 m0, s59, 118784
s_add_u32 s60, s63, 32768
buffer_load_dwordx4 v41, s[48:51], s60 offen lds
s_add_u32 m0, s59, 120832
s_add_u32 s60, s63, 49152
buffer_load_dwordx4 v41, s[48:51], s60 offen lds
s_add_u32 s63, s63, 65536
s_cmp_eq_u32 s63, 1835008
s_cselect_b32 s63, 0, s63
s_waitcnt vmcnt(20)
s_barrier
s_add_u32 m0, s59, 57344
s_add_u32 s60, s69, 0
buffer_load_dwordx4 v42, s[44:47], s60 offen sc1 lds
s_add_u32 m0, s59, 59392
s_add_u32 s60, s69, 2048
buffer_load_dwordx4 v42, s[44:47], s60 offen sc1 lds
s_add_u32 m0, s59, 61440
s_add_u32 s60, s69, 131072
buffer_load_dwordx4 v42, s[44:47], s60 offen sc1 lds
s_add_u32 m0, s59, 63488
s_add_u32 s60, s69, 133120
buffer_load_dwordx4 v42, s[44:47], s60 offen sc1 lds
s_add_u32 s69, s69, 262144
s_cmp_eq_u32 s69, s68
s_cselect_b32 s69, s67, s69
s_add_u32 m0, s59, 8192
s_add_u32 s60, s63, 0
buffer_load_dwordx4 v41, s[48:51], s60 offen lds
s_add_u32 m0, s59, 10240
s_add_u32 s60, s63, 16384
buffer_load_dwordx4 v41, s[48:51], s60 offen lds
s_add_u32 m0, s59, 12288
s_add_u32 s60, s63, 32768
buffer_load_dwordx4 v41, s[48:51], s60 offen lds
s_add_u32 m0, s59, 14336
s_add_u32 s60, s63, 49152
buffer_load_dwordx4 v41, s[48:51], s60 offen lds
s_add_u32 s63, s63, 65536
s_cmp_eq_u32 s63, 1835008
s_cselect_b32 s63, 0, s63
s_waitcnt vmcnt(24)
s_barrier
s_add_u32 m0, s59, 65536
s_add_u32 s60, s69, 0
buffer_load_dwordx4 v42, s[44:47], s60 offen sc1 lds
s_add_u32 m0, s59, 67584
s_add_u32 s60, s69, 2048
buffer_load_dwordx4 v42, s[44:47], s60 offen sc1 lds
s_add_u32 m0, s59, 69632
s_add_u32 s60, s69, 131072
buffer_load_dwordx4 v42, s[44:47], s60 offen sc1 lds
s_add_u32 m0, s59, 71680
s_add_u32 s60, s69, 133120
buffer_load_dwordx4 v42, s[44:47], s60 offen sc1 lds
s_add_u32 s69, s69, 262144
s_cmp_eq_u32 s69, s68
s_cselect_b32 s69, s67, s69
s_add_u32 m0, s59, 122880
s_add_u32 s60, s63, 0
buffer_load_dwordx4 v41, s[48:51], s60 offen lds
s_add_u32 m0, s59, 124928
s_add_u32 s60, s63, 16384
buffer_load_dwordx4 v41, s[48:51], s60 offen lds
s_add_u32 m0, s59, 126976
s_add_u32 s60, s63, 32768
buffer_load_dwordx4 v41, s[48:51], s60 offen lds
s_add_u32 m0, s59, 129024
s_add_u32 s60, s63, 49152
buffer_load_dwordx4 v41, s[48:51], s60 offen lds
s_add_u32 s63, s63, 65536
s_cmp_eq_u32 s63, 1835008
s_cselect_b32 s63, 0, s63
s_waitcnt vmcnt(28)
s_barrier
s_add_u32 m0, s59, 73728
s_add_u32 s60, s69, 0
buffer_load_dwordx4 v42, s[44:47], s60 offen sc1 lds
s_add_u32 m0, s59, 75776
s_add_u32 s60, s69, 2048
buffer_load_dwordx4 v42, s[44:47], s60 offen sc1 lds
s_add_u32 m0, s59, 77824
s_add_u32 s60, s69, 131072
buffer_load_dwordx4 v42, s[44:47], s60 offen sc1 lds
s_add_u32 m0, s59, 79872
s_add_u32 s60, s69, 133120
buffer_load_dwordx4 v42, s[44:47], s60 offen sc1 lds
s_add_u32 s69, s69, 262144
s_cmp_eq_u32 s69, s68
s_cselect_b32 s69, s67, s69
s_add_u32 m0, s59, 16384
s_add_u32 s60, s63, 0
buffer_load_dwordx4 v41, s[48:51], s60 offen lds
s_add_u32 m0, s59, 18432
s_add_u32 s60, s63, 16384
buffer_load_dwordx4 v41, s[48:51], s60 offen lds
s_add_u32 m0, s59, 20480
s_add_u32 s60, s63, 32768
buffer_load_dwordx4 v41, s[48:51], s60 offen lds
s_add_u32 m0, s59, 22528
s_add_u32 s60, s63, 49152
buffer_load_dwordx4 v41, s[48:51], s60 offen lds
s_add_u32 s63, s63, 65536
s_cmp_eq_u32 s63, 1835008
s_cselect_b32 s63, 0, s63
s_waitcnt vmcnt(32)
s_barrier
s_add_u32 m0, s59, 81920
s_add_u32 s60, s69, 0
buffer_load_dwordx4 v42, s[44:47], s60 offen sc1 lds
s_add_u32 m0, s59, 83968
s_add_u32 s60, s69, 2048
buffer_load_dwordx4 v42, s[44:47], s60 offen sc1 lds
s_add_u32 m0, s59, 86016
s_add_u32 s60, s69, 131072
buffer_load_dwordx4 v42, s[44:47], s60 offen sc1 lds
s_add_u32 m0, s59, 88064
s_add_u32 s60, s69, 133120
buffer_load_dwordx4 v42, s[44:47], s60 offen sc1 lds
s_add_u32 s69, s69, 262144
s_cmp_eq_u32 s69, s68
s_cselect_b32 s69, s67, s69
s_add_u32 m0, s59, 131072
s_add_u32 s60, s63, 0
buffer_load_dwordx4 v41, s[48:51], s60 offen lds
s_add_u32 m0, s59, 133120
s_add_u32 s60, s63, 16384
buffer_load_dwordx4 v41, s[48:51], s60 offen lds
s_add_u32 m0, s59, 135168
s_add_u32 s60, s63, 32768
buffer_load_dwordx4 v41, s[48:51], s60 offen lds
s_add_u32 m0, s59, 137216
s_add_u32 s60, s63, 49152
buffer_load_dwordx4 v41, s[48:51], s60 offen lds
s_add_u32 s63, s63, 65536
s_cmp_eq_u32 s63, 1835008
s_cselect_b32 s63, 0, s63
s_waitcnt vmcnt(36)
s_barrier
s_add_u32 m0, s59, 90112
s_add_u32 s60, s69, 0
buffer_load_dwordx4 v42, s[44:47], s60 offen sc1 lds
s_add_u32 m0, s59, 92160
s_add_u32 s60, s69, 2048
buffer_load_dwordx4 v42, s[44:47], s60 offen sc1 lds
s_add_u32 m0, s59, 94208
s_add_u32 s60, s69, 131072
buffer_load_dwordx4 v42, s[44:47], s60 offen sc1 lds
s_add_u32 m0, s59, 96256
s_add_u32 s60, s69, 133120
buffer_load_dwordx4 v42, s[44:47], s60 offen sc1 lds
s_add_u32 s69, s69, 262144
s_cmp_eq_u32 s69, s68
s_cselect_b32 s69, s67, s69
s_add_u32 m0, s59, 24576
s_add_u32 s60, s63, 0
buffer_load_dwordx4 v41, s[48:51], s60 offen lds
s_add_u32 m0, s59, 26624
s_add_u32 s60, s63, 16384
buffer_load_dwordx4 v41, s[48:51], s60 offen lds
s_add_u32 m0, s59, 28672
s_add_u32 s60, s63, 32768
buffer_load_dwordx4 v41, s[48:51], s60 offen lds
s_add_u32 m0, s59, 30720
s_add_u32 s60, s63, 49152
buffer_load_dwordx4 v41, s[48:51], s60 offen lds
s_add_u32 s63, s63, 65536
s_cmp_eq_u32 s63, 1835008
s_cselect_b32 s63, 0, s63
s_waitcnt vmcnt(36)
s_barrier
s_add_u32 m0, s59, 98304
s_add_u32 s60, s69, 0
buffer_load_dwordx4 v42, s[44:47], s60 offen sc1 lds
s_add_u32 m0, s59, 100352
s_add_u32 s60, s69, 2048
buffer_load_dwordx4 v42, s[44:47], s60 offen sc1 lds
s_add_u32 m0, s59, 102400
s_add_u32 s60, s69, 131072
buffer_load_dwordx4 v42, s[44:47], s60 offen sc1 lds
s_add_u32 m0, s59, 104448
s_add_u32 s60, s69, 133120
buffer_load_dwordx4 v42, s[44:47], s60 offen sc1 lds
s_add_u32 s69, s69, 262144
s_cmp_eq_u32 s69, s68
s_cselect_b32 s69, s67, s69
s_add_u32 m0, s59, 139264
s_add_u32 s60, s63, 0
buffer_load_dwordx4 v41, s[48:51], s60 offen lds
s_add_u32 m0, s59, 141312
s_add_u32 s60, s63, 16384
buffer_load_dwordx4 v41, s[48:51], s60 offen lds
s_add_u32 m0, s59, 143360
s_add_u32 s60, s63, 32768
buffer_load_dwordx4 v41, s[48:51], s60 offen lds
s_add_u32 m0, s59, 145408
s_add_u32 s60, s63, 49152
buffer_load_dwordx4 v41, s[48:51], s60 offen lds
s_add_u32 s63, s63, 65536
s_cmp_eq_u32 s63, 1835008
s_cselect_b32 s63, 0, s63
s_waitcnt vmcnt(36)
s_barrier
s_add_u32 m0, s59, 106496
s_add_u32 s60, s69, 0
buffer_load_dwordx4 v42, s[44:47], s60 offen sc1 lds
s_add_u32 m0, s59, 108544
s_add_u32 s60, s69, 2048
buffer_load_dwordx4 v42, s[44:47], s60 offen sc1 lds
s_add_u32 m0, s59, 110592
s_add_u32 s60, s69, 131072
buffer_load_dwordx4 v42, s[44:47], s60 offen sc1 lds
s_add_u32 m0, s59, 112640
s_add_u32 s60, s69, 133120
buffer_load_dwordx4 v42, s[44:47], s60 offen sc1 lds
s_add_u32 s69, s69, 262144
s_cmp_eq_u32 s69, s68
s_cselect_b32 s69, s67, s69
s_add_u32 m0, s59, 0
s_add_u32 s60, s63, 0
buffer_load_dwordx4 v41, s[48:51], s60 offen lds
s_add_u32 m0, s59, 2048
s_add_u32 s60, s63, 16384
buffer_load_dwordx4 v41, s[48:51], s60 offen lds
s_add_u32 m0, s59, 4096
s_add_u32 s60, s63, 32768
buffer_load_dwordx4 v41, s[48:51], s60 offen lds
s_add_u32 m0, s59, 6144
s_add_u32 s60, s63, 49152
buffer_load_dwordx4 v41, s[48:51], s60 offen lds
s_add_u32 s63, s63, 65536
s_cmp_eq_u32 s63, 1835008
s_cselect_b32 s63, 0, s63
s_waitcnt vmcnt(36)
s_barrier
s_add_u32 m0, s59, 32768
s_add_u32 s60, s69, 0
buffer_load_dwordx4 v42, s[44:47], s60 offen sc1 lds
s_add_u32 m0, s59, 34816
s_add_u32 s60, s69, 2048
buffer_load_dwordx4 v42, s[44:47], s60 offen sc1 lds
s_add_u32 m0, s59, 36864
s_add_u32 s60, s69, 131072
buffer_load_dwordx4 v42, s[44:47], s60 offen sc1 lds
s_add_u32 m0, s59, 38912
s_add_u32 s60, s69, 133120
buffer_load_dwordx4 v42, s[44:47], s60 offen sc1 lds
s_add_u32 s69, s69, 262144
s_cmp_eq_u32 s69, s68
s_cselect_b32 s69, s67, s69
s_add_u32 m0, s59, 49152
s_add_u32 s60, s63, 0
buffer_load_dwordx4 v41, s[48:51], s60 offen lds
s_add_u32 m0, s59, 51200
s_add_u32 s60, s63, 16384
buffer_load_dwordx4 v41, s[48:51], s60 offen lds
s_add_u32 m0, s59, 53248
s_add_u32 s60, s63, 32768
buffer_load_dwordx4 v41, s[48:51], s60 offen lds
s_add_u32 m0, s59, 55296
s_add_u32 s60, s63, 49152
buffer_load_dwordx4 v41, s[48:51], s60 offen lds
s_add_u32 s63, s63, 65536
s_cmp_eq_u32 s63, 1835008
s_cselect_b32 s63, 0, s63
s_waitcnt vmcnt(36)
s_barrier
s_add_u32 m0, s59, 40960
s_add_u32 s60, s69, 0
buffer_load_dwordx4 v42, s[44:47], s60 offen sc1 lds
s_add_u32 m0, s59, 43008
s_add_u32 s60, s69, 2048
buffer_load_dwordx4 v42, s[44:47], s60 offen sc1 lds
s_add_u32 m0, s59, 45056
s_add_u32 s60, s69, 131072
buffer_load_dwordx4 v42, s[44:47], s60 offen sc1 lds
s_add_u32 m0, s59, 47104
s_add_u32 s60, s69, 133120
buffer_load_dwordx4 v42, s[44:47], s60 offen sc1 lds
s_add_u32 s69, s69, 262144
s_cmp_eq_u32 s69, s68
s_cselect_b32 s69, s67, s69
s_add_u32 m0, s59, 57344
s_add_u32 s60, s63, 0
buffer_load_dwordx4 v41, s[48:51], s60 offen lds
s_add_u32 m0, s59, 59392
s_add_u32 s60, s63, 16384
buffer_load_dwordx4 v41, s[48:51], s60 offen lds
s_add_u32 m0, s59, 61440
s_add_u32 s60, s63, 32768
buffer_load_dwordx4 v41, s[48:51], s60 offen lds
s_add_u32 m0, s59, 63488
s_add_u32 s60, s63, 49152
buffer_load_dwordx4 v41, s[48:51], s60 offen lds
s_add_u32 s63, s63, 65536
s_cmp_eq_u32 s63, 1835008
s_cselect_b32 s63, 0, s63
s_waitcnt vmcnt(36)
s_barrier
s_add_u32 m0, s59, 147456
s_add_u32 s60, s69, 0
buffer_load_dwordx4 v42, s[44:47], s60 offen sc1 lds
s_add_u32 m0, s59, 149504
s_add_u32 s60, s69, 2048
buffer_load_dwordx4 v42, s[44:47], s60 offen sc1 lds
s_add_u32 m0, s59, 151552
s_add_u32 s60, s69, 131072
buffer_load_dwordx4 v42, s[44:47], s60 offen sc1 lds
s_add_u32 m0, s59, 153600
s_add_u32 s60, s69, 133120
buffer_load_dwordx4 v42, s[44:47], s60 offen sc1 lds
s_add_u32 s69, s69, 262144
s_cmp_eq_u32 s69, s68
s_cselect_b32 s69, s67, s69
s_add_u32 m0, s59, 65536
s_add_u32 s60, s63, 0
buffer_load_dwordx4 v41, s[48:51], s60 offen lds
s_add_u32 m0, s59, 67584
s_add_u32 s60, s63, 16384
buffer_load_dwordx4 v41, s[48:51], s60 offen lds
s_add_u32 m0, s59, 69632
s_add_u32 s60, s63, 32768
buffer_load_dwordx4 v41, s[48:51], s60 offen lds
s_add_u32 m0, s59, 71680
s_add_u32 s60, s63, 49152
buffer_load_dwordx4 v41, s[48:51], s60 offen lds
s_add_u32 s63, s63, 65536
s_cmp_eq_u32 s63, 1835008
s_cselect_b32 s63, 0, s63
s_waitcnt vmcnt(36)
s_barrier
s_add_u32 m0, s59, 155648
s_add_u32 s60, s69, 0
buffer_load_dwordx4 v42, s[44:47], s60 offen sc1 lds
s_add_u32 m0, s59, 157696
s_add_u32 s60, s69, 2048
buffer_load_dwordx4 v42, s[44:47], s60 offen sc1 lds
s_add_u32 m0, s59, 159744
s_add_u32 s60, s69, 131072
buffer_load_dwordx4 v42, s[44:47], s60 offen sc1 lds
s_add_u32 m0, s59, 161792
s_add_u32 s60, s69, 133120
buffer_load_dwordx4 v42, s[44:47], s60 offen sc1 lds
s_add_u32 s69, s69, 262144
s_cmp_eq_u32 s69, s68
s_cselect_b32 s69, s67, s69
s_add_u32 m0, s59, 73728
s_add_u32 s60, s63, 0
buffer_load_dwordx4 v41, s[48:51], s60 offen lds
s_add_u32 m0, s59, 75776
s_add_u32 s60, s63, 16384
buffer_load_dwordx4 v41, s[48:51], s60 offen lds
s_add_u32 m0, s59, 77824
s_add_u32 s60, s63, 32768
buffer_load_dwordx4 v41, s[48:51], s60 offen lds
s_add_u32 m0, s59, 79872
s_add_u32 s60, s63, 49152
buffer_load_dwordx4 v41, s[48:51], s60 offen lds
s_add_u32 s63, s63, 65536
s_cmp_eq_u32 s63, 1835008
s_cselect_b32 s63, 0, s63
s_waitcnt vmcnt(36)
s_barrier
s_add_u32 m0, s59, 114688
s_add_u32 s60, s69, 0
buffer_load_dwordx4 v42, s[44:47], s60 offen sc1 lds
s_add_u32 m0, s59, 116736
s_add_u32 s60, s69, 2048
buffer_load_dwordx4 v42, s[44:47], s60 offen sc1 lds
s_add_u32 m0, s59, 118784
s_add_u32 s60, s69, 131072
buffer_load_dwordx4 v42, s[44:47], s60 offen sc1 lds
s_add_u32 m0, s59, 120832
s_add_u32 s60, s69, 133120
buffer_load_dwordx4 v42, s[44:47], s60 offen sc1 lds
s_add_u32 s69, s69, 262144
s_cmp_eq_u32 s69, s68
s_cselect_b32 s69, s67, s69
s_lshl_b32 s63, s58, 16
s_add_u32 m0, s59, 81920
s_add_u32 s60, s63, 0
buffer_load_dwordx4 v41, s[52:55], s60 offen lds
s_add_u32 m0, s59, 83968
s_add_u32 s60, s63, 16384
buffer_load_dwordx4 v41, s[52:55], s60 offen lds
s_add_u32 m0, s59, 86016
s_add_u32 s60, s63, 32768
buffer_load_dwordx4 v41, s[52:55], s60 offen lds
s_add_u32 m0, s59, 88064
s_add_u32 s60, s63, 49152
buffer_load_dwordx4 v41, s[52:55], s60 offen lds
s_add_u32 s63, s63, 65536
s_and_b32 s63, s63, 524287
s_waitcnt vmcnt(36)
s_barrier
s_add_u32 m0, s59, 8192
s_add_u32 s60, s69, 0
buffer_load_dwordx4 v42, s[44:47], s60 offen sc1 lds
s_add_u32 m0, s59, 10240
s_add_u32 s60, s69, 2048
buffer_load_dwordx4 v42, s[44:47], s60 offen sc1 lds
s_add_u32 m0, s59, 12288
s_add_u32 s60, s69, 131072
buffer_load_dwordx4 v42, s[44:47], s60 offen sc1 lds
s_add_u32 m0, s59, 14336
s_add_u32 s60, s69, 133120
buffer_load_dwordx4 v42, s[44:47], s60 offen sc1 lds
s_add_u32 s69, s69, 262144
s_cmp_eq_u32 s69, s68
s_cselect_b32 s69, s67, s69
s_add_u32 m0, s59, 90112
s_add_u32 s60, s63, 0
buffer_load_dwordx4 v41, s[52:55], s60 offen lds
s_add_u32 m0, s59, 92160
s_add_u32 s60, s63, 16384
buffer_load_dwordx4 v41, s[52:55], s60 offen lds
s_add_u32 m0, s59, 94208
s_add_u32 s60, s63, 32768
buffer_load_dwordx4 v41, s[52:55], s60 offen lds
s_add_u32 m0, s59, 96256
s_add_u32 s60, s63, 49152
buffer_load_dwordx4 v41, s[52:55], s60 offen lds
s_add_u32 s63, s63, 65536
s_and_b32 s63, s63, 524287
s_waitcnt vmcnt(36)
s_barrier
s_add_u32 m0, s59, 122880
s_add_u32 s60, s69, 0
buffer_load_dwordx4 v42, s[44:47], s60 offen sc1 lds
s_add_u32 m0, s59, 124928
s_add_u32 s60, s69, 2048
buffer_load_dwordx4 v42, s[44:47], s60 offen sc1 lds
s_add_u32 m0, s59, 126976
s_add_u32 s60, s69, 131072
buffer_load_dwordx4 v42, s[44:47], s60 offen sc1 lds
s_add_u32 m0, s59, 129024
s_add_u32 s60, s69, 133120
buffer_load_dwordx4 v42, s[44:47], s60 offen sc1 lds
s_add_u32 s69, s69, 262144
s_cmp_eq_u32 s69, s68
s_cselect_b32 s69, s67, s69
s_add_u32 m0, s59, 98304
s_add_u32 s60, s63, 0
buffer_load_dwordx4 v41, s[52:55], s60 offen lds
s_add_u32 m0, s59, 100352
s_add_u32 s60, s63, 16384
buffer_load_dwordx4 v41, s[52:55], s60 offen lds
s_add_u32 m0, s59, 102400
s_add_u32 s60, s63, 32768
buffer_load_dwordx4 v41, s[52:55], s60 offen lds
s_add_u32 m0, s59, 104448
s_add_u32 s60, s63, 49152
buffer_load_dwordx4 v41, s[52:55], s60 offen lds
s_add_u32 s63, s63, 65536
s_and_b32 s63, s63, 524287
s_waitcnt vmcnt(36)
s_barrier
s_mov_b32 s67, s68
s_mul_i32 s60, s58, 262144
s_add_u32 s69, s68, s60
s_add_u32 s68, s68, 2097152
s_add_u32 m0, s59, 16384
s_add_u32 s60, s69, 0
buffer_load_dwordx4 v42, s[44:47], s60 offen sc1 lds
s_add_u32 m0, s59, 18432
s_add_u32 s60, s69, 2048
buffer_load_dwordx4 v42, s[44:47], s60 offen sc1 lds
s_add_u32 m0, s59, 20480
s_add_u32 s60, s69, 131072
buffer_load_dwordx4 v42, s[44:47], s60 offen sc1 lds
s_add_u32 m0, s59, 22528
s_add_u32 s60, s69, 133120
buffer_load_dwordx4 v42, s[44:47], s60 offen sc1 lds
s_add_u32 s69, s69, 262144
s_cmp_eq_u32 s69, s68
s_cselect_b32 s69, s67, s69
s_add_u32 m0, s59, 106496
s_add_u32 s60, s63, 0
buffer_load_dwordx4 v41, s[52:55], s60 offen lds
s_add_u32 m0, s59, 108544
s_add_u32 s60, s63, 16384
buffer_load_dwordx4 v41, s[52:55], s60 offen lds
s_add_u32 m0, s59, 110592
s_add_u32 s60, s63, 32768
buffer_load_dwordx4 v41, s[52:55], s60 offen lds
s_add_u32 m0, s59, 112640
s_add_u32 s60, s63, 49152
buffer_load_dwordx4 v41, s[52:55], s60 offen lds
s_add_u32 s63, s63, 65536
s_and_b32 s63, s63, 524287
s_waitcnt vmcnt(36)
s_barrier
s_add_u32 m0, s59, 131072
s_add_u32 s60, s69, 0
buffer_load_dwordx4 v42, s[44:47], s60 offen sc1 lds
s_add_u32 m0, s59, 133120
s_add_u32 s60, s69, 2048
buffer_load_dwordx4 v42, s[44:47], s60 offen sc1 lds
s_add_u32 m0, s59, 135168
s_add_u32 s60, s69, 131072
buffer_load_dwordx4 v42, s[44:47], s60 offen sc1 lds
s_add_u32 m0, s59, 137216
s_add_u32 s60, s69, 133120
buffer_load_dwordx4 v42, s[44:47], s60 offen sc1 lds
s_add_u32 s69, s69, 262144
s_cmp_eq_u32 s69, s68
s_cselect_b32 s69, s67, s69
s_add_u32 m0, s59, 32768
s_add_u32 s60, s63, 0
buffer_load_dwordx4 v41, s[52:55], s60 offen lds
s_add_u32 m0, s59, 34816
s_add_u32 s60, s63, 16384
buffer_load_dwordx4 v41, s[52:55], s60 offen lds
s_add_u32 m0, s59, 36864
s_add_u32 s60, s63, 32768
buffer_load_dwordx4 v41, s[52:55], s60 offen lds
s_add_u32 m0, s59, 38912
s_add_u32 s60, s63, 49152
buffer_load_dwordx4 v41, s[52:55], s60 offen lds
s_add_u32 s63, s63, 65536
s_and_b32 s63, s63, 524287
s_waitcnt vmcnt(36)
s_barrier
s_add_u32 m0, s59, 24576
s_add_u32 s60, s69, 0
buffer_load_dwordx4 v42, s[44:47], s60 offen sc1 lds
s_add_u32 m0, s59, 26624
s_add_u32 s60, s69, 2048
buffer_load_dwordx4 v42, s[44:47], s60 offen sc1 lds
s_add_u32 m0, s59, 28672
s_add_u32 s60, s69, 131072
buffer_load_dwordx4 v42, s[44:47], s60 offen sc1 lds
s_add_u32 m0, s59, 30720
s_add_u32 s60, s69, 133120
buffer_load_dwordx4 v42, s[44:47], s60 offen sc1 lds
s_add_u32 s69, s69, 262144
s_cmp_eq_u32 s69, s68
s_cselect_b32 s69, s67, s69
s_add_u32 m0, s59, 40960
s_add_u32 s60, s63, 0
buffer_load_dwordx4 v41, s[52:55], s60 offen lds
s_add_u32 m0, s59, 43008
s_add_u32 s60, s63, 16384
buffer_load_dwordx4 v41, s[52:55], s60 offen lds
s_add_u32 m0, s59, 45056
s_add_u32 s60, s63, 32768
buffer_load_dwordx4 v41, s[52:55], s60 offen lds
s_add_u32 m0, s59, 47104
s_add_u32 s60, s63, 49152
buffer_load_dwordx4 v41, s[52:55], s60 offen lds
s_add_u32 s63, s63, 65536
s_and_b32 s63, s63, 524287
s_waitcnt vmcnt(36)
s_barrier
s_add_u32 m0, s59, 139264
s_add_u32 s60, s69, 0
buffer_load_dwordx4 v42, s[44:47], s60 offen sc1 lds
s_add_u32 m0, s59, 141312
s_add_u32 s60, s69, 2048
buffer_load_dwordx4 v42, s[44:47], s60 offen sc1 lds
s_add_u32 m0, s59, 143360
s_add_u32 s60, s69, 131072
buffer_load_dwordx4 v42, s[44:47], s60 offen sc1 lds
s_add_u32 m0, s59, 145408
s_add_u32 s60, s69, 133120
buffer_load_dwordx4 v42, s[44:47], s60 offen sc1 lds
s_add_u32 s69, s69, 262144
s_cmp_eq_u32 s69, s68
s_cselect_b32 s69, s67, s69
s_add_u32 m0, s59, 147456
s_add_u32 s60, s63, 0
buffer_load_dwordx4 v41, s[52:55], s60 offen lds
s_add_u32 m0, s59, 149504
s_add_u32 s60, s63, 16384
buffer_load_dwordx4 v41, s[52:55], s60 offen lds
s_add_u32 m0, s59, 151552
s_add_u32 s60, s63, 32768
buffer_load_dwordx4 v41, s[52:55], s60 offen lds
s_add_u32 m0, s59, 153600
s_add_u32 s60, s63, 49152
buffer_load_dwordx4 v41, s[52:55], s60 offen lds
s_add_u32 s63, s63, 65536
s_and_b32 s63, s63, 524287
s_waitcnt vmcnt(36)
s_barrier
s_add_u32 m0, s59, 0
s_add_u32 s60, s69, 0
buffer_load_dwordx4 v42, s[44:47], s60 offen sc1 lds
s_add_u32 m0, s59, 2048
s_add_u32 s60, s69, 2048
buffer_load_dwordx4 v42, s[44:47], s60 offen sc1 lds
s_add_u32 m0, s59, 4096
s_add_u32 s60, s69, 131072
buffer_load_dwordx4 v42, s[44:47], s60 offen sc1 lds
s_add_u32 m0, s59, 6144
s_add_u32 s60, s69, 133120
buffer_load_dwordx4 v42, s[44:47], s60 offen sc1 lds
s_add_u32 s69, s69, 262144
s_cmp_eq_u32 s69, s68
s_cselect_b32 s69, s67, s69
s_add_u32 m0, s59, 155648
s_add_u32 s60, s63, 0
buffer_load_dwordx4 v41, s[52:55], s60 offen lds
s_add_u32 m0, s59, 157696
s_add_u32 s60, s63, 16384
buffer_load_dwordx4 v41, s[52:55], s60 offen lds
s_add_u32 m0, s59, 159744
s_add_u32 s60, s63, 32768
buffer_load_dwordx4 v41, s[52:55], s60 offen lds
s_add_u32 m0, s59, 161792
s_add_u32 s60, s63, 49152
buffer_load_dwordx4 v41, s[52:55], s60 offen lds
s_add_u32 s63, s63, 65536
s_and_b32 s63, s63, 524287
s_waitcnt vmcnt(36)
s_barrier
s_add_u32 m0, s59, 49152
s_add_u32 s60, s69, 0
buffer_load_dwordx4 v42, s[44:47], s60 offen sc1 lds
s_add_u32 m0, s59, 51200
s_add_u32 s60, s69, 2048
buffer_load_dwordx4 v42, s[44:47], s60 offen sc1 lds
s_add_u32 m0, s59, 53248
s_add_u32 s60, s69, 131072
buffer_load_dwordx4 v42, s[44:47], s60 offen sc1 lds
s_add_u32 m0, s59, 55296
s_add_u32 s60, s69, 133120
buffer_load_dwordx4 v42, s[44:47], s60 offen sc1 lds
s_add_u32 s69, s69, 262144
s_cmp_eq_u32 s69, s68
s_cselect_b32 s69, s67, s69
s_waitcnt vmcnt(32)
s_barrier
s_add_u32 m0, s59, 114688
s_add_u32 s60, s69, 0
buffer_load_dwordx4 v42, s[44:47], s60 offen sc1 lds
s_add_u32 m0, s59, 116736
s_add_u32 s60, s69, 2048
buffer_load_dwordx4 v42, s[44:47], s60 offen sc1 lds
s_add_u32 m0, s59, 118784
s_add_u32 s60, s69, 131072
buffer_load_dwordx4 v42, s[44:47], s60 offen sc1 lds
s_add_u32 m0, s59, 120832
s_add_u32 s60, s69, 133120
buffer_load_dwordx4 v42, s[44:47], s60 offen sc1 lds
s_add_u32 s69, s69, 262144
s_cmp_eq_u32 s69, s68
s_cselect_b32 s69, s67, s69
s_waitcnt vmcnt(28)
s_barrier
s_add_u32 m0, s59, 57344
s_add_u32 s60, s69, 0
buffer_load_dwordx4 v42, s[44:47], s60 offen sc1 lds
s_add_u32 m0, s59, 59392
s_add_u32 s60, s69, 2048
buffer_load_dwordx4 v42, s[44:47], s60 offen sc1 lds
s_add_u32 m0, s59, 61440
s_add_u32 s60, s69, 131072
buffer_load_dwordx4 v42, s[44:47], s60 offen sc1 lds
s_add_u32 m0, s59, 63488
s_add_u32 s60, s69, 133120
buffer_load_dwordx4 v42, s[44:47], s60 offen sc1 lds
s_add_u32 s69, s69, 262144
s_cmp_eq_u32 s69, s68
s_cselect_b32 s69, s67, s69
s_waitcnt vmcnt(24)
s_barrier
s_waitcnt vmcnt(16)
s_barrier
s_waitcnt vmcnt(8)
s_barrier
s_waitcnt vmcnt(4)
s_barrier
s_waitcnt vmcnt(0)
s_barrier
k2_fin:
k_end:
s_endpgm
code_end:
.section .rodata,"a"
.p2align 6
.amdhsa_kernel recurrent_scan__linear_attn_block__dense_activation_squared_relu__prompt_kernel
  .amdhsa_next_free_vgpr 256
  .amdhsa_next_free_sgpr 102
  .amdhsa_accum_offset 256
  .amdhsa_group_segment_fixed_size 0
  .amdhsa_kernarg_size 88
  .amdhsa_user_sgpr_count 2
  .amdhsa_user_sgpr_kernarg_segment_ptr 1
  .amdhsa_system_sgpr_workgroup_id_x 1
  .amdhsa_float_denorm_mode_32 3
.end_amdhsa_kernel
```
